```python
import torch

def _softmax(x, axis=-1):
    return torch.softmax(x, dim=axis)

def _gelu(x):
    return torch.nn.functional.gelu(x, approximate='tanh')

def _silu(x):
    return torch.nn.functional.silu(x)

def _sigmoid(x):
    return torch.sigmoid(x)

def _layernorm(x, axis=-1, eps=1e-05):
    m = x.mean(dim=axis, keepdim=True)
    v = x.var(dim=axis, keepdim=True, unbiased=False)
    return (x - m) / torch.sqrt(v + eps)

def _scatter_add(tgt, idx, src, axis=0):
    return tgt.clone().index_add_(axis, idx, src)

def _segment_sum(src, seg, n):
    out = torch.zeros((n,) + src.shape[1:], dtype=src.dtype)
    return out.index_add_(0, seg, src)

def _pad(x, pw):
    flat = tuple((v for pair in reversed(pw) for v in pair))
    return torch.nn.functional.pad(x, flat)
kernel_name = 'adaLN_cond__softmax_full_mha__dense_activation_silu__prompt'

def setup_inputs():

    _w = lambda a: (lambda t: t.to(torch.bfloat16) if t.is_floating_point() else t)(torch.as_tensor(a))

    def _A_setup():
        B, S, D = (1, 2048, 576)
        return {'x': _w((lambda *s: torch.randn(*s, dtype=torch.bfloat16) * 0.05)(B, S, D)), 'wqkv': _w((lambda *s: torch.randn(*s, dtype=torch.bfloat16) * 0.05)(D, 3 * D)), 'wo': _w((lambda *s: torch.randn(*s, dtype=torch.bfloat16) * 0.05)(D, D))}
    _A_in = _A_setup()

    def _B_setup():
        B, S, D, F = (1, 2048, 576, 4608)
        return {'x': _w((lambda *s: torch.randn(*s, dtype=torch.bfloat16) * 0.05)(B, S, D)), 'w1': _w((lambda *s: torch.randn(*s, dtype=torch.bfloat16) * 3.2)(D, F) * D ** (-0.5)), 'w2': _w((lambda *s: torch.randn(*s, dtype=torch.bfloat16) * 0.4)(F, D) * F ** (-0.5))}
    _B_in = _B_setup()
    return {'A_x': _A_in['x'], 'A_wqkv': _A_in['wqkv'], 'A_wo': _A_in['wo'], 'B_x': _B_in['x'], 'B_w1': _B_in['w1'], 'B_w2': _B_in['w2'], 'c': _w((lambda *s: torch.randn(*s, dtype=torch.bfloat16) * 0.1)(1, 576) * 8.0), 'w_mod': _w((lambda *s: torch.randn(*s, dtype=torch.bfloat16) * 0.1)(576, 6 * 576) * 576 ** (-0.5) * 8.0)}

def reference(A_x, A_wqkv, A_wo, B_x, B_w1, B_w2, c, w_mod):

    def _A_ref(x, wqkv, wo):
        B, S, D = x.shape
        H = 32
        Dh = D // H
        qkv = (lambda x, *d: x.permute(*d))((x @ wqkv).reshape(B, S, 3, H, Dh), 2, 0, 3, 1, 4)
        q, k, v = (qkv[0], qkv[1], qkv[2])
        scale = Dh ** (-0.5)
        scores = torch.einsum('bhqd,bhkd->bhqk', q, k) * scale
        p = _softmax(scores, axis=-1)
        o = torch.einsum('bhqk,bhkd->bhqd', p, v)
        return (lambda x, *d: x.permute(*d))(o, 0, 2, 1, 3).reshape(B, S, D) @ wo

    def _B_ref(x, w1, w2):
        h = torch.einsum('bsd,df->bsf', x, w1)
        h = _silu(h)
        out = torch.einsum('bsf,fd->bsd', h, w2)
        return out
    x = A_x
    mod = (_silu(c) @ w_mod).reshape(c.shape[0], 6, 1, -1)
    sa, ca, ga, sb, cb, gb = (mod[:, 0].clone(), mod[:, 1].clone(), mod[:, 2].clone(), mod[:, 3].clone(), mod[:, 4].clone(), mod[:, 5].clone())
    h = _layernorm(x, axis=-1) * (1 + ca) + sa
    x = x + ga * _A_ref(h, A_wqkv, A_wo)
    h = _layernorm(x, axis=-1) * (1 + cb) + sb
    x = x + gb * _B_ref(h, B_w1, B_w2)
    return x
```

```asm
; @launch kernel=k1_kernel grid=(256,1,1) block=(512,1,1) lds=117440
; @launch kernel=k2_kernel grid=(256,1,1) block=(768,1,1) lds=163840
; @launch kernel=km_kernel grid=(256,1,1) block=(512,1,1) lds=151552
.amdgcn_target "amdgcn-amd-amdhsa--gfx950"
.text
.globl k1_kernel
.p2align 8
.type k1_kernel,@function
k1_kernel:
    s_load_dwordx16 s[8:23], s[0:1], 0
    s_load_dwordx4 s[24:27], s[0:1], 64
    s_load_dwordx2 s[28:29], s[0:1], 80
    s_cmp_ge_u32 s2, 256
    s_cbranch_scc1 END_k1_kernel
    v_lshrrev_b32 v2, 6, v0
    v_and_b32 v1, 63, v0
    v_readfirstlane_b32 s6, v2
    s_bfe_u32 s64, s2, 0x10002
    s_lshl_b32 s64, s64, 4
    s_lshr_b32 s5, s2, 4
    s_add_u32 s64, s64, s5
    s_nop 0
    s_lshl_b32 s65, s64, 3
    s_add_u32 s65, s65, s6
    s_mul_i32 s65, s65, 9216
    s_add_u32 s66, s65, 4608
    v_lshrrev_b32 v25, 3, v1
    v_and_b32 v24, 7, v1
    v_mul_u32_u24 v26, 1152, v25
    v_lshl_add_u32 v26, v24, 4, v26
    v_lshlrev_b32 v27, 4, v1
    v_mov_b32 v23, 114304
    s_mul_i32 s68, s6, 9216
    s_add_u32 s68, s68, 74880
    s_mov_b32 s69, 0x40000
    s_mov_b32 s77, s2
    s_cmp_lt_u32 s2, 90
    s_mov_b32 s5, 92
    s_cselect_b32 s5, s5, -54
    s_cmp_lt_u32 s2, 36
    s_cselect_b32 s5, 0, s5
    s_cmp_ge_u32 s2, 182
    s_cselect_b32 s5, 0, s5
    s_add_u32 s2, s2, s5
    s_nop 0
    s_cmp_eq_u32 s6, 7
    s_cbranch_scc1 KF_7
    s_cmp_ge_u32 s6, 4
    s_cbranch_scc1 KF_N
    s_cmp_ge_u32 s2, 128
    s_cbranch_scc1 KF_P
    s_cmp_ge_u32 s2, 108
    s_cbranch_scc1 KF_W
    s_mul_i32 s5, s6, 995328
    s_lshl_b32 s7, s2, 6
    s_add_u32 s5, s5, s7
    v_lshrrev_b32 v2, 2, v1
    v_mul_u32_u24 v2, 6912, v2
    v_and_b32 v3, 3, v1
    v_lshl_add_u32 v2, v3, 4, v2
    v_lshlrev_b32 v3, 1, v1
    s_mul_i32 s30, s6, 288
    s_waitcnt lgkmcnt(0)
    s_mov_b32 s32, s22
    s_mov_b32 s33, s23
    s_mov_b32 s34, 3981312
    s_mov_b32 s35, 0x20000
    s_mov_b32 s36, s20
    s_mov_b32 s37, s21
    s_mov_b32 s38, 1152
    s_mov_b32 s39, 0x20000
    buffer_load_ushort v8, v3, s[36:39], s30 offen offset:0
    buffer_load_ushort v9, v3, s[36:39], s30 offen offset:128
    buffer_load_ushort v10, v3, s[36:39], s30 offen offset:256
    s_add_u32 m0, s68, 0
    s_add_u32 s31, s5, 0
    buffer_load_dwordx4 v2, s[32:35], s31 offen lds
    s_add_u32 m0, s68, 1024
    s_add_u32 s31, s5, 110592
    buffer_load_dwordx4 v2, s[32:35], s31 offen lds
    s_add_u32 m0, s68, 2048
    s_add_u32 s31, s5, 221184
    buffer_load_dwordx4 v2, s[32:35], s31 offen lds
    s_add_u32 m0, s68, 3072
    s_add_u32 s31, s5, 331776
    buffer_load_dwordx4 v2, s[32:35], s31 offen lds
    s_add_u32 m0, s68, 4096
    s_add_u32 s31, s5, 442368
    buffer_load_dwordx4 v2, s[32:35], s31 offen lds
    s_add_u32 m0, s68, 5120
    s_add_u32 s31, s5, 552960
    buffer_load_dwordx4 v2, s[32:35], s31 offen lds
    s_add_u32 m0, s68, 6144
    s_add_u32 s31, s5, 663552
    buffer_load_dwordx4 v2, s[32:35], s31 offen lds
    s_add_u32 m0, s68, 7168
    s_add_u32 s31, s5, 774144
    buffer_load_dwordx4 v2, s[32:35], s31 offen lds
    s_add_u32 m0, s68, 8192
    s_add_u32 s31, s5, 884736
    buffer_load_dwordx4 v2, s[32:35], s31 offen lds
    s_mov_b32 s44, s8
    s_mov_b32 s45, s9
    s_mov_b32 s46, 2359296
    s_mov_b32 s47, 0x20000
    buffer_load_dwordx4 v[28:31], v27, s[44:47], s65 offen offset:0
    buffer_load_dwordx4 v[32:35], v27, s[44:47], s65 offen offset:1152
    buffer_load_dwordx4 v[36:39], v27, s[44:47], s65 offen offset:2304
    buffer_load_dwordx4 v[40:43], v27, s[44:47], s65 offen offset:3456
    buffer_load_dwordx4 v[44:47], v27, s[44:47], s66 offen offset:0
    buffer_load_dwordx4 v[48:51], v27, s[44:47], s66 offen offset:1152
    buffer_load_dwordx4 v[52:55], v27, s[44:47], s66 offen offset:2304
    buffer_load_dwordx4 v[56:59], v27, s[44:47], s66 offen offset:3456
    buffer_load_dwordx4 v[60:63], v26, s[44:47], s65 offen offset:1024
    s_mov_b32 s44, s26
    s_mov_b32 s45, s27
    s_mov_b32 s46, 256
    s_mov_b32 s47, 0x20000
    s_barrier
    s_add_u32 s40, s28, 65536
    s_addc_u32 s41, s29, 0
    s_mov_b32 s42, 23296
    s_mov_b32 s43, 0x20000
    v_lshrrev_b32 v4, 4, v1
    v_bfe_u32 v5, v1, 2, 2
    v_and_b32 v6, 3, v1
    v_lshrrev_b32 v7, 1, v4
    v_lshl_add_u32 v5, v7, 3, v5
    v_lshlrev_b32 v5, 6, v5
    v_and_b32 v4, 1, v4
    v_lshl_add_u32 v5, v4, 5, v5
    v_lshl_add_u32 v5, v6, 3, v5
    v_add_u32 v5, s68, v5
    s_lshl_b32 s30, s6, 9
    s_add_u32 s30, s30, 111744
    v_add_u32 v4, s30, v3
    v_lshlrev_b32 v7, 4, v7
    v_add_u32 v7, s30, v7
    s_mov_b32 s31, 3216550459
    s_waitcnt vmcnt(18)
    v_lshlrev_b32 v8, 16, v8
    v_mul_f32 v12, s31, v8
    v_lshlrev_b32 v9, 16, v9
    v_mul_f32 v13, s31, v9
    v_lshlrev_b32 v10, 16, v10
    v_mul_f32 v14, s31, v10
    v_exp_f32 v12, v12
    v_exp_f32 v13, v13
    v_exp_f32 v14, v14
    v_add_f32 v12, 1.0, v12
    v_add_f32 v13, 1.0, v13
    v_add_f32 v14, 1.0, v14
    v_rcp_f32 v12, v12
    v_rcp_f32 v13, v13
    v_rcp_f32 v14, v14
    v_mul_f32 v12, v8, v12
    v_mul_f32 v13, v9, v13
    v_mul_f32 v14, v10, v14
    v_cvt_pk_bf16_f32 v12, v12, v12
    v_cvt_pk_bf16_f32 v13, v13, v13
    v_cvt_pk_bf16_f32 v14, v14, v14
    ds_write_b16 v4, v12 offset:0
    ds_write_b16 v4, v13 offset:128
    ds_write_b16 v4, v14 offset:256
    v_and_b32 v2, 31, v1
    v_lshlrev_b32 v6, 4, v2
    v_add_u32 v6, 113792, v6
    s_lshl_b32 s30, s6, 2
    v_add_u32 v4, s30, v6
    s_sub_u32 s3, s2, 18
    s_cmp_lt_u32 s3, 18
    s_cselect_b32 s4, 1.0, 0
    s_sub_u32 s3, s2, 72
    s_cmp_lt_u32 s3, 18
    s_cselect_b32 s4, 1.0, s4
    s_lshl_b32 s5, s2, 6
    s_add_u32 s5, s5, 16384
    s_mov_b32 s31, 4
    s_mov_b32 s7, 35
    v_mov_b32 v12, 1
    ds_read_b128 v[64:67], v7 offset:0
    ds_read_b128 v[72:75], v7 offset:32
    ds_read_b128 v[80:83], v7 offset:64
    ds_read_b128 v[88:91], v7 offset:96
    ds_read_b128 v[96:99], v7 offset:128
    ds_read_b128 v[104:107], v7 offset:160
    ds_read_b128 v[112:115], v7 offset:192
    ds_read_b128 v[120:123], v7 offset:224
    ds_read_b128 v[128:131], v7 offset:256
    s_waitcnt vmcnt(17) lgkmcnt(0)
    ds_read_b64_tr_b16 v[68:69], v5 offset:0
    ds_read_b64_tr_b16 v[70:71], v5 offset:256
    s_waitcnt vmcnt(16)
    ds_read_b64_tr_b16 v[76:77], v5 offset:1024
    ds_read_b64_tr_b16 v[78:79], v5 offset:1280
    s_waitcnt lgkmcnt(2)
    v_mfma_f32_32x32x16_bf16 v[208:223], v[64:67], v[68:71], 0
    s_waitcnt vmcnt(15)
    ds_read_b64_tr_b16 v[84:85], v5 offset:2048
    ds_read_b64_tr_b16 v[86:87], v5 offset:2304
    s_waitcnt lgkmcnt(2)
    v_mfma_f32_32x32x16_bf16 v[208:223], v[72:75], v[76:79], v[208:223]
    s_waitcnt vmcnt(14)
    ds_read_b64_tr_b16 v[92:93], v5 offset:3072
    ds_read_b64_tr_b16 v[94:95], v5 offset:3328
    s_waitcnt lgkmcnt(2)
    v_mfma_f32_32x32x16_bf16 v[208:223], v[80:83], v[84:87], v[208:223]
    s_waitcnt vmcnt(13)
    ds_read_b64_tr_b16 v[100:101], v5 offset:4096
    ds_read_b64_tr_b16 v[102:103], v5 offset:4352
    s_waitcnt lgkmcnt(2)
    v_mfma_f32_32x32x16_bf16 v[208:223], v[88:91], v[92:95], v[208:223]
    s_waitcnt vmcnt(12)
    ds_read_b64_tr_b16 v[108:109], v5 offset:5120
    ds_read_b64_tr_b16 v[110:111], v5 offset:5376
    s_waitcnt lgkmcnt(2)
    v_mfma_f32_32x32x16_bf16 v[208:223], v[96:99], v[100:103], v[208:223]
    s_waitcnt vmcnt(11)
    ds_read_b64_tr_b16 v[116:117], v5 offset:6144
    ds_read_b64_tr_b16 v[118:119], v5 offset:6400
    s_waitcnt lgkmcnt(2)
    v_mfma_f32_32x32x16_bf16 v[208:223], v[104:107], v[108:111], v[208:223]
    s_waitcnt vmcnt(10)
    ds_read_b64_tr_b16 v[124:125], v5 offset:7168
    ds_read_b64_tr_b16 v[126:127], v5 offset:7424
    s_waitcnt lgkmcnt(2)
    v_mfma_f32_32x32x16_bf16 v[208:223], v[112:115], v[116:119], v[208:223]
    s_waitcnt vmcnt(9)
    ds_read_b64_tr_b16 v[132:133], v5 offset:8192
    ds_read_b64_tr_b16 v[134:135], v5 offset:8448
    s_waitcnt lgkmcnt(2)
    v_mfma_f32_32x32x16_bf16 v[208:223], v[120:123], v[124:127], v[208:223]
    s_waitcnt lgkmcnt(0)
    v_mfma_f32_32x32x16_bf16 v[208:223], v[128:131], v[132:135], v[208:223]
    s_nop 11
    ds_write_b32 v4, v208
    s_mov_b64 exec, 1
    s_waitcnt lgkmcnt(0)
    ds_add_rtn_u32 v13, v23, v12 offset:4
    s_mov_b32 exec_lo, -1
    s_waitcnt lgkmcnt(0)
    v_readfirstlane_b32 s30, v13
    s_nop 0
    s_cmp_lg_u32 s30, 3
    s_cbranch_scc1 KF_S0
    ds_read_b128 v[8:11], v6
    s_waitcnt lgkmcnt(0)
    v_add_f32 v8, v8, v9
    v_add_f32 v10, v10, v11
    v_add_f32 v8, v8, v10
    v_cvt_pk_bf16_f32 v8, v8, v8
    v_lshlrev_b32 v8, 16, v8
    v_add_f32 v8, s4, v8
    v_cvt_pk_bf16_f32 v9, v8, v8
    buffer_store_short v9, v3, s[40:43], s5 offen sc1
    s_cmp_lt_u32 s2, 36
    s_cbranch_scc1 KF_FL
    s_mov_b32 exec_hi, -1
    s_waitcnt vmcnt(1)
    s_branch KF_S
KF_P:
    s_sub_u32 s31, s2, 128
    s_lshl_b32 s31, s31, 2
    s_add_u32 s31, s31, s6
    s_cmp_ge_u32 s31, 216
    s_cbranch_scc1 KF_N
    s_mul_i32 s3, s31, 1821
    s_lshr_b32 s3, s3, 16
    s_mul_i32 s4, s3, 36
    s_sub_u32 s4, s31, s4
    s_mul_i32 s5, s4, 55296
    s_mul_i32 s7, s3, 576
    s_add_u32 s5, s5, s7
    v_add_u32 v2, 0, v1
    v_mul_u32_u24 v3, 1821, v2
    v_lshrrev_b32 v3, 16, v3
    v_lshlrev_b32 v2, 4, v2
    v_mul_u32_u24 v3, 2880, v3
    v_add_u32 v8, v2, v3
    v_add_u32 v2, 64, v1
    v_mul_u32_u24 v3, 1821, v2
    v_lshrrev_b32 v3, 16, v3
    v_lshlrev_b32 v2, 4, v2
    v_mul_u32_u24 v3, 2880, v3
    v_add_u32 v9, v2, v3
    v_add_u32 v2, 128, v1
    v_mul_u32_u24 v3, 1821, v2
    v_lshrrev_b32 v3, 16, v3
    v_lshlrev_b32 v2, 4, v2
    v_mul_u32_u24 v3, 2880, v3
    v_add_u32 v10, v2, v3
    v_add_u32 v2, 192, v1
    v_mul_u32_u24 v3, 1821, v2
    v_lshrrev_b32 v3, 16, v3
    v_lshlrev_b32 v2, 4, v2
    v_mul_u32_u24 v3, 2880, v3
    v_add_u32 v11, v2, v3
    v_add_u32 v2, 256, v1
    v_mul_u32_u24 v3, 1821, v2
    v_lshrrev_b32 v3, 16, v3
    v_lshlrev_b32 v2, 4, v2
    v_mul_u32_u24 v3, 2880, v3
    v_add_u32 v12, v2, v3
    v_add_u32 v2, 320, v1
    v_mul_u32_u24 v3, 1821, v2
    v_lshrrev_b32 v3, 16, v3
    v_lshlrev_b32 v2, 4, v2
    v_mul_u32_u24 v3, 2880, v3
    v_add_u32 v13, v2, v3
    v_add_u32 v2, 384, v1
    v_mul_u32_u24 v3, 1821, v2
    v_lshrrev_b32 v3, 16, v3
    v_lshlrev_b32 v2, 4, v2
    v_mul_u32_u24 v3, 2880, v3
    v_add_u32 v14, v2, v3
    v_add_u32 v2, 448, v1
    v_mul_u32_u24 v3, 1821, v2
    v_lshrrev_b32 v3, 16, v3
    v_lshlrev_b32 v2, 4, v2
    v_mul_u32_u24 v3, 2880, v3
    v_add_u32 v15, v2, v3
    v_add_u32 v2, 512, v1
    v_mul_u32_u24 v3, 1821, v2
    v_lshrrev_b32 v3, 16, v3
    v_lshlrev_b32 v2, 4, v2
    v_mul_u32_u24 v3, 2880, v3
    v_add_u32 v16, v2, v3
    s_waitcnt lgkmcnt(0)
    s_mov_b32 s32, s10
    s_mov_b32 s33, s11
    s_mov_b32 s34, 1990656
    s_mov_b32 s35, 0x20000
    s_add_u32 s36, s28, 1048576
    s_addc_u32 s37, s29, 0
    s_mov_b32 s38, 1990656
    s_mov_b32 s39, 0x20000
    s_add_u32 m0, s68, 0
    s_nop 0
    buffer_load_dwordx4 v8, s[32:35], s5 offen lds
    s_add_u32 m0, s68, 1024
    s_nop 0
    buffer_load_dwordx4 v9, s[32:35], s5 offen lds
    s_add_u32 m0, s68, 2048
    s_nop 0
    buffer_load_dwordx4 v10, s[32:35], s5 offen lds
    s_add_u32 m0, s68, 3072
    s_nop 0
    buffer_load_dwordx4 v11, s[32:35], s5 offen lds
    s_add_u32 m0, s68, 4096
    s_nop 0
    buffer_load_dwordx4 v12, s[32:35], s5 offen lds
    s_add_u32 m0, s68, 5120
    s_nop 0
    buffer_load_dwordx4 v13, s[32:35], s5 offen lds
    s_add_u32 m0, s68, 6144
    s_nop 0
    buffer_load_dwordx4 v14, s[32:35], s5 offen lds
    s_add_u32 m0, s68, 7168
    s_nop 0
    buffer_load_dwordx4 v15, s[32:35], s5 offen lds
    s_add_u32 m0, s68, 8192
    s_nop 0
    buffer_load_dwordx4 v16, s[32:35], s5 offen lds
    s_mov_b32 s44, s8
    s_mov_b32 s45, s9
    s_mov_b32 s46, 2359296
    s_mov_b32 s47, 0x20000
    buffer_load_dwordx4 v[28:31], v27, s[44:47], s65 offen offset:0
    buffer_load_dwordx4 v[32:35], v27, s[44:47], s65 offen offset:1152
    buffer_load_dwordx4 v[36:39], v27, s[44:47], s65 offen offset:2304
    buffer_load_dwordx4 v[40:43], v27, s[44:47], s65 offen offset:3456
    buffer_load_dwordx4 v[44:47], v27, s[44:47], s66 offen offset:0
    buffer_load_dwordx4 v[48:51], v27, s[44:47], s66 offen offset:1152
    buffer_load_dwordx4 v[52:55], v27, s[44:47], s66 offen offset:2304
    buffer_load_dwordx4 v[56:59], v27, s[44:47], s66 offen offset:3456
    buffer_load_dwordx4 v[60:63], v26, s[44:47], s65 offen offset:1024
    s_mov_b32 s44, s26
    s_mov_b32 s45, s27
    s_mov_b32 s46, 256
    s_mov_b32 s47, 0x20000
    s_barrier
    v_lshrrev_b32 v4, 4, v1
    v_bfe_u32 v5, v1, 2, 2
    v_and_b32 v6, 3, v1
    v_lshrrev_b32 v7, 1, v4
    v_lshl_add_u32 v5, v7, 3, v5
    v_mul_u32_u24 v5, 576, v5
    v_add_u32 v5, s68, v5
    v_and_b32 v4, 1, v4
    v_lshl_add_u32 v7, v4, 2, v6
    v_mul_u32_u24 v7, 72, v7
    v_add_u32 v7, v7, v5
    v_mul_u32_u24 v4, 40, v4
    v_add_u32 v5, v5, v4
    v_and_b32 v4, 1, v6
    v_lshrrev_b32 v6, 1, v6
    v_lshl_add_u32 v6, v4, 1, v6
    v_lshl_add_u32 v5, v6, 3, v5
    s_lshr_b32 s5, s3, 1
    s_mul_i32 s5, s5, 18
    s_and_b32 s3, s3, 1
    s_add_u32 s7, s5, s3
    s_add_u32 s7, s7, 16
    s_lshl_b32 s3, s3, 3
    s_add_u32 s5, s5, s3
    s_mul_i32 s5, s5, 36
    s_add_u32 s5, s5, s4
    s_lshl_b32 s5, s5, 10
    s_mul_i32 s7, s7, 36
    s_add_u32 s7, s7, s4
    s_lshl_b32 s7, s7, 10
    s_waitcnt vmcnt(9)
    ds_read_b64_tr_b16 v[64:65], v5 offset:0
    ds_read_b64_tr_b16 v[66:67], v5 offset:2304
    ds_read_b64_tr_b16 v[68:69], v5 offset:72
    ds_read_b64_tr_b16 v[70:71], v5 offset:2376
    ds_read_b64_tr_b16 v[72:73], v5 offset:144
    ds_read_b64_tr_b16 v[74:75], v5 offset:2448
    ds_read_b64_tr_b16 v[76:77], v5 offset:216
    ds_read_b64_tr_b16 v[78:79], v5 offset:2520
    ds_read_b64_tr_b16 v[80:81], v5 offset:288
    ds_read_b64_tr_b16 v[82:83], v5 offset:2592
    ds_read_b64_tr_b16 v[84:85], v5 offset:360
    ds_read_b64_tr_b16 v[86:87], v5 offset:2664
    s_waitcnt lgkmcnt(4)
    ds_read_b64_tr_b16 v[88:89], v5 offset:432
    ds_read_b64_tr_b16 v[90:91], v5 offset:2736
    ds_read_b64_tr_b16 v[92:93], v5 offset:504
    ds_read_b64_tr_b16 v[94:95], v5 offset:2808
    ds_read_b64_tr_b16 v[96:97], v7 offset:32
    ds_read_b64_tr_b16 v[98:99], v7 offset:2336
    buffer_store_dwordx4 v[64:67], v27, s[36:39], s5 offen sc1
    s_add_u32 s5, s5, 36864
    buffer_store_dwordx4 v[68:71], v27, s[36:39], s5 offen sc1
    s_add_u32 s5, s5, 36864
    buffer_store_dwordx4 v[72:75], v27, s[36:39], s5 offen sc1
    s_add_u32 s5, s5, 36864
    buffer_store_dwordx4 v[76:79], v27, s[36:39], s5 offen sc1
    s_add_u32 s5, s5, 36864
    s_waitcnt lgkmcnt(0)
    buffer_store_dwordx4 v[80:83], v27, s[36:39], s5 offen sc1
    s_add_u32 s5, s5, 36864
    buffer_store_dwordx4 v[84:87], v27, s[36:39], s5 offen sc1
    s_add_u32 s5, s5, 36864
    buffer_store_dwordx4 v[88:91], v27, s[36:39], s5 offen sc1
    s_add_u32 s5, s5, 36864
    buffer_store_dwordx4 v[92:95], v27, s[36:39], s5 offen sc1
    s_add_u32 s5, s5, 36864
    buffer_store_dwordx4 v[96:99], v27, s[36:39], s7 offen sc1
    v_mov_b32 v12, 1
    s_mov_b32 s31, 0
    s_mov_b32 s7, 53
    s_mov_b64 exec, 1
    s_waitcnt vmcnt(0)
    ds_add_rtn_u32 v13, v23, v12 offset:4
    s_waitcnt lgkmcnt(0)
    v_readfirstlane_b32 s30, v13
    s_nop 0
    s_cmp_lg_u32 s30, 3
    s_cbranch_scc1 KF_S0
KF_FL:
    s_mov_b64 exec, 1
    v_mov_b32 v13, 1
    s_add_u32 s72, s28, 229376
    s_addc_u32 s73, s29, 0
    s_mov_b32 s74, 4096
    s_mov_b32 s75, 0x20000
    s_waitcnt vmcnt(0)
    buffer_atomic_add v13, v27, s[44:47], s31 offen sc0 sc1
    s_waitcnt vmcnt(0)
    v_readfirstlane_b32 s30, v13
    s_nop 0
    s_cmp_lg_u32 s30, s7
    s_cbranch_scc1 KF_S0
    s_mov_b64 exec, -1
    s_mov_b64 exec, -1
    v_mov_b32 v12, 1
    v_lshlrev_b32 v14, 7, v1
    buffer_atomic_add v12, v14, s[72:75], s31 offen sc1
    v_add_u32 v14, 8192, v14
    s_mov_b64 exec, 1
    s_mov_b64 exec, 1
    buffer_store_dword v12, v27, s[44:47], s31 offen offset:128 sc1
    s_mov_b64 exec, -1
    s_branch KF_S
KF_W:
    s_sub_u32 s3, s2, 108
    s_cmp_ge_u32 s3, 18
    s_cbranch_scc1 KF_N
    s_mul_i32 s7, s6, 18
    s_add_u32 s7, s7, s3
    s_mul_i32 s7, s7, 9216
    s_mul_i32 s5, s3, 41472
    s_mul_i32 s4, s3, 331776
    s_sub_u32 s4, s4, 5289984
    s_cmp_ge_u32 s3, 16
    s_cselect_b32 s5, s4, s5
    s_cselect_b32 s3, 2, 4
    s_cselect_b32 s4, 32, 4
    s_mul_i32 s4, s4, 1152
    s_mul_i32 s31, s6, 288
    s_add_u32 s5, s5, s31
    v_add_u32 v2, 0, v1
    v_mul_u32_u24 v3, 3641, v2
    v_lshrrev_b32 v3, 16, v3
    v_lshlrev_b32 v2, 4, v2
    v_lshrrev_b32 v4, s3, v3
    v_mul_u32_u24 v3, 864, v3
    v_mul_u32_u24 v4, s4, v4
    v_add3_u32 v8, v2, v3, v4
    v_add_u32 v2, 64, v1
    v_mul_u32_u24 v3, 3641, v2
    v_lshrrev_b32 v3, 16, v3
    v_lshlrev_b32 v2, 4, v2
    v_lshrrev_b32 v4, s3, v3
    v_mul_u32_u24 v3, 864, v3
    v_mul_u32_u24 v4, s4, v4
    v_add3_u32 v9, v2, v3, v4
    v_add_u32 v2, 128, v1
    v_mul_u32_u24 v3, 3641, v2
    v_lshrrev_b32 v3, 16, v3
    v_lshlrev_b32 v2, 4, v2
    v_lshrrev_b32 v4, s3, v3
    v_mul_u32_u24 v3, 864, v3
    v_mul_u32_u24 v4, s4, v4
    v_add3_u32 v10, v2, v3, v4
    v_add_u32 v2, 192, v1
    v_mul_u32_u24 v3, 3641, v2
    v_lshrrev_b32 v3, 16, v3
    v_lshlrev_b32 v2, 4, v2
    v_lshrrev_b32 v4, s3, v3
    v_mul_u32_u24 v3, 864, v3
    v_mul_u32_u24 v4, s4, v4
    v_add3_u32 v11, v2, v3, v4
    v_add_u32 v2, 256, v1
    v_mul_u32_u24 v3, 3641, v2
    v_lshrrev_b32 v3, 16, v3
    v_lshlrev_b32 v2, 4, v2
    v_lshrrev_b32 v4, s3, v3
    v_mul_u32_u24 v3, 864, v3
    v_mul_u32_u24 v4, s4, v4
    v_add3_u32 v12, v2, v3, v4
    v_add_u32 v2, 320, v1
    v_mul_u32_u24 v3, 3641, v2
    v_lshrrev_b32 v3, 16, v3
    v_lshlrev_b32 v2, 4, v2
    v_lshrrev_b32 v4, s3, v3
    v_mul_u32_u24 v3, 864, v3
    v_mul_u32_u24 v4, s4, v4
    v_add3_u32 v13, v2, v3, v4
    v_add_u32 v2, 384, v1
    v_mul_u32_u24 v3, 3641, v2
    v_lshrrev_b32 v3, 16, v3
    v_lshlrev_b32 v2, 4, v2
    v_lshrrev_b32 v4, s3, v3
    v_mul_u32_u24 v3, 864, v3
    v_mul_u32_u24 v4, s4, v4
    v_add3_u32 v14, v2, v3, v4
    v_add_u32 v2, 448, v1
    v_mul_u32_u24 v3, 3641, v2
    v_lshrrev_b32 v3, 16, v3
    v_lshlrev_b32 v2, 4, v2
    v_lshrrev_b32 v4, s3, v3
    v_mul_u32_u24 v3, 864, v3
    v_mul_u32_u24 v4, s4, v4
    v_add3_u32 v15, v2, v3, v4
    v_add_u32 v2, 512, v1
    v_mul_u32_u24 v3, 3641, v2
    v_lshrrev_b32 v3, 16, v3
    v_lshlrev_b32 v2, 4, v2
    v_lshrrev_b32 v4, s3, v3
    v_mul_u32_u24 v3, 864, v3
    v_mul_u32_u24 v4, s4, v4
    v_add3_u32 v16, v2, v3, v4
    s_waitcnt lgkmcnt(0)
    s_mov_b32 s32, s12
    s_mov_b32 s33, s13
    s_mov_b32 s34, 663552
    s_mov_b32 s35, 0x20000
    s_add_u32 s36, s28, 72351744
    s_addc_u32 s37, s29, 0
    s_mov_b32 s38, 663552
    s_mov_b32 s39, 0x20000
    s_add_u32 m0, s68, 0
    s_nop 0
    buffer_load_dwordx4 v8, s[32:35], s5 offen lds
    s_add_u32 m0, s68, 1024
    s_nop 0
    buffer_load_dwordx4 v9, s[32:35], s5 offen lds
    s_add_u32 m0, s68, 2048
    s_nop 0
    buffer_load_dwordx4 v10, s[32:35], s5 offen lds
    s_add_u32 m0, s68, 3072
    s_nop 0
    buffer_load_dwordx4 v11, s[32:35], s5 offen lds
    s_add_u32 m0, s68, 4096
    s_nop 0
    buffer_load_dwordx4 v12, s[32:35], s5 offen lds
    s_add_u32 m0, s68, 5120
    s_nop 0
    buffer_load_dwordx4 v13, s[32:35], s5 offen lds
    s_add_u32 m0, s68, 6144
    s_nop 0
    buffer_load_dwordx4 v14, s[32:35], s5 offen lds
    s_add_u32 m0, s68, 7168
    s_nop 0
    buffer_load_dwordx4 v15, s[32:35], s5 offen lds
    s_add_u32 m0, s68, 8192
    s_nop 0
    buffer_load_dwordx4 v16, s[32:35], s5 offen lds
    s_mov_b32 s44, s8
    s_mov_b32 s45, s9
    s_mov_b32 s46, 2359296
    s_mov_b32 s47, 0x20000
    buffer_load_dwordx4 v[28:31], v27, s[44:47], s65 offen offset:0
    buffer_load_dwordx4 v[32:35], v27, s[44:47], s65 offen offset:1152
    buffer_load_dwordx4 v[36:39], v27, s[44:47], s65 offen offset:2304
    buffer_load_dwordx4 v[40:43], v27, s[44:47], s65 offen offset:3456
    buffer_load_dwordx4 v[44:47], v27, s[44:47], s66 offen offset:0
    buffer_load_dwordx4 v[48:51], v27, s[44:47], s66 offen offset:1152
    buffer_load_dwordx4 v[52:55], v27, s[44:47], s66 offen offset:2304
    buffer_load_dwordx4 v[56:59], v27, s[44:47], s66 offen offset:3456
    buffer_load_dwordx4 v[60:63], v26, s[44:47], s65 offen offset:1024
    s_mov_b32 s44, s26
    s_mov_b32 s45, s27
    s_mov_b32 s46, 256
    s_mov_b32 s47, 0x20000
    s_barrier
    v_lshrrev_b32 v4, 4, v1
    v_bfe_u32 v5, v1, 2, 2
    v_and_b32 v6, 3, v1
    v_lshl_add_u32 v5, v4, 3, v5
    v_mul_u32_u24 v5, 288, v5
    v_lshl_add_u32 v5, v6, 3, v5
    v_add_u32 v5, s68, v5
    s_waitcnt vmcnt(9)
    ds_read_b64_tr_b16 v[64:65], v5 offset:0
    ds_read_b64_tr_b16 v[66:67], v5 offset:1152
    ds_read_b64_tr_b16 v[68:69], v5 offset:32
    ds_read_b64_tr_b16 v[70:71], v5 offset:1184
    ds_read_b64_tr_b16 v[72:73], v5 offset:64
    ds_read_b64_tr_b16 v[74:75], v5 offset:1216
    ds_read_b64_tr_b16 v[76:77], v5 offset:96
    ds_read_b64_tr_b16 v[78:79], v5 offset:1248
    ds_read_b64_tr_b16 v[80:81], v5 offset:128
    ds_read_b64_tr_b16 v[82:83], v5 offset:1280
    ds_read_b64_tr_b16 v[84:85], v5 offset:160
    ds_read_b64_tr_b16 v[86:87], v5 offset:1312
    s_waitcnt lgkmcnt(4)
    ds_read_b64_tr_b16 v[88:89], v5 offset:192
    ds_read_b64_tr_b16 v[90:91], v5 offset:1344
    ds_read_b64_tr_b16 v[92:93], v5 offset:224
    ds_read_b64_tr_b16 v[94:95], v5 offset:1376
    ds_read_b64_tr_b16 v[96:97], v5 offset:256
    ds_read_b64_tr_b16 v[98:99], v5 offset:1408
    s_waitcnt lgkmcnt(0)
    buffer_store_dwordx4 v[64:67], v27, s[36:39], s7 offen offset:0 sc1
    buffer_store_dwordx4 v[68:71], v27, s[36:39], s7 offen offset:1024 sc1
    buffer_store_dwordx4 v[72:75], v27, s[36:39], s7 offen offset:2048 sc1
    buffer_store_dwordx4 v[76:79], v27, s[36:39], s7 offen offset:3072 sc1
    s_add_u32 s7, s7, 4096
    buffer_store_dwordx4 v[80:83], v27, s[36:39], s7 offen offset:0 sc1
    buffer_store_dwordx4 v[84:87], v27, s[36:39], s7 offen offset:1024 sc1
    buffer_store_dwordx4 v[88:91], v27, s[36:39], s7 offen offset:2048 sc1
    buffer_store_dwordx4 v[92:95], v27, s[36:39], s7 offen offset:3072 sc1
    s_add_u32 s7, s7, 4096
    buffer_store_dwordx4 v[96:99], v27, s[36:39], s7 offen offset:0 sc1
    s_waitcnt vmcnt(9)
    s_branch KF_S
KF_7:
    v_mov_b32 v8, 0
    v_mov_b32 v9, 0
    ds_write_b64 v23, v[8:9]
KF_N:
    s_cmp_lg_u32 s6, 6
    s_cbranch_scc1 KF_N2
    s_getpc_b64 s[40:41]
PC_k1_kernel:
    s_add_u32 s40, s40, k2_kernel-PC_k1_kernel
    s_addc_u32 s41, s41, 0
    s_lshr_b32 s42, s2, 3
    s_lshl_b32 s42, s42, 12
    v_lshlrev_b32 v4, 6, v1
    v_add_u32 v4, s42, v4
    v_mov_b32 v5, CODE_END-k2_kernel
    v_cmp_lt_u32 vcc, v4, v5
    v_mov_b32 v7, s41
    v_add_co_u32 v6, s[44:45], s40, v4
    s_nop 1
    v_addc_co_u32 v7, s[44:45], 0, v7, s[44:45]
    s_and_saveexec_b64 s[42:43], vcc
    s_cbranch_execz PFX_k1_kernel
    global_load_dword v4, v[6:7], off
PFX_k1_kernel:
    s_mov_b64 exec, s[42:43]
KF_N2:
    s_waitcnt lgkmcnt(0)
    s_cmp_lg_u32 s6, 7
    s_cbranch_scc1 KF_N3
    s_add_u32 s72, s28, 229376
    s_addc_u32 s73, s29, 0
    s_mov_b32 s74, 4096
    s_mov_b32 s75, 0x20000
    s_and_b32 s76, s77, 31
    s_lshl_b32 s76, s76, 7
    v_mov_b32 v8, 0
    buffer_load_dwordx2 v[20:21], v8, s[72:75], s76 offen sc1
KF_N3:
    s_mov_b32 s44, s8
    s_mov_b32 s45, s9
    s_mov_b32 s46, 2359296
    s_mov_b32 s47, 0x20000
    buffer_load_dwordx4 v[28:31], v27, s[44:47], s65 offen offset:0
    buffer_load_dwordx4 v[32:35], v27, s[44:47], s65 offen offset:1152
    buffer_load_dwordx4 v[36:39], v27, s[44:47], s65 offen offset:2304
    buffer_load_dwordx4 v[40:43], v27, s[44:47], s65 offen offset:3456
    buffer_load_dwordx4 v[44:47], v27, s[44:47], s66 offen offset:0
    buffer_load_dwordx4 v[48:51], v27, s[44:47], s66 offen offset:1152
    buffer_load_dwordx4 v[52:55], v27, s[44:47], s66 offen offset:2304
    buffer_load_dwordx4 v[56:59], v27, s[44:47], s66 offen offset:3456
    buffer_load_dwordx4 v[60:63], v26, s[44:47], s65 offen offset:1024
    s_mov_b32 s44, s26
    s_mov_b32 s45, s27
    s_mov_b32 s46, 256
    s_mov_b32 s47, 0x20000
    s_barrier
KF_S0:
    s_mov_b64 exec, -1
    s_waitcnt vmcnt(0)
KF_S:
    s_mov_b32 s2, s77
    v_readfirstlane_b32 s70, v20
    v_readfirstlane_b32 s71, v21
    s_mov_b32 s31, 0xffff0000
    v_lshlrev_b32 v136, 16, v28
    v_and_b32 v137, s31, v28
    v_lshlrev_b32 v138, 16, v29
    v_and_b32 v139, s31, v29
    v_lshlrev_b32 v140, 16, v30
    v_and_b32 v141, s31, v30
    v_lshlrev_b32 v142, 16, v31
    v_and_b32 v143, s31, v31
    v_pk_add_f32 v[18:19], v[136:137], v[138:139]
    v_pk_add_f32 v[20:21], v[140:141], v[142:143]
    v_pk_add_f32 v[18:19], v[18:19], v[20:21]
    v_add_f32 v8, v18, v19
    v_lshlrev_b32 v144, 16, v32
    v_and_b32 v145, s31, v32
    v_lshlrev_b32 v146, 16, v33
    v_and_b32 v147, s31, v33
    v_lshlrev_b32 v148, 16, v34
    v_and_b32 v149, s31, v34
    v_lshlrev_b32 v150, 16, v35
    v_and_b32 v151, s31, v35
    v_pk_add_f32 v[18:19], v[144:145], v[146:147]
    v_pk_add_f32 v[20:21], v[148:149], v[150:151]
    v_pk_add_f32 v[18:19], v[18:19], v[20:21]
    v_add_f32 v9, v18, v19
    v_lshlrev_b32 v152, 16, v36
    v_and_b32 v153, s31, v36
    v_lshlrev_b32 v154, 16, v37
    v_and_b32 v155, s31, v37
    v_lshlrev_b32 v156, 16, v38
    v_and_b32 v157, s31, v38
    v_lshlrev_b32 v158, 16, v39
    v_and_b32 v159, s31, v39
    v_pk_add_f32 v[18:19], v[152:153], v[154:155]
    v_pk_add_f32 v[20:21], v[156:157], v[158:159]
    v_pk_add_f32 v[18:19], v[18:19], v[20:21]
    v_add_f32 v10, v18, v19
    v_lshlrev_b32 v160, 16, v40
    v_and_b32 v161, s31, v40
    v_lshlrev_b32 v162, 16, v41
    v_and_b32 v163, s31, v41
    v_lshlrev_b32 v164, 16, v42
    v_and_b32 v165, s31, v42
    v_lshlrev_b32 v166, 16, v43
    v_and_b32 v167, s31, v43
    v_pk_add_f32 v[18:19], v[160:161], v[162:163]
    v_pk_add_f32 v[20:21], v[164:165], v[166:167]
    v_pk_add_f32 v[18:19], v[18:19], v[20:21]
    v_add_f32 v11, v18, v19
    v_lshlrev_b32 v168, 16, v44
    v_and_b32 v169, s31, v44
    v_lshlrev_b32 v170, 16, v45
    v_and_b32 v171, s31, v45
    v_lshlrev_b32 v172, 16, v46
    v_and_b32 v173, s31, v46
    v_lshlrev_b32 v174, 16, v47
    v_and_b32 v175, s31, v47
    v_pk_add_f32 v[18:19], v[168:169], v[170:171]
    v_pk_add_f32 v[20:21], v[172:173], v[174:175]
    v_pk_add_f32 v[18:19], v[18:19], v[20:21]
    v_add_f32 v12, v18, v19
    v_lshlrev_b32 v176, 16, v48
    v_and_b32 v177, s31, v48
    v_lshlrev_b32 v178, 16, v49
    v_and_b32 v179, s31, v49
    v_lshlrev_b32 v180, 16, v50
    v_and_b32 v181, s31, v50
    v_lshlrev_b32 v182, 16, v51
    v_and_b32 v183, s31, v51
    v_pk_add_f32 v[18:19], v[176:177], v[178:179]
    v_pk_add_f32 v[20:21], v[180:181], v[182:183]
    v_pk_add_f32 v[18:19], v[18:19], v[20:21]
    v_add_f32 v13, v18, v19
    v_lshlrev_b32 v184, 16, v52
    v_and_b32 v185, s31, v52
    v_lshlrev_b32 v186, 16, v53
    v_and_b32 v187, s31, v53
    v_lshlrev_b32 v188, 16, v54
    v_and_b32 v189, s31, v54
    v_lshlrev_b32 v190, 16, v55
    v_and_b32 v191, s31, v55
    v_pk_add_f32 v[18:19], v[184:185], v[186:187]
    v_pk_add_f32 v[20:21], v[188:189], v[190:191]
    v_pk_add_f32 v[18:19], v[18:19], v[20:21]
    v_add_f32 v14, v18, v19
    v_lshlrev_b32 v192, 16, v56
    v_and_b32 v193, s31, v56
    v_lshlrev_b32 v194, 16, v57
    v_and_b32 v195, s31, v57
    v_lshlrev_b32 v196, 16, v58
    v_and_b32 v197, s31, v58
    v_lshlrev_b32 v198, 16, v59
    v_and_b32 v199, s31, v59
    v_pk_add_f32 v[18:19], v[192:193], v[194:195]
    v_pk_add_f32 v[20:21], v[196:197], v[198:199]
    v_pk_add_f32 v[18:19], v[18:19], v[20:21]
    v_add_f32 v15, v18, v19
    v_lshlrev_b32 v200, 16, v60
    v_and_b32 v201, s31, v60
    v_lshlrev_b32 v202, 16, v61
    v_and_b32 v203, s31, v61
    v_lshlrev_b32 v204, 16, v62
    v_and_b32 v205, s31, v62
    v_lshlrev_b32 v206, 16, v63
    v_and_b32 v207, s31, v63
    v_pk_add_f32 v[18:19], v[200:201], v[202:203]
    v_pk_add_f32 v[20:21], v[204:205], v[206:207]
    v_pk_add_f32 v[18:19], v[18:19], v[20:21]
    v_add_f32 v16, v18, v19
    v_permlane32_swap_b32 v8, v12
    v_permlane32_swap_b32 v9, v13
    v_permlane32_swap_b32 v10, v14
    v_permlane32_swap_b32 v11, v15
    v_add_f32 v8, v8, v12
    v_add_f32 v9, v9, v13
    v_add_f32 v10, v10, v14
    v_add_f32 v11, v11, v15
    s_nop 0
    v_permlane16_swap_b32 v8, v10
    v_permlane16_swap_b32 v9, v11
    v_add_f32 v8, v8, v10
    v_add_f32 v9, v9, v11
    s_nop 0
    v_add_f32_dpp v8, v8, v8 row_ror:8 row_mask:0xf bank_mask:0xf
    s_nop 1
    v_add_f32_dpp v8, v9, v9 row_ror:8 row_mask:0xf bank_mask:0xc
    v_add_f32 v8, v8, v16
    s_nop 1
    v_add_f32_dpp v8, v8, v8 quad_perm:[1,0,3,2] row_mask:0xf bank_mask:0xf
    s_nop 1
    v_add_f32_dpp v8, v8, v8 quad_perm:[2,3,0,1] row_mask:0xf bank_mask:0xf
    s_nop 1
    v_add_f32_dpp v8, v8, v8 row_half_mirror row_mask:0xf bank_mask:0xf
    v_mul_f32 v8, 3135475257, v8
    s_nop 0
    v_readlane_b32 s8, v8, 0
    v_readlane_b32 s10, v8, 8
    v_readlane_b32 s12, v8, 16
    v_readlane_b32 s14, v8, 24
    v_readlane_b32 s16, v8, 32
    v_readlane_b32 s18, v8, 40
    v_readlane_b32 s20, v8, 48
    v_readlane_b32 s22, v8, 56
    v_pk_add_f32 v[200:201], v[200:201], v[8:9] op_sel_hi:[1,0]
    v_pk_add_f32 v[202:203], v[202:203], v[8:9] op_sel_hi:[1,0]
    v_pk_add_f32 v[204:205], v[204:205], v[8:9] op_sel_hi:[1,0]
    v_pk_add_f32 v[206:207], v[206:207], v[8:9] op_sel_hi:[1,0]
    v_pk_add_f32 v[136:137], v[136:137], s[8:9] op_sel_hi:[1,0]
    v_pk_add_f32 v[138:139], v[138:139], s[8:9] op_sel_hi:[1,0]
    v_pk_add_f32 v[140:141], v[140:141], s[8:9] op_sel_hi:[1,0]
    v_pk_add_f32 v[142:143], v[142:143], s[8:9] op_sel_hi:[1,0]
    v_pk_add_f32 v[144:145], v[144:145], s[10:11] op_sel_hi:[1,0]
    v_pk_add_f32 v[146:147], v[146:147], s[10:11] op_sel_hi:[1,0]
    v_pk_add_f32 v[148:149], v[148:149], s[10:11] op_sel_hi:[1,0]
    v_pk_add_f32 v[150:151], v[150:151], s[10:11] op_sel_hi:[1,0]
    v_pk_add_f32 v[152:153], v[152:153], s[12:13] op_sel_hi:[1,0]
    v_pk_add_f32 v[154:155], v[154:155], s[12:13] op_sel_hi:[1,0]
    v_pk_add_f32 v[156:157], v[156:157], s[12:13] op_sel_hi:[1,0]
    v_pk_add_f32 v[158:159], v[158:159], s[12:13] op_sel_hi:[1,0]
    v_pk_add_f32 v[160:161], v[160:161], s[14:15] op_sel_hi:[1,0]
    v_pk_add_f32 v[162:163], v[162:163], s[14:15] op_sel_hi:[1,0]
    v_pk_add_f32 v[164:165], v[164:165], s[14:15] op_sel_hi:[1,0]
    v_pk_add_f32 v[166:167], v[166:167], s[14:15] op_sel_hi:[1,0]
    v_pk_add_f32 v[168:169], v[168:169], s[16:17] op_sel_hi:[1,0]
    v_pk_add_f32 v[170:171], v[170:171], s[16:17] op_sel_hi:[1,0]
    v_pk_add_f32 v[172:173], v[172:173], s[16:17] op_sel_hi:[1,0]
    v_pk_add_f32 v[174:175], v[174:175], s[16:17] op_sel_hi:[1,0]
    v_pk_add_f32 v[176:177], v[176:177], s[18:19] op_sel_hi:[1,0]
    v_pk_add_f32 v[178:179], v[178:179], s[18:19] op_sel_hi:[1,0]
    v_pk_add_f32 v[180:181], v[180:181], s[18:19] op_sel_hi:[1,0]
    v_pk_add_f32 v[182:183], v[182:183], s[18:19] op_sel_hi:[1,0]
    v_pk_add_f32 v[184:185], v[184:185], s[20:21] op_sel_hi:[1,0]
    v_pk_add_f32 v[186:187], v[186:187], s[20:21] op_sel_hi:[1,0]
    v_pk_add_f32 v[188:189], v[188:189], s[20:21] op_sel_hi:[1,0]
    v_pk_add_f32 v[190:191], v[190:191], s[20:21] op_sel_hi:[1,0]
    v_pk_add_f32 v[192:193], v[192:193], s[22:23] op_sel_hi:[1,0]
    v_pk_add_f32 v[194:195], v[194:195], s[22:23] op_sel_hi:[1,0]
    v_pk_add_f32 v[196:197], v[196:197], s[22:23] op_sel_hi:[1,0]
    v_pk_add_f32 v[198:199], v[198:199], s[22:23] op_sel_hi:[1,0]
    v_pk_mul_f32 v[18:19], v[136:137], v[136:137]
    v_pk_fma_f32 v[18:19], v[138:139], v[138:139], v[18:19]
    v_pk_fma_f32 v[18:19], v[140:141], v[140:141], v[18:19]
    v_pk_fma_f32 v[18:19], v[142:143], v[142:143], v[18:19]
    v_add_f32 v8, v18, v19
    v_pk_mul_f32 v[18:19], v[144:145], v[144:145]
    v_pk_fma_f32 v[18:19], v[146:147], v[146:147], v[18:19]
    v_pk_fma_f32 v[18:19], v[148:149], v[148:149], v[18:19]
    v_pk_fma_f32 v[18:19], v[150:151], v[150:151], v[18:19]
    v_add_f32 v9, v18, v19
    v_pk_mul_f32 v[18:19], v[152:153], v[152:153]
    v_pk_fma_f32 v[18:19], v[154:155], v[154:155], v[18:19]
    v_pk_fma_f32 v[18:19], v[156:157], v[156:157], v[18:19]
    v_pk_fma_f32 v[18:19], v[158:159], v[158:159], v[18:19]
    v_add_f32 v10, v18, v19
    v_pk_mul_f32 v[18:19], v[160:161], v[160:161]
    v_pk_fma_f32 v[18:19], v[162:163], v[162:163], v[18:19]
    v_pk_fma_f32 v[18:19], v[164:165], v[164:165], v[18:19]
    v_pk_fma_f32 v[18:19], v[166:167], v[166:167], v[18:19]
    v_add_f32 v11, v18, v19
    v_pk_mul_f32 v[18:19], v[168:169], v[168:169]
    v_pk_fma_f32 v[18:19], v[170:171], v[170:171], v[18:19]
    v_pk_fma_f32 v[18:19], v[172:173], v[172:173], v[18:19]
    v_pk_fma_f32 v[18:19], v[174:175], v[174:175], v[18:19]
    v_add_f32 v12, v18, v19
    v_pk_mul_f32 v[18:19], v[176:177], v[176:177]
    v_pk_fma_f32 v[18:19], v[178:179], v[178:179], v[18:19]
    v_pk_fma_f32 v[18:19], v[180:181], v[180:181], v[18:19]
    v_pk_fma_f32 v[18:19], v[182:183], v[182:183], v[18:19]
    v_add_f32 v13, v18, v19
    v_pk_mul_f32 v[18:19], v[184:185], v[184:185]
    v_pk_fma_f32 v[18:19], v[186:187], v[186:187], v[18:19]
    v_pk_fma_f32 v[18:19], v[188:189], v[188:189], v[18:19]
    v_pk_fma_f32 v[18:19], v[190:191], v[190:191], v[18:19]
    v_add_f32 v14, v18, v19
    v_pk_mul_f32 v[18:19], v[192:193], v[192:193]
    v_pk_fma_f32 v[18:19], v[194:195], v[194:195], v[18:19]
    v_pk_fma_f32 v[18:19], v[196:197], v[196:197], v[18:19]
    v_pk_fma_f32 v[18:19], v[198:199], v[198:199], v[18:19]
    v_add_f32 v15, v18, v19
    v_pk_mul_f32 v[18:19], v[200:201], v[200:201]
    v_pk_fma_f32 v[18:19], v[202:203], v[202:203], v[18:19]
    v_pk_fma_f32 v[18:19], v[204:205], v[204:205], v[18:19]
    v_pk_fma_f32 v[18:19], v[206:207], v[206:207], v[18:19]
    v_add_f32 v16, v18, v19
    v_permlane32_swap_b32 v8, v12
    v_permlane32_swap_b32 v9, v13
    v_permlane32_swap_b32 v10, v14
    v_permlane32_swap_b32 v11, v15
    v_add_f32 v8, v8, v12
    v_add_f32 v9, v9, v13
    v_add_f32 v10, v10, v14
    v_add_f32 v11, v11, v15
    s_nop 0
    v_permlane16_swap_b32 v8, v10
    v_permlane16_swap_b32 v9, v11
    v_add_f32 v8, v8, v10
    v_add_f32 v9, v9, v11
    s_nop 0
    v_add_f32_dpp v8, v8, v8 row_ror:8 row_mask:0xf bank_mask:0xf
    s_nop 1
    v_add_f32_dpp v8, v9, v9 row_ror:8 row_mask:0xf bank_mask:0xc
    v_add_f32 v8, v8, v16
    s_nop 1
    v_add_f32_dpp v8, v8, v8 quad_perm:[1,0,3,2] row_mask:0xf bank_mask:0xf
    s_nop 1
    v_add_f32_dpp v8, v8, v8 quad_perm:[2,3,0,1] row_mask:0xf bank_mask:0xf
    s_nop 1
    v_add_f32_dpp v8, v8, v8 row_half_mirror row_mask:0xf bank_mask:0xf
    v_mov_b32 v9, 925353388
    v_fmac_f32 v9, 987991609, v8
    v_rsq_f32 v8, v9
    s_nop 0
    v_readlane_b32 s8, v8, 0
    v_readlane_b32 s10, v8, 8
    v_readlane_b32 s12, v8, 16
    v_readlane_b32 s14, v8, 24
    v_readlane_b32 s16, v8, 32
    v_readlane_b32 s18, v8, 40
    v_readlane_b32 s20, v8, 48
    v_readlane_b32 s22, v8, 56
    v_pk_mul_f32 v[200:201], v[200:201], v[8:9] op_sel_hi:[1,0]
    v_pk_mul_f32 v[202:203], v[202:203], v[8:9] op_sel_hi:[1,0]
    v_pk_mul_f32 v[204:205], v[204:205], v[8:9] op_sel_hi:[1,0]
    v_pk_mul_f32 v[206:207], v[206:207], v[8:9] op_sel_hi:[1,0]
    v_pk_mul_f32 v[136:137], v[136:137], s[8:9] op_sel_hi:[1,0]
    v_pk_mul_f32 v[138:139], v[138:139], s[8:9] op_sel_hi:[1,0]
    v_pk_mul_f32 v[140:141], v[140:141], s[8:9] op_sel_hi:[1,0]
    v_pk_mul_f32 v[142:143], v[142:143], s[8:9] op_sel_hi:[1,0]
    v_pk_mul_f32 v[144:145], v[144:145], s[10:11] op_sel_hi:[1,0]
    v_pk_mul_f32 v[146:147], v[146:147], s[10:11] op_sel_hi:[1,0]
    v_pk_mul_f32 v[148:149], v[148:149], s[10:11] op_sel_hi:[1,0]
    v_pk_mul_f32 v[150:151], v[150:151], s[10:11] op_sel_hi:[1,0]
    v_pk_mul_f32 v[152:153], v[152:153], s[12:13] op_sel_hi:[1,0]
    v_pk_mul_f32 v[154:155], v[154:155], s[12:13] op_sel_hi:[1,0]
    v_pk_mul_f32 v[156:157], v[156:157], s[12:13] op_sel_hi:[1,0]
    v_pk_mul_f32 v[158:159], v[158:159], s[12:13] op_sel_hi:[1,0]
    v_pk_mul_f32 v[160:161], v[160:161], s[14:15] op_sel_hi:[1,0]
    v_pk_mul_f32 v[162:163], v[162:163], s[14:15] op_sel_hi:[1,0]
    v_pk_mul_f32 v[164:165], v[164:165], s[14:15] op_sel_hi:[1,0]
    v_pk_mul_f32 v[166:167], v[166:167], s[14:15] op_sel_hi:[1,0]
    v_pk_mul_f32 v[168:169], v[168:169], s[16:17] op_sel_hi:[1,0]
    v_pk_mul_f32 v[170:171], v[170:171], s[16:17] op_sel_hi:[1,0]
    v_pk_mul_f32 v[172:173], v[172:173], s[16:17] op_sel_hi:[1,0]
    v_pk_mul_f32 v[174:175], v[174:175], s[16:17] op_sel_hi:[1,0]
    v_pk_mul_f32 v[176:177], v[176:177], s[18:19] op_sel_hi:[1,0]
    v_pk_mul_f32 v[178:179], v[178:179], s[18:19] op_sel_hi:[1,0]
    v_pk_mul_f32 v[180:181], v[180:181], s[18:19] op_sel_hi:[1,0]
    v_pk_mul_f32 v[182:183], v[182:183], s[18:19] op_sel_hi:[1,0]
    v_pk_mul_f32 v[184:185], v[184:185], s[20:21] op_sel_hi:[1,0]
    v_pk_mul_f32 v[186:187], v[186:187], s[20:21] op_sel_hi:[1,0]
    v_pk_mul_f32 v[188:189], v[188:189], s[20:21] op_sel_hi:[1,0]
    v_pk_mul_f32 v[190:191], v[190:191], s[20:21] op_sel_hi:[1,0]
    v_pk_mul_f32 v[192:193], v[192:193], s[22:23] op_sel_hi:[1,0]
    v_pk_mul_f32 v[194:195], v[194:195], s[22:23] op_sel_hi:[1,0]
    v_pk_mul_f32 v[196:197], v[196:197], s[22:23] op_sel_hi:[1,0]
    v_pk_mul_f32 v[198:199], v[198:199], s[22:23] op_sel_hi:[1,0]
    s_and_b32 s3, s2, 3
    s_lshl_b32 s3, s3, 1
    s_bfe_u32 s30, s2, 0x10003
    s_add_u32 s3, s3, s30
    s_nop 0
    s_mul_i32 s3, s3, 7
    s_add_u32 s3, s3, s6
    s_cmp_eq_u32 s6, 7
    s_cselect_b32 s3, 60, s3
    s_mul_i32 s30, s3, 36864
    s_and_b32 s5, s64, 3
    v_mov_b32 v7, v27
    s_add_u32 s48, s28, 1048576
    s_addc_u32 s49, s29, 0
    s_mov_b32 s50, 1990656
    s_mov_b32 s51, 0x20000
    s_add_u32 s52, s28, 4194304
    s_addc_u32 s53, s29, 0
    s_mov_b32 s54, 10223616
    s_mov_b32 s55, 0x20000
    s_add_u32 s7, s5, 0
    s_and_b32 s7, s7, 3
    s_mul_i32 s56, s7, 9216
    s_add_u32 s56, s56, s30
    s_mul_i32 s60, s7, 18720
    s_add_u32 s7, s5, 1
    s_and_b32 s7, s7, 3
    s_mul_i32 s57, s7, 9216
    s_add_u32 s57, s57, s30
    s_mul_i32 s61, s7, 18720
    s_add_u32 s7, s5, 2
    s_and_b32 s7, s7, 3
    s_mul_i32 s58, s7, 9216
    s_add_u32 s58, s58, s30
    s_mul_i32 s62, s7, 18720
    s_add_u32 s7, s5, 3
    s_and_b32 s7, s7, 3
    s_mul_i32 s59, s7, 9216
    s_add_u32 s59, s59, s30
    s_mul_i32 s63, s7, 18720
    s_lshl_b32 s30, s6, 7
    v_mul_u32_u24 v6, 1040, v1
    v_add_u32 v6, s30, v6
    v_mul_u32_u24 v5, 1040, v24
    v_lshl_add_u32 v5, v25, 4, v5
    s_add_u32 s30, s30, 66560
    v_add_u32 v5, s30, v5
    v_add_u32 v2, 114368, v27
    v_lshlrev_b32 v3, 4, v24
    v_add_u32 v3, 115392, v3
    s_cmp_lg_u32 s6, 7
    s_cbranch_scc1 KF_GO
    v_mov_b32 v8, 0
    v_mov_b32 v9, 128
    v_mov_b32 v10, 0
    v_mov_b32 v11, 0
    s_add_u32 s72, s28, 229376
    s_addc_u32 s73, s29, 0
    s_mov_b32 s74, 4096
    s_mov_b32 s75, 0x20000
    s_and_b32 s76, s2, 31
    s_lshl_b32 s76, s76, 7
KF_PP:
    buffer_load_dwordx2 v[20:21], v8, s[72:75], s76 offen sc1
    s_sub_u32 s69, s69, 1
    s_cselect_b32 s7, 1, 0
    s_and_b32 s30, s69, 7
    s_cbranch_scc1 KF_PQ
    buffer_load_dwordx2 v[10:11], v9, s[44:47], 0 offen sc1
KF_PQ:
    s_waitcnt vmcnt(0)
    v_subrev_u32 v20, s70, v20
    v_subrev_u32 v21, s71, v21
    v_or3_b32 v20, v20, s7, v10
    v_or3_b32 v21, v21, s7, v11
    ds_write_b32 v23, v20
    v_min_u32 v21, v20, v21
    s_nop 0
    v_readfirstlane_b32 s30, v21
    s_nop 0
    s_cmp_lg_u32 s30, 0
    s_cbranch_scc1 KF_PX
    s_sleep 1
    s_branch KF_PP
KF_PX:
    s_add_u32 s32, s28, 81920
    s_addc_u32 s33, s29, 0
    s_mov_b32 s34, 6912
    s_mov_b32 s35, 0x20000
    buffer_load_dwordx4 v[8:11], v27, s[32:35], 0 offen offset:0 sc1
    buffer_load_dwordx4 v[12:15], v27, s[32:35], 0 offen offset:1024 sc1
    buffer_load_dwordx4 v[16:19], v27, s[32:35], 0 offen offset:2048 sc1
    s_waitcnt vmcnt(2)
    ds_write_b128 v2, v[8:11] offset:0
    s_waitcnt vmcnt(1)
    ds_write_b128 v2, v[12:15] offset:1024
    s_waitcnt vmcnt(0)
    ds_write_b128 v2, v[16:19] offset:2048
    s_waitcnt lgkmcnt(0)
    s_branch KF_B
KF_GO:
    ds_read_b32 v22, v23
    s_waitcnt lgkmcnt(0)
    v_readfirstlane_b32 s30, v22
    s_nop 0
    s_cmp_lg_u32 s30, 0
    s_cbranch_scc1 KF_GO_X
    s_sleep 1
    s_branch KF_GO
KF_GO_X:
KF_B:
    buffer_load_dwordx4 v[64:67], v7, s[48:51], s56 offen offset:0 sc1
    buffer_load_dwordx4 v[68:71], v7, s[48:51], s56 offen offset:1024 sc1
    buffer_load_dwordx4 v[72:75], v7, s[48:51], s56 offen offset:2048 sc1
    buffer_load_dwordx4 v[76:79], v7, s[48:51], s56 offen offset:3072 sc1
    s_add_u32 s56, s56, 4096
    buffer_load_dwordx4 v[80:83], v7, s[48:51], s56 offen offset:0 sc1
    buffer_load_dwordx4 v[84:87], v7, s[48:51], s56 offen offset:1024 sc1
    buffer_load_dwordx4 v[88:91], v7, s[48:51], s56 offen offset:2048 sc1
    buffer_load_dwordx4 v[92:95], v7, s[48:51], s56 offen offset:3072 sc1
    s_barrier
    ds_read_b128 v[224:227], v2
    ds_read_b128 v[228:231], v2 offset:1152
    ds_read_b128 v[232:235], v3
    ds_read_b128 v[236:239], v3 offset:1152
    s_waitcnt lgkmcnt(2)
    v_lshlrev_b32 v8, 16, v224
    v_and_b32 v9, s31, v224
    v_lshlrev_b32 v10, 16, v225
    v_and_b32 v11, s31, v225
    v_lshlrev_b32 v12, 16, v226
    v_and_b32 v13, s31, v226
    v_lshlrev_b32 v14, 16, v227
    v_and_b32 v15, s31, v227
    v_lshlrev_b32 v16, 16, v228
    v_and_b32 v17, s31, v228
    v_lshlrev_b32 v18, 16, v229
    v_and_b32 v19, s31, v229
    v_lshlrev_b32 v20, 16, v230
    v_and_b32 v21, s31, v230
    v_lshlrev_b32 v22, 16, v231
    v_and_b32 v23, s31, v231
    v_pk_fma_f32 v[136:137], v[136:137], v[16:17], v[8:9]
    v_pk_fma_f32 v[138:139], v[138:139], v[18:19], v[10:11]
    v_pk_fma_f32 v[140:141], v[140:141], v[20:21], v[12:13]
    v_pk_fma_f32 v[142:143], v[142:143], v[22:23], v[14:15]
    v_cvt_pk_bf16_f32 v28, v136, v137
    v_cvt_pk_bf16_f32 v29, v138, v139
    v_cvt_pk_bf16_f32 v30, v140, v141
    v_cvt_pk_bf16_f32 v31, v142, v143
    ds_write_b128 v6, v[28:31] offset:0
    s_add_u32 s56, s56, 4096
    buffer_load_dwordx4 v[96:99], v7, s[48:51], s56 offen offset:0 sc1
    v_pk_fma_f32 v[144:145], v[144:145], v[16:17], v[8:9]
    v_pk_fma_f32 v[146:147], v[146:147], v[18:19], v[10:11]
    v_pk_fma_f32 v[148:149], v[148:149], v[20:21], v[12:13]
    v_pk_fma_f32 v[150:151], v[150:151], v[22:23], v[14:15]
    v_cvt_pk_bf16_f32 v32, v144, v145
    v_cvt_pk_bf16_f32 v33, v146, v147
    v_cvt_pk_bf16_f32 v34, v148, v149
    v_cvt_pk_bf16_f32 v35, v150, v151
    ds_write_b128 v6, v[32:35] offset:16
    buffer_load_dwordx4 v[100:103], v7, s[48:51], s57 offen offset:0 sc1
    v_pk_fma_f32 v[152:153], v[152:153], v[16:17], v[8:9]
    v_pk_fma_f32 v[154:155], v[154:155], v[18:19], v[10:11]
    v_pk_fma_f32 v[156:157], v[156:157], v[20:21], v[12:13]
    v_pk_fma_f32 v[158:159], v[158:159], v[22:23], v[14:15]
    v_cvt_pk_bf16_f32 v36, v152, v153
    v_cvt_pk_bf16_f32 v37, v154, v155
    v_cvt_pk_bf16_f32 v38, v156, v157
    v_cvt_pk_bf16_f32 v39, v158, v159
    ds_write_b128 v6, v[36:39] offset:32
    buffer_load_dwordx4 v[104:107], v7, s[48:51], s57 offen offset:1024 sc1
    v_pk_fma_f32 v[160:161], v[160:161], v[16:17], v[8:9]
    v_pk_fma_f32 v[162:163], v[162:163], v[18:19], v[10:11]
    v_pk_fma_f32 v[164:165], v[164:165], v[20:21], v[12:13]
    v_pk_fma_f32 v[166:167], v[166:167], v[22:23], v[14:15]
    v_cvt_pk_bf16_f32 v40, v160, v161
    v_cvt_pk_bf16_f32 v41, v162, v163
    v_cvt_pk_bf16_f32 v42, v164, v165
    v_cvt_pk_bf16_f32 v43, v166, v167
    ds_write_b128 v6, v[40:43] offset:48
    buffer_load_dwordx4 v[108:111], v7, s[48:51], s57 offen offset:2048 sc1
    v_pk_fma_f32 v[168:169], v[168:169], v[16:17], v[8:9]
    v_pk_fma_f32 v[170:171], v[170:171], v[18:19], v[10:11]
    v_pk_fma_f32 v[172:173], v[172:173], v[20:21], v[12:13]
    v_pk_fma_f32 v[174:175], v[174:175], v[22:23], v[14:15]
    v_cvt_pk_bf16_f32 v44, v168, v169
    v_cvt_pk_bf16_f32 v45, v170, v171
    v_cvt_pk_bf16_f32 v46, v172, v173
    v_cvt_pk_bf16_f32 v47, v174, v175
    ds_write_b128 v6, v[44:47] offset:64
    buffer_load_dwordx4 v[112:115], v7, s[48:51], s57 offen offset:3072 sc1
    v_pk_fma_f32 v[176:177], v[176:177], v[16:17], v[8:9]
    v_pk_fma_f32 v[178:179], v[178:179], v[18:19], v[10:11]
    v_pk_fma_f32 v[180:181], v[180:181], v[20:21], v[12:13]
    v_pk_fma_f32 v[182:183], v[182:183], v[22:23], v[14:15]
    v_cvt_pk_bf16_f32 v48, v176, v177
    v_cvt_pk_bf16_f32 v49, v178, v179
    v_cvt_pk_bf16_f32 v50, v180, v181
    v_cvt_pk_bf16_f32 v51, v182, v183
    ds_write_b128 v6, v[48:51] offset:80
    s_add_u32 s57, s57, 4096
    buffer_load_dwordx4 v[116:119], v7, s[48:51], s57 offen offset:0 sc1
    v_pk_fma_f32 v[184:185], v[184:185], v[16:17], v[8:9]
    v_pk_fma_f32 v[186:187], v[186:187], v[18:19], v[10:11]
    v_pk_fma_f32 v[188:189], v[188:189], v[20:21], v[12:13]
    v_pk_fma_f32 v[190:191], v[190:191], v[22:23], v[14:15]
    v_cvt_pk_bf16_f32 v52, v184, v185
    v_cvt_pk_bf16_f32 v53, v186, v187
    v_cvt_pk_bf16_f32 v54, v188, v189
    v_cvt_pk_bf16_f32 v55, v190, v191
    ds_write_b128 v6, v[52:55] offset:96
    buffer_load_dwordx4 v[120:123], v7, s[48:51], s57 offen offset:1024 sc1
    v_pk_fma_f32 v[192:193], v[192:193], v[16:17], v[8:9]
    v_pk_fma_f32 v[194:195], v[194:195], v[18:19], v[10:11]
    v_pk_fma_f32 v[196:197], v[196:197], v[20:21], v[12:13]
    v_pk_fma_f32 v[198:199], v[198:199], v[22:23], v[14:15]
    v_cvt_pk_bf16_f32 v56, v192, v193
    v_cvt_pk_bf16_f32 v57, v194, v195
    v_cvt_pk_bf16_f32 v58, v196, v197
    v_cvt_pk_bf16_f32 v59, v198, v199
    ds_write_b128 v6, v[56:59] offset:112
    buffer_load_dwordx4 v[124:127], v7, s[48:51], s57 offen offset:2048 sc1
    s_waitcnt lgkmcnt(8)
    v_lshlrev_b32 v240, 16, v232
    v_and_b32 v241, s31, v232
    v_lshlrev_b32 v242, 16, v233
    v_and_b32 v243, s31, v233
    v_lshlrev_b32 v244, 16, v234
    v_and_b32 v245, s31, v234
    v_lshlrev_b32 v246, 16, v235
    v_and_b32 v247, s31, v235
    v_lshlrev_b32 v248, 16, v236
    v_and_b32 v249, s31, v236
    v_lshlrev_b32 v250, 16, v237
    v_and_b32 v251, s31, v237
    v_lshlrev_b32 v252, 16, v238
    v_and_b32 v253, s31, v238
    v_lshlrev_b32 v254, 16, v239
    v_and_b32 v255, s31, v239
    v_pk_fma_f32 v[200:201], v[200:201], v[248:249], v[240:241]
    v_pk_fma_f32 v[202:203], v[202:203], v[250:251], v[242:243]
    v_pk_fma_f32 v[204:205], v[204:205], v[252:253], v[244:245]
    v_pk_fma_f32 v[206:207], v[206:207], v[254:255], v[246:247]
    v_cvt_pk_bf16_f32 v60, v200, v201
    v_cvt_pk_bf16_f32 v61, v202, v203
    v_cvt_pk_bf16_f32 v62, v204, v205
    v_cvt_pk_bf16_f32 v63, v206, v207
    ds_write_b128 v5, v[60:63]
    buffer_load_dwordx4 v[128:131], v7, s[48:51], s57 offen offset:3072 sc1
    v_lshrrev_b32 v3, 5, v1
    v_and_b32 v4, 31, v1
    v_mul_u32_u24 v5, 1040, v3
    v_lshl_add_u32 v5, v4, 4, v5
    v_add_u32 v8, s60, v5
    v_add_u32 v9, s61, v5
    v_add_u32 v10, s62, v5
    v_add_u32 v11, s63, v5
    s_waitcnt lgkmcnt(0)
    s_barrier
    s_cmp_ge_u32 s3, 54
    s_cbranch_scc1 K1_PF
    ds_read_b128 v[28:31], v8 offset:0
    ds_read_b128 v[32:35], v8 offset:512
    ds_read_b128 v[36:39], v8 offset:2080
    ds_read_b128 v[40:43], v8 offset:2592
    ds_read_b128 v[44:47], v8 offset:4160
    ds_read_b128 v[48:51], v8 offset:4672
    ds_read_b128 v[52:55], v8 offset:6240
    ds_read_b128 v[56:59], v8 offset:6752
    s_waitcnt vmcnt(16) lgkmcnt(6)
    v_mfma_f32_32x32x16_bf16 v[208:223], v[64:67], v[28:31], 0
    s_add_u32 s57, s57, 4096
    buffer_load_dwordx4 v[132:135], v7, s[48:51], s57 offen offset:0 sc1
    v_mfma_f32_32x32x16_bf16 v[224:239], v[64:67], v[32:35], 0
    ds_read_b128 v[28:31], v8 offset:8320
    ds_read_b128 v[32:35], v8 offset:8832
    s_waitcnt vmcnt(16) lgkmcnt(6)
    v_mfma_f32_32x32x16_bf16 v[208:223], v[68:71], v[36:39], v[208:223]
    buffer_load_dwordx4 v[136:139], v7, s[48:51], s58 offen offset:0 sc1
    v_mfma_f32_32x32x16_bf16 v[224:239], v[68:71], v[40:43], v[224:239]
    ds_read_b128 v[36:39], v8 offset:10400
    ds_read_b128 v[40:43], v8 offset:10912
    s_waitcnt vmcnt(16) lgkmcnt(6)
    v_mfma_f32_32x32x16_bf16 v[208:223], v[72:75], v[44:47], v[208:223]
    buffer_load_dwordx4 v[140:143], v7, s[48:51], s58 offen offset:1024 sc1
    v_mfma_f32_32x32x16_bf16 v[224:239], v[72:75], v[48:51], v[224:239]
    ds_read_b128 v[44:47], v8 offset:12480
    ds_read_b128 v[48:51], v8 offset:12992
    s_waitcnt vmcnt(16) lgkmcnt(6)
    v_mfma_f32_32x32x16_bf16 v[208:223], v[76:79], v[52:55], v[208:223]
    buffer_load_dwordx4 v[144:147], v7, s[48:51], s58 offen offset:2048 sc1
    v_mfma_f32_32x32x16_bf16 v[224:239], v[76:79], v[56:59], v[224:239]
    ds_read_b128 v[52:55], v8 offset:14560
    ds_read_b128 v[56:59], v8 offset:15072
    s_waitcnt vmcnt(16) lgkmcnt(6)
    v_mfma_f32_32x32x16_bf16 v[208:223], v[80:83], v[28:31], v[208:223]
    buffer_load_dwordx4 v[148:151], v7, s[48:51], s58 offen offset:3072 sc1
    v_mfma_f32_32x32x16_bf16 v[224:239], v[80:83], v[32:35], v[224:239]
    ds_read_b128 v[28:31], v8 offset:16640
    ds_read_b128 v[32:35], v8 offset:17152
    s_waitcnt vmcnt(16) lgkmcnt(6)
    v_mfma_f32_32x32x16_bf16 v[208:223], v[84:87], v[36:39], v[208:223]
    s_add_u32 s58, s58, 4096
    buffer_load_dwordx4 v[152:155], v7, s[48:51], s58 offen offset:0 sc1
    v_mfma_f32_32x32x16_bf16 v[224:239], v[84:87], v[40:43], v[224:239]
    ds_read_b128 v[36:39], v9 offset:0
    ds_read_b128 v[40:43], v9 offset:512
    s_waitcnt vmcnt(16) lgkmcnt(6)
    v_mfma_f32_32x32x16_bf16 v[208:223], v[88:91], v[44:47], v[208:223]
    buffer_load_dwordx4 v[156:159], v7, s[48:51], s58 offen offset:1024 sc1
    v_mfma_f32_32x32x16_bf16 v[224:239], v[88:91], v[48:51], v[224:239]
    ds_read_b128 v[44:47], v9 offset:2080
    ds_read_b128 v[48:51], v9 offset:2592
    s_waitcnt vmcnt(16) lgkmcnt(6)
    v_mfma_f32_32x32x16_bf16 v[208:223], v[92:95], v[52:55], v[208:223]
    buffer_load_dwordx4 v[160:163], v7, s[48:51], s58 offen offset:2048 sc1
    v_mfma_f32_32x32x16_bf16 v[224:239], v[92:95], v[56:59], v[224:239]
    ds_read_b128 v[52:55], v9 offset:4160
    ds_read_b128 v[56:59], v9 offset:4672
    s_waitcnt vmcnt(16) lgkmcnt(6)
    v_mfma_f32_32x32x16_bf16 v[208:223], v[96:99], v[28:31], v[208:223]
    buffer_load_dwordx4 v[164:167], v7, s[48:51], s58 offen offset:3072 sc1
    v_mfma_f32_32x32x16_bf16 v[224:239], v[96:99], v[32:35], v[224:239]
    ds_read_b128 v[28:31], v9 offset:6240
    ds_read_b128 v[32:35], v9 offset:6752
    s_waitcnt vmcnt(16) lgkmcnt(6)
    v_mfma_f32_32x32x16_bf16 v[208:223], v[100:103], v[36:39], v[208:223]
    s_add_u32 s58, s58, 4096
    buffer_load_dwordx4 v[168:171], v7, s[48:51], s58 offen offset:0 sc1
    v_mfma_f32_32x32x16_bf16 v[224:239], v[100:103], v[40:43], v[224:239]
    ds_read_b128 v[36:39], v9 offset:8320
    ds_read_b128 v[40:43], v9 offset:8832
    s_waitcnt vmcnt(16) lgkmcnt(6)
    v_mfma_f32_32x32x16_bf16 v[208:223], v[104:107], v[44:47], v[208:223]
    buffer_load_dwordx4 v[172:175], v7, s[48:51], s59 offen offset:0 sc1
    v_mfma_f32_32x32x16_bf16 v[224:239], v[104:107], v[48:51], v[224:239]
    ds_read_b128 v[44:47], v9 offset:10400
    ds_read_b128 v[48:51], v9 offset:10912
    s_waitcnt vmcnt(16) lgkmcnt(6)
    v_mfma_f32_32x32x16_bf16 v[208:223], v[108:111], v[52:55], v[208:223]
    buffer_load_dwordx4 v[176:179], v7, s[48:51], s59 offen offset:1024 sc1
    v_mfma_f32_32x32x16_bf16 v[224:239], v[108:111], v[56:59], v[224:239]
    ds_read_b128 v[52:55], v9 offset:12480
    ds_read_b128 v[56:59], v9 offset:12992
    s_waitcnt vmcnt(16) lgkmcnt(6)
    v_mfma_f32_32x32x16_bf16 v[208:223], v[112:115], v[28:31], v[208:223]
    buffer_load_dwordx4 v[180:183], v7, s[48:51], s59 offen offset:2048 sc1
    v_mfma_f32_32x32x16_bf16 v[224:239], v[112:115], v[32:35], v[224:239]
    ds_read_b128 v[28:31], v9 offset:14560
    ds_read_b128 v[32:35], v9 offset:15072
    s_waitcnt vmcnt(16) lgkmcnt(6)
    v_mfma_f32_32x32x16_bf16 v[208:223], v[116:119], v[36:39], v[208:223]
    buffer_load_dwordx4 v[184:187], v7, s[48:51], s59 offen offset:3072 sc1
    v_mfma_f32_32x32x16_bf16 v[224:239], v[116:119], v[40:43], v[224:239]
    ds_read_b128 v[36:39], v9 offset:16640
    ds_read_b128 v[40:43], v9 offset:17152
    s_waitcnt vmcnt(16) lgkmcnt(6)
    v_mfma_f32_32x32x16_bf16 v[208:223], v[120:123], v[44:47], v[208:223]
    s_add_u32 s59, s59, 4096
    buffer_load_dwordx4 v[188:191], v7, s[48:51], s59 offen offset:0 sc1
    v_mfma_f32_32x32x16_bf16 v[224:239], v[120:123], v[48:51], v[224:239]
    ds_read_b128 v[44:47], v10 offset:0
    ds_read_b128 v[48:51], v10 offset:512
    s_waitcnt vmcnt(16) lgkmcnt(6)
    v_mfma_f32_32x32x16_bf16 v[208:223], v[124:127], v[52:55], v[208:223]
    buffer_load_dwordx4 v[192:195], v7, s[48:51], s59 offen offset:1024 sc1
    v_mfma_f32_32x32x16_bf16 v[224:239], v[124:127], v[56:59], v[224:239]
    ds_read_b128 v[52:55], v10 offset:2080
    ds_read_b128 v[56:59], v10 offset:2592
    s_waitcnt vmcnt(16) lgkmcnt(6)
    v_mfma_f32_32x32x16_bf16 v[208:223], v[128:131], v[28:31], v[208:223]
    buffer_load_dwordx4 v[196:199], v7, s[48:51], s59 offen offset:2048 sc1
    v_mfma_f32_32x32x16_bf16 v[224:239], v[128:131], v[32:35], v[224:239]
    ds_read_b128 v[28:31], v10 offset:4160
    ds_read_b128 v[32:35], v10 offset:4672
    s_waitcnt vmcnt(16) lgkmcnt(6)
    v_mfma_f32_32x32x16_bf16 v[208:223], v[132:135], v[36:39], v[208:223]
    buffer_load_dwordx4 v[200:203], v7, s[48:51], s59 offen offset:3072 sc1
    v_mfma_f32_32x32x16_bf16 v[224:239], v[132:135], v[40:43], v[224:239]
    ds_read_b128 v[36:39], v10 offset:6240
    ds_read_b128 v[40:43], v10 offset:6752
    s_waitcnt vmcnt(16) lgkmcnt(6)
    v_mfma_f32_32x32x16_bf16 v[208:223], v[136:139], v[44:47], v[208:223]
    s_add_u32 s59, s59, 4096
    buffer_load_dwordx4 v[204:207], v7, s[48:51], s59 offen offset:0 sc1
    v_mfma_f32_32x32x16_bf16 v[224:239], v[136:139], v[48:51], v[224:239]
    ds_read_b128 v[44:47], v10 offset:8320
    ds_read_b128 v[48:51], v10 offset:8832
    s_waitcnt vmcnt(16) lgkmcnt(6)
    v_mfma_f32_32x32x16_bf16 v[208:223], v[140:143], v[52:55], v[208:223]
    v_mfma_f32_32x32x16_bf16 v[224:239], v[140:143], v[56:59], v[224:239]
    ds_read_b128 v[52:55], v10 offset:10400
    ds_read_b128 v[56:59], v10 offset:10912
    s_waitcnt vmcnt(15) lgkmcnt(6)
    v_mfma_f32_32x32x16_bf16 v[208:223], v[144:147], v[28:31], v[208:223]
    v_mfma_f32_32x32x16_bf16 v[224:239], v[144:147], v[32:35], v[224:239]
    ds_read_b128 v[28:31], v10 offset:12480
    ds_read_b128 v[32:35], v10 offset:12992
    s_waitcnt vmcnt(14) lgkmcnt(6)
    v_mfma_f32_32x32x16_bf16 v[208:223], v[148:151], v[36:39], v[208:223]
    v_mfma_f32_32x32x16_bf16 v[224:239], v[148:151], v[40:43], v[224:239]
    ds_read_b128 v[36:39], v10 offset:14560
    ds_read_b128 v[40:43], v10 offset:15072
    s_waitcnt vmcnt(13) lgkmcnt(6)
    v_mfma_f32_32x32x16_bf16 v[208:223], v[152:155], v[44:47], v[208:223]
    v_mfma_f32_32x32x16_bf16 v[224:239], v[152:155], v[48:51], v[224:239]
    ds_read_b128 v[44:47], v10 offset:16640
    ds_read_b128 v[48:51], v10 offset:17152
    s_waitcnt vmcnt(12) lgkmcnt(6)
    v_mfma_f32_32x32x16_bf16 v[208:223], v[156:159], v[52:55], v[208:223]
    v_mfma_f32_32x32x16_bf16 v[224:239], v[156:159], v[56:59], v[224:239]
    ds_read_b128 v[52:55], v11 offset:0
    ds_read_b128 v[56:59], v11 offset:512
    s_waitcnt vmcnt(11) lgkmcnt(6)
    v_mfma_f32_32x32x16_bf16 v[208:223], v[160:163], v[28:31], v[208:223]
    v_mfma_f32_32x32x16_bf16 v[224:239], v[160:163], v[32:35], v[224:239]
    ds_read_b128 v[28:31], v11 offset:2080
    ds_read_b128 v[32:35], v11 offset:2592
    s_waitcnt vmcnt(10) lgkmcnt(6)
    v_mfma_f32_32x32x16_bf16 v[208:223], v[164:167], v[36:39], v[208:223]
    v_mfma_f32_32x32x16_bf16 v[224:239], v[164:167], v[40:43], v[224:239]
    ds_read_b128 v[36:39], v11 offset:4160
    ds_read_b128 v[40:43], v11 offset:4672
    s_waitcnt vmcnt(9) lgkmcnt(6)
    v_mfma_f32_32x32x16_bf16 v[208:223], v[168:171], v[44:47], v[208:223]
    v_mfma_f32_32x32x16_bf16 v[224:239], v[168:171], v[48:51], v[224:239]
    ds_read_b128 v[44:47], v11 offset:6240
    ds_read_b128 v[48:51], v11 offset:6752
    s_waitcnt vmcnt(8) lgkmcnt(6)
    v_mfma_f32_32x32x16_bf16 v[208:223], v[172:175], v[52:55], v[208:223]
    v_mfma_f32_32x32x16_bf16 v[224:239], v[172:175], v[56:59], v[224:239]
    ds_read_b128 v[52:55], v11 offset:8320
    ds_read_b128 v[56:59], v11 offset:8832
    s_waitcnt vmcnt(7) lgkmcnt(6)
    v_mfma_f32_32x32x16_bf16 v[208:223], v[176:179], v[28:31], v[208:223]
    v_mfma_f32_32x32x16_bf16 v[224:239], v[176:179], v[32:35], v[224:239]
    ds_read_b128 v[28:31], v11 offset:10400
    ds_read_b128 v[32:35], v11 offset:10912
    s_waitcnt vmcnt(6) lgkmcnt(6)
    v_mfma_f32_32x32x16_bf16 v[208:223], v[180:183], v[36:39], v[208:223]
    v_mfma_f32_32x32x16_bf16 v[224:239], v[180:183], v[40:43], v[224:239]
    ds_read_b128 v[36:39], v11 offset:12480
    ds_read_b128 v[40:43], v11 offset:12992
    s_waitcnt vmcnt(5) lgkmcnt(6)
    v_mfma_f32_32x32x16_bf16 v[208:223], v[184:187], v[44:47], v[208:223]
    v_mfma_f32_32x32x16_bf16 v[224:239], v[184:187], v[48:51], v[224:239]
    ds_read_b128 v[44:47], v11 offset:14560
    ds_read_b128 v[48:51], v11 offset:15072
    s_waitcnt vmcnt(4) lgkmcnt(6)
    v_mfma_f32_32x32x16_bf16 v[208:223], v[188:191], v[52:55], v[208:223]
    v_mfma_f32_32x32x16_bf16 v[224:239], v[188:191], v[56:59], v[224:239]
    ds_read_b128 v[52:55], v11 offset:16640
    ds_read_b128 v[56:59], v11 offset:17152
    s_waitcnt vmcnt(3) lgkmcnt(6)
    v_mfma_f32_32x32x16_bf16 v[208:223], v[192:195], v[28:31], v[208:223]
    v_mfma_f32_32x32x16_bf16 v[224:239], v[192:195], v[32:35], v[224:239]
    s_waitcnt vmcnt(2) lgkmcnt(4)
    v_mfma_f32_32x32x16_bf16 v[208:223], v[196:199], v[36:39], v[208:223]
    v_mfma_f32_32x32x16_bf16 v[224:239], v[196:199], v[40:43], v[224:239]
    s_waitcnt vmcnt(1) lgkmcnt(2)
    v_mfma_f32_32x32x16_bf16 v[208:223], v[200:203], v[44:47], v[208:223]
    v_mfma_f32_32x32x16_bf16 v[224:239], v[200:203], v[48:51], v[224:239]
    s_waitcnt vmcnt(0) lgkmcnt(0)
    v_mfma_f32_32x32x16_bf16 v[208:223], v[204:207], v[52:55], v[208:223]
    v_mfma_f32_32x32x16_bf16 v[224:239], v[204:207], v[56:59], v[224:239]
    s_cmp_lt_u32 s3, 18
    s_cselect_b32 s31, 1051597459, 1.0
    s_cselect_b32 s30, 0, 5242880
    s_mul_i32 s5, s64, 4864
    s_add_u32 s30, s30, s5
    s_mul_i32 s5, s3, 3642
    s_lshr_b32 s5, s5, 16
    s_mul_i32 s7, s5, 18
    s_sub_u32 s7, s3, s7
    v_lshrrev_b32 v8, 4, v4
    v_and_b32 v9, 15, v4
    v_mul_u32_u24 v8, 640, v8
    v_add_u32 v8, 1024, v8
    s_cmp_ge_u32 s7, 16
    s_cbranch_scc1 K1_HI
    s_mul_i32 s7, s7, 311296
    s_add_u32 s30, s30, s7
    s_cmp_eq_u32 s5, 2
    s_cselect_b64 vcc, -1, 0
    v_lshl_add_u32 v8, v9, 5, v8
    v_lshl_add_u32 v8, v3, 4, v8
    v_lshlrev_b32 v9, 4, v1
    v_cndmask_b32 v8, v9, v8, vcc
    s_add_u32 s7, s30, 155648
    v_mul_f32 v208, s31, v208
    v_mul_f32 v209, s31, v209
    v_mul_f32 v210, s31, v210
    v_mul_f32 v211, s31, v211
    v_mul_f32 v212, s31, v212
    v_mul_f32 v213, s31, v213
    v_mul_f32 v214, s31, v214
    v_mul_f32 v215, s31, v215
    v_mul_f32 v216, s31, v216
    v_mul_f32 v217, s31, v217
    v_mul_f32 v218, s31, v218
    v_mul_f32 v219, s31, v219
    v_mul_f32 v220, s31, v220
    v_mul_f32 v221, s31, v221
    v_mul_f32 v222, s31, v222
    v_mul_f32 v223, s31, v223
    v_mul_f32 v224, s31, v224
    v_mul_f32 v225, s31, v225
    v_mul_f32 v226, s31, v226
    v_mul_f32 v227, s31, v227
    v_mul_f32 v228, s31, v228
    v_mul_f32 v229, s31, v229
    v_mul_f32 v230, s31, v230
    v_mul_f32 v231, s31, v231
    v_mul_f32 v232, s31, v232
    v_mul_f32 v233, s31, v233
    v_mul_f32 v234, s31, v234
    v_mul_f32 v235, s31, v235
    v_mul_f32 v236, s31, v236
    v_mul_f32 v237, s31, v237
    v_mul_f32 v238, s31, v238
    v_mul_f32 v239, s31, v239
    v_cvt_pk_bf16_f32 v28, v208, v209
    v_cvt_pk_bf16_f32 v29, v210, v211
    v_cvt_pk_bf16_f32 v30, v212, v213
    v_cvt_pk_bf16_f32 v31, v214, v215
    buffer_store_dwordx4 v[28:31], v8, s[52:55], s30 offen offset:0 sc1
    v_cvt_pk_bf16_f32 v32, v216, v217
    v_cvt_pk_bf16_f32 v33, v218, v219
    v_cvt_pk_bf16_f32 v34, v220, v221
    v_cvt_pk_bf16_f32 v35, v222, v223
    buffer_store_dwordx4 v[32:35], v8, s[52:55], s7 offen offset:0 sc1
    v_cvt_pk_bf16_f32 v36, v224, v225
    v_cvt_pk_bf16_f32 v37, v226, v227
    v_cvt_pk_bf16_f32 v38, v228, v229
    v_cvt_pk_bf16_f32 v39, v230, v231
    buffer_store_dwordx4 v[36:39], v8, s[52:55], s30 offen offset:2432 sc1
    v_cvt_pk_bf16_f32 v40, v232, v233
    v_cvt_pk_bf16_f32 v41, v234, v235
    v_cvt_pk_bf16_f32 v42, v236, v237
    v_cvt_pk_bf16_f32 v43, v238, v239
    buffer_store_dwordx4 v[40:43], v8, s[52:55], s7 offen offset:2432 sc1
    s_endpgm
K1_HI:
    s_sub_u32 s7, s7, 16
    s_mul_i32 s7, s7, 2490368
    s_add_u32 s30, s30, s7
    s_mov_b32 s7, 311296
    v_mul_lo_u32 v10, v3, s7
    v_lshl_add_u32 v8, v9, 3, v8
    v_add_u32 v8, v8, v10
    v_lshl_add_u32 v9, v4, 2, v10
    v_mul_f32 v208, s31, v208
    v_mul_f32 v209, s31, v209
    v_mul_f32 v210, s31, v210
    v_mul_f32 v211, s31, v211
    v_mul_f32 v212, s31, v212
    v_mul_f32 v213, s31, v213
    v_mul_f32 v214, s31, v214
    v_mul_f32 v215, s31, v215
    v_mul_f32 v216, s31, v216
    v_mul_f32 v217, s31, v217
    v_mul_f32 v218, s31, v218
    v_mul_f32 v219, s31, v219
    v_mul_f32 v220, s31, v220
    v_mul_f32 v221, s31, v221
    v_mul_f32 v222, s31, v222
    v_mul_f32 v223, s31, v223
    v_mul_f32 v224, s31, v224
    v_mul_f32 v225, s31, v225
    v_mul_f32 v226, s31, v226
    v_mul_f32 v227, s31, v227
    v_mul_f32 v228, s31, v228
    v_mul_f32 v229, s31, v229
    v_mul_f32 v230, s31, v230
    v_mul_f32 v231, s31, v231
    v_mul_f32 v232, s31, v232
    v_mul_f32 v233, s31, v233
    v_mul_f32 v234, s31, v234
    v_mul_f32 v235, s31, v235
    v_mul_f32 v236, s31, v236
    v_mul_f32 v237, s31, v237
    v_mul_f32 v238, s31, v238
    v_mul_f32 v239, s31, v239
    v_cvt_pk_bf16_f32 v28, v208, v209
    v_mov_b32 v29, 0x3f803f80
    v_cvt_pk_bf16_f32 v30, v210, v211
    v_mov_b32 v31, 0x3f803f80
    v_cvt_pk_bf16_f32 v32, v212, v213
    v_mov_b32 v33, 0x3f803f80
    v_cvt_pk_bf16_f32 v34, v214, v215
    v_mov_b32 v35, 0x3f803f80
    v_cvt_pk_bf16_f32 v36, v216, v217
    v_mov_b32 v37, 0x3f803f80
    v_cvt_pk_bf16_f32 v38, v218, v219
    v_mov_b32 v39, 0x3f803f80
    v_cvt_pk_bf16_f32 v40, v220, v221
    v_mov_b32 v41, 0x3f803f80
    v_cvt_pk_bf16_f32 v42, v222, v223
    v_mov_b32 v43, 0x3f803f80
    v_cvt_pk_bf16_f32 v44, v224, v225
    v_mov_b32 v45, 0x3f803f80
    v_cvt_pk_bf16_f32 v46, v226, v227
    v_mov_b32 v47, 0x3f803f80
    v_cvt_pk_bf16_f32 v48, v228, v229
    v_mov_b32 v49, 0x3f803f80
    v_cvt_pk_bf16_f32 v50, v230, v231
    v_mov_b32 v51, 0x3f803f80
    v_cvt_pk_bf16_f32 v52, v232, v233
    v_mov_b32 v53, 0x3f803f80
    v_cvt_pk_bf16_f32 v54, v234, v235
    v_mov_b32 v55, 0x3f803f80
    v_cvt_pk_bf16_f32 v56, v236, v237
    v_mov_b32 v57, 0x3f803f80
    v_cvt_pk_bf16_f32 v58, v238, v239
    v_mov_b32 v59, 0x3f803f80
    s_cmp_eq_u32 s5, 2
    s_cbranch_scc1 K1_HIV
    s_add_u32 s7, s30, 2304
    buffer_store_dword v28, v9, s[52:55], s7 offen offset:0
    buffer_store_dword v44, v9, s[52:55], s7 offen offset:2432
    s_add_u32 s7, s30, 157952
    buffer_store_dword v30, v9, s[52:55], s7 offen offset:0
    buffer_store_dword v46, v9, s[52:55], s7 offen offset:2432
    s_add_u32 s7, s30, 624896
    buffer_store_dword v32, v9, s[52:55], s7 offen offset:0
    buffer_store_dword v48, v9, s[52:55], s7 offen offset:2432
    s_add_u32 s7, s30, 780544
    buffer_store_dword v34, v9, s[52:55], s7 offen offset:0
    buffer_store_dword v50, v9, s[52:55], s7 offen offset:2432
    s_add_u32 s7, s30, 1247488
    buffer_store_dword v36, v9, s[52:55], s7 offen offset:0
    buffer_store_dword v52, v9, s[52:55], s7 offen offset:2432
    s_add_u32 s7, s30, 1403136
    buffer_store_dword v38, v9, s[52:55], s7 offen offset:0
    buffer_store_dword v54, v9, s[52:55], s7 offen offset:2432
    s_add_u32 s7, s30, 1870080
    buffer_store_dword v40, v9, s[52:55], s7 offen offset:0
    buffer_store_dword v56, v9, s[52:55], s7 offen offset:2432
    s_add_u32 s7, s30, 2025728
    buffer_store_dword v42, v9, s[52:55], s7 offen offset:0
    buffer_store_dword v58, v9, s[52:55], s7 offen offset:2432
    s_endpgm
K1_HIV:
    s_add_u32 s7, s30, 0
    buffer_store_dwordx2 v[28:29], v8, s[52:55], s7 offen offset:512
    buffer_store_dwordx2 v[44:45], v8, s[52:55], s7 offen offset:2944
    s_add_u32 s7, s30, 155648
    buffer_store_dwordx2 v[30:31], v8, s[52:55], s7 offen offset:512
    buffer_store_dwordx2 v[46:47], v8, s[52:55], s7 offen offset:2944
    s_add_u32 s7, s30, 622592
    buffer_store_dwordx2 v[32:33], v8, s[52:55], s7 offen offset:512
    buffer_store_dwordx2 v[48:49], v8, s[52:55], s7 offen offset:2944
    s_add_u32 s7, s30, 778240
    buffer_store_dwordx2 v[34:35], v8, s[52:55], s7 offen offset:512
    buffer_store_dwordx2 v[50:51], v8, s[52:55], s7 offen offset:2944
    s_add_u32 s7, s30, 1245184
    buffer_store_dwordx2 v[36:37], v8, s[52:55], s7 offen offset:512
    buffer_store_dwordx2 v[52:53], v8, s[52:55], s7 offen offset:2944
    s_add_u32 s7, s30, 1400832
    buffer_store_dwordx2 v[38:39], v8, s[52:55], s7 offen offset:512
    buffer_store_dwordx2 v[54:55], v8, s[52:55], s7 offen offset:2944
    s_add_u32 s7, s30, 1867776
    buffer_store_dwordx2 v[40:41], v8, s[52:55], s7 offen offset:512
    buffer_store_dwordx2 v[56:57], v8, s[52:55], s7 offen offset:2944
    s_add_u32 s7, s30, 2023424
    buffer_store_dwordx2 v[42:43], v8, s[52:55], s7 offen offset:512
    buffer_store_dwordx2 v[58:59], v8, s[52:55], s7 offen offset:2944
    s_endpgm
K1_PF:
    s_cmp_lg_u32 s6, 7
    s_cbranch_scc1 END_k1_kernel
    s_mul_i32 s30, s2, 9216
    s_add_u32 s32, s28, 14680064
    s_addc_u32 s33, s29, 0
    s_mov_b32 s34, 2359296
    s_mov_b32 s35, 0x20000
    v_mov_b32 v8, -1
    v_mov_b32 v9, -1
    v_mov_b32 v10, -1
    v_mov_b32 v11, -1
    buffer_store_dwordx4 v[8:11], v7, s[32:35], s30 offen offset:0 sc1
    buffer_store_dwordx4 v[8:11], v7, s[32:35], s30 offen offset:1024 sc1
    buffer_store_dwordx4 v[8:11], v7, s[32:35], s30 offen offset:2048 sc1
    buffer_store_dwordx4 v[8:11], v7, s[32:35], s30 offen offset:3072 sc1
    s_add_u32 s30, s30, 4096
    buffer_store_dwordx4 v[8:11], v7, s[32:35], s30 offen offset:0 sc1
    buffer_store_dwordx4 v[8:11], v7, s[32:35], s30 offen offset:1024 sc1
    buffer_store_dwordx4 v[8:11], v7, s[32:35], s30 offen offset:2048 sc1
    buffer_store_dwordx4 v[8:11], v7, s[32:35], s30 offen offset:3072 sc1
    s_add_u32 s30, s30, 4096
    buffer_store_dwordx4 v[8:11], v7, s[32:35], s30 offen offset:0 sc1
END_k1_kernel:
    s_endpgm
.globl k2_kernel
.p2align 8
.type k2_kernel,@function
k2_kernel:
    s_load_dwordx16 s[8:23], s[0:1], 0
    s_load_dwordx2 s[24:25], s[0:1], 64
    s_load_dwordx2 s[28:29], s[0:1], 80
    s_cmp_ge_u32 s2, 256
    s_cbranch_scc1 END_k2_kernel
    v_lshrrev_b32 v2, 6, v0
    v_and_b32 v1, 63, v0
    v_readfirstlane_b32 s6, v2
    s_and_b32 s3, s2, 7
    s_lshl_b32 s3, s3, 2
    s_bfe_u32 s4, s2, 0x20003
    s_add_u32 s3, s3, s4
    s_lshr_b32 s4, s2, 5
    s_lshl_b32 s4, s4, 3
    s_add_u32 s4, s4, s6
    s_mul_i32 s5, s3, 155648
    s_mul_i32 s7, s4, 2432
    s_add_u32 s7, s7, s5
    s_lshl_b32 s30, s6, 10
    s_add_u32 s31, s5, s30
    v_lshlrev_b32 v2, 4, v1
    v_and_b32 v3, 31, v1
    v_lshlrev_b32 v3, 2, v3
    s_cmp_ge_u32 s6, 8
    s_waitcnt lgkmcnt(0)
    s_mov_b32 s36, s28
    s_mov_b32 s37, s29
    s_mov_b32 s38, 4980736
    s_mov_b32 s39, 0x20000
    s_cbranch_scc1 K2_HELP
    s_add_u32 s36, s28, 9437184
    s_addc_u32 s37, s29, 0
    s_add_u32 s32, s28, 4194304
    s_addc_u32 s33, s29, 0
    s_mov_b32 s34, 4980736
    s_mov_b32 s35, 0x20000
    s_add_u32 s44, s28, 14680064
    s_addc_u32 s45, s29, 0
    s_mov_b32 s46, 2359296
    s_mov_b32 s47, 0x20000
    buffer_load_dwordx4 v[72:75], v2, s[32:35], s7 offen
    buffer_load_dword v76, v3, s[32:35], s7 offen offset:2304
    buffer_load_dwordx4 v[80:83], v2, s[36:39], s5 offen
    buffer_load_dword v78, v3, s[36:39], s5 offen offset:2304
    s_add_u32 m0, s30, 0
    s_add_u32 s7, s31, 0
    buffer_load_dwordx4 v2, s[36:39], s7 offen lds
    s_add_u32 m0, s30, 8192
    s_add_u32 s7, s31, 8192
    buffer_load_dwordx4 v2, s[36:39], s7 offen lds
    s_add_u32 m0, s30, 16384
    s_add_u32 s7, s31, 16384
    buffer_load_dwordx4 v2, s[36:39], s7 offen lds
    v_lshrrev_b32 v4, 4, v1
    v_bfe_u32 v5, v1, 2, 2
    v_and_b32 v6, 3, v1
    v_and_b32 v7, 1, v6
    v_lshrrev_b32 v6, 1, v6
    v_lshl_add_u32 v6, v7, 1, v6
    v_lshrrev_b32 v7, 1, v4
    v_lshl_add_u32 v5, v7, 2, v5
    v_lshlrev_b32 v12, 5, v5
    v_lshl_add_u32 v12, v6, 3, v12
    v_lshlrev_b32 v13, 3, v5
    v_add_u32 v13, 512, v13
    v_and_b32 v4, 1, v4
    v_cmp_eq_u32 vcc, 1, v4
    v_add_u32 v14, 256, v12
    v_add_u32 v15, 64, v13
    v_cndmask_b32 v12, v12, v13, vcc
    v_cndmask_b32 v13, v14, v15, vcc
    v_and_b32 v4, 3, v1
    v_cmp_ne_u32 s[48:49], 0, v4
    s_nop 0
    s_and_b64 vcc, vcc, s[48:49]
    v_mov_b32 v4, 0x100000
    v_cndmask_b32 v12, v12, v4, vcc
    v_cndmask_b32 v13, v13, v4, vcc
    v_cmp_gt_u32 s[48:49], 32, v1
    s_add_u32 s52, s28, 72351744
    s_addc_u32 s53, s29, 0
    s_mov_b32 s54, 663552
    s_mov_b32 s55, 0x20000
    s_mov_b32 s64, s8
    s_mov_b32 s65, s9
    s_mov_b32 s66, 2359296
    s_mov_b32 s67, 0x20000
    s_add_u32 s40, s28, 81920
    s_addc_u32 s41, s29, 0
    s_mov_b32 s42, 6912
    s_mov_b32 s43, 0x20000
    s_add_u32 s32, s28, 17825792
    s_addc_u32 s33, s29, 0
    s_mov_b32 s34, 5505024
    s_mov_b32 s35, 0x20000
    s_add_u32 s36, s28, 24117248
    s_addc_u32 s37, s29, 0
    s_mov_b32 s38, 65536
    s_mov_b32 s39, 0x20000
    s_min_u32 s58, s6, 8
    s_mul_i32 s50, s58, 11
    s_lshr_b32 s50, s50, 5
    s_mul_i32 s51, s50, 3
    s_sub_u32 s51, s58, s51
    s_bfe_u32 s56, s2, 0x20003
    s_mul_i32 s57, s56, 3
    s_add_u32 s57, s57, s50
    s_mul_i32 s57, s57, 55296
    s_mul_i32 s68, s51, 3072
    s_add_u32 s57, s57, s68
    s_and_b32 s70, s2, 7
    s_lshl_b32 s70, s70, 3
    s_lshr_b32 s75, s2, 5
    s_add_u32 s70, s70, s75
    s_mul_i32 s68, s56, 9
    s_add_u32 s68, s68, s58
    s_lshl_b32 s71, s68, 5
    s_mul_i32 s59, s70, 36864
    s_add_u32 s62, s59, s71
    s_add_u32 s63, s71, 2304
    s_add_u32 s71, s71, 4608
    s_buffer_load_dwordx8 s[8:15], s[40:43], s63
    s_buffer_load_dwordx8 s[16:23], s[40:43], s71
    s_lshl_b32 s68, s68, 10
    s_add_u32 s68, s68, s59
    s_add_u32 s69, s68, 3145728
    s_mul_i32 s72, s50, 12288
    s_add_u32 s59, s59, s72
    s_add_u32 s60, s59, 4096
    s_add_u32 s61, s59, 8192
    s_lshl_b32 s70, s70, 2
    s_add_u32 s70, s70, s56
    s_lshl_b32 s70, s70, 8
    s_mul_i32 s76, s50, 18944
    s_mul_i32 s77, s51, 192
    s_add_u32 s76, s76, s77
    s_lshl_b32 s77, s58, 6
    s_mov_b32 s72, 0x100000
    s_mov_b32 s73, 63
    s_mov_b32 s74, 0xffff0000
    v_lshrrev_b32 v5, 4, v1
    v_and_b32 v7, 15, v1
    v_lshlrev_b32 v5, 9, v5
    v_lshl_add_u32 v6, v7, 2, v5
    v_lshl_add_u32 v5, v7, 4, v5
    v_mov_b32 v7, 0
    v_mov_b32 v79, 0x3f803f80
    s_mov_b32 s40, 0
    s_mov_b32 s41, 1
    s_lshr_b32 s43, s6, 2
    v_mov_b32 v77, 0
    v_mov_b32 v14, 0xff800000
    s_waitcnt vmcnt(3) lgkmcnt(0)
    v_cndmask_b32 v76, 0, v76, s[48:49]
    s_branch K2_MAX1
K2_RESTART:
    v_mov_b32 v77, 0
    v_mov_b32 v14, 0xff800000
    v_mov_b32 v8, v2
    v_mov_b32 v9, v3
K2_MAX:
    ds_read_b32 v78, v9 offset:2304
    ds_read_b128 v[80:83], v8
    v_add_u32 v9, 2432, v9
    v_add_u32 v8, 2432, v8
    s_waitcnt lgkmcnt(0)
K2_MAX1:
    s_nop 1
    v_mfma_f32_32x32x8_bf16 v[16:31], v[78:79], v[76:77], 0
    v_mfma_f32_32x32x16_bf16 v[16:31], v[80:83], v[72:75], v[16:31]
    s_sub_u32 s41, s41, 1
    s_nop 10
    v_max3_f32 v14, v16, v17, v14
    v_max3_f32 v14, v18, v19, v14
    v_max3_f32 v14, v20, v21, v14
    v_max3_f32 v14, v22, v23, v14
    v_max3_f32 v14, v24, v25, v14
    v_max3_f32 v14, v26, v27, v14
    v_max3_f32 v14, v28, v29, v14
    v_max3_f32 v14, v30, v31, v14
    s_cmp_lg_u32 s41, 0
    s_cbranch_scc1 K2_MAX
    v_mov_b32 v15, v14
    v_mov_b32 v8, v2
    v_mov_b32 v9, v3
    v_permlane32_swap_b32 v14, v15
    v_max_f32 v14, v14, v15
    v_cvt_pk_bf16_f32 v15, -v14, -v14
    v_mov_b32 v10, v12
    v_lshlrev_b32 v4, 16, v15
    v_add_f32 v4, v4, v14
    v_cvt_pk_bf16_f32 v4, -v14, -v4
    v_mov_b32 v11, v13
    v_cndmask_b32 v77, 0, v4, s[48:49]
    v_mov_b32 v48, 0
    v_mov_b32 v49, 0
    v_mov_b32 v50, 0
    v_mov_b32 v51, 0
    v_mov_b32 v52, 0
    v_mov_b32 v53, 0
    v_mov_b32 v54, 0
    v_mov_b32 v55, 0
    v_mov_b32 v56, 0
    v_mov_b32 v57, 0
    v_mov_b32 v58, 0
    v_mov_b32 v59, 0
    v_mov_b32 v60, 0
    v_mov_b32 v61, 0
    v_mov_b32 v62, 0
    v_mov_b32 v63, 0
    v_mov_b32 v68, 0
    v_mov_b32 v88, 0
    v_mov_b32 v69, 0
    v_mov_b32 v89, 0
    v_mov_b32 v70, 0
    v_mov_b32 v90, 0
    v_mov_b32 v71, 0
    v_mov_b32 v91, 0
    s_cmp_lg_u32 s40, 0
    s_cbranch_scc1 K2_NB
    s_waitcnt vmcnt(0)
    s_barrier
K2_NB:
    ds_read_b32 v78, v9 offset:2304
    ds_read_b128 v[80:83], v8
    ds_read_b64_tr_b16 v[84:85], v10 offset:1024
    ds_read_b64_tr_b16 v[86:87], v11 offset:1024
    s_waitcnt lgkmcnt(2)
    v_mfma_f32_32x32x8_bf16 v[16:31], v[78:79], v[76:77], 0
    v_mfma_f32_32x32x16_bf16 v[16:31], v[80:83], v[72:75], v[16:31]
    ds_read_b32 v78, v9 offset:4736
    ds_read_b128 v[80:83], v8 offset:2432
    s_mov_b32 s42, 8
    s_nop 7
    s_waitcnt lgkmcnt(0)
    s_setprio 3
    s_mov_b32 s43, 0xfe
K2_LOOP:
    s_bitcmp1_b32 s43, s40
    s_cbranch_scc1 K2_SYNC
K2_BACK:
    s_waitcnt lgkmcnt(5)
    v_mfma_f32_32x32x8_bf16 v[32:47], v[78:79], v[76:77], 0
    ds_read_b32 v78, v9 offset:7168
    v_exp_f32 v16, v16
    v_exp_f32 v17, v17
    v_exp_f32 v18, v18
    v_exp_f32 v19, v19
    s_waitcnt lgkmcnt(4)
    v_mfma_f32_32x32x16_bf16 v[48:63], v[88:91], v[68:71], v[48:63]
    ds_read_b64_tr_b16 v[88:89], v10 offset:1664
    ds_read_b64_tr_b16 v[90:91], v11 offset:1664
    v_cvt_pk_bf16_f32 v64, v16, v17
    v_exp_f32 v20, v20
    v_cvt_pk_bf16_f32 v65, v18, v19
    v_exp_f32 v21, v21
    v_exp_f32 v22, v22
    v_exp_f32 v23, v23
    s_waitcnt lgkmcnt(5)
    v_mfma_f32_32x32x16_bf16 v[32:47], v[80:83], v[72:75], v[32:47]
    ds_read_b128 v[80:83], v8 offset:4864
    v_cvt_pk_bf16_f32 v66, v20, v21
    v_exp_f32 v24, v24
    v_cvt_pk_bf16_f32 v67, v22, v23
    v_exp_f32 v25, v25
    v_exp_f32 v26, v26
    v_exp_f32 v27, v27
    s_waitcnt lgkmcnt(4)
    v_mfma_f32_32x32x16_bf16 v[48:63], v[84:87], v[64:67], v[48:63]
    ds_read_b64_tr_b16 v[84:85], v10 offset:3456
    ds_read_b64_tr_b16 v[86:87], v11 offset:3456
    v_cvt_pk_bf16_f32 v68, v24, v25
    v_exp_f32 v28, v28
    v_cvt_pk_bf16_f32 v69, v26, v27
    v_exp_f32 v29, v29
    v_exp_f32 v30, v30
    v_exp_f32 v31, v31
    v_cvt_pk_bf16_f32 v70, v28, v29
    v_cvt_pk_bf16_f32 v71, v30, v31
    s_waitcnt lgkmcnt(5)
    v_mfma_f32_32x32x8_bf16 v[16:31], v[78:79], v[76:77], 0
    ds_read_b32 v78, v9 offset:9600
    v_exp_f32 v32, v32
    v_exp_f32 v33, v33
    v_exp_f32 v34, v34
    v_exp_f32 v35, v35
    s_waitcnt lgkmcnt(4)
    v_mfma_f32_32x32x16_bf16 v[48:63], v[88:91], v[68:71], v[48:63]
    ds_read_b64_tr_b16 v[88:89], v10 offset:4096
    ds_read_b64_tr_b16 v[90:91], v11 offset:4096
    v_cvt_pk_bf16_f32 v64, v32, v33
    v_exp_f32 v36, v36
    v_cvt_pk_bf16_f32 v65, v34, v35
    v_exp_f32 v37, v37
    v_exp_f32 v38, v38
    v_exp_f32 v39, v39
    s_waitcnt lgkmcnt(5)
    v_mfma_f32_32x32x16_bf16 v[16:31], v[80:83], v[72:75], v[16:31]
    ds_read_b128 v[80:83], v8 offset:7296
    v_cvt_pk_bf16_f32 v66, v36, v37
    v_exp_f32 v40, v40
    v_cvt_pk_bf16_f32 v67, v38, v39
    v_exp_f32 v41, v41
    v_exp_f32 v42, v42
    v_exp_f32 v43, v43
    s_waitcnt lgkmcnt(4)
    v_mfma_f32_32x32x16_bf16 v[48:63], v[84:87], v[64:67], v[48:63]
    ds_read_b64_tr_b16 v[84:85], v10 offset:5888
    ds_read_b64_tr_b16 v[86:87], v11 offset:5888
    v_cvt_pk_bf16_f32 v68, v40, v41
    v_exp_f32 v44, v44
    v_cvt_pk_bf16_f32 v69, v42, v43
    v_exp_f32 v45, v45
    v_exp_f32 v46, v46
    v_exp_f32 v47, v47
    v_cvt_pk_bf16_f32 v70, v44, v45
    v_cvt_pk_bf16_f32 v71, v46, v47
    s_waitcnt lgkmcnt(5)
    v_mfma_f32_32x32x8_bf16 v[32:47], v[78:79], v[76:77], 0
    ds_read_b32 v78, v9 offset:12032
    v_exp_f32 v16, v16
    v_exp_f32 v17, v17
    v_exp_f32 v18, v18
    v_exp_f32 v19, v19
    s_waitcnt lgkmcnt(4)
    v_mfma_f32_32x32x16_bf16 v[48:63], v[88:91], v[68:71], v[48:63]
    ds_read_b64_tr_b16 v[88:89], v10 offset:6528
    ds_read_b64_tr_b16 v[90:91], v11 offset:6528
    v_cvt_pk_bf16_f32 v64, v16, v17
    v_exp_f32 v20, v20
    v_cvt_pk_bf16_f32 v65, v18, v19
    v_exp_f32 v21, v21
    v_exp_f32 v22, v22
    v_exp_f32 v23, v23
    s_waitcnt lgkmcnt(5)
    v_mfma_f32_32x32x16_bf16 v[32:47], v[80:83], v[72:75], v[32:47]
    ds_read_b128 v[80:83], v8 offset:9728
    v_cvt_pk_bf16_f32 v66, v20, v21
    v_exp_f32 v24, v24
    v_cvt_pk_bf16_f32 v67, v22, v23
    v_exp_f32 v25, v25
    v_exp_f32 v26, v26
    v_exp_f32 v27, v27
    s_waitcnt lgkmcnt(4)
    v_mfma_f32_32x32x16_bf16 v[48:63], v[84:87], v[64:67], v[48:63]
    ds_read_b64_tr_b16 v[84:85], v10 offset:8320
    ds_read_b64_tr_b16 v[86:87], v11 offset:8320
    v_cvt_pk_bf16_f32 v68, v24, v25
    v_exp_f32 v28, v28
    v_cvt_pk_bf16_f32 v69, v26, v27
    v_exp_f32 v29, v29
    v_exp_f32 v30, v30
    v_exp_f32 v31, v31
    v_cvt_pk_bf16_f32 v70, v28, v29
    v_cvt_pk_bf16_f32 v71, v30, v31
    s_waitcnt lgkmcnt(5)
    v_mfma_f32_32x32x8_bf16 v[16:31], v[78:79], v[76:77], 0
    ds_read_b32 v78, v9 offset:14464
    v_exp_f32 v32, v32
    v_exp_f32 v33, v33
    v_exp_f32 v34, v34
    v_exp_f32 v35, v35
    s_waitcnt lgkmcnt(4)
    v_mfma_f32_32x32x16_bf16 v[48:63], v[88:91], v[68:71], v[48:63]
    ds_read_b64_tr_b16 v[88:89], v10 offset:8960
    ds_read_b64_tr_b16 v[90:91], v11 offset:8960
    v_cvt_pk_bf16_f32 v64, v32, v33
    v_exp_f32 v36, v36
    v_cvt_pk_bf16_f32 v65, v34, v35
    v_exp_f32 v37, v37
    v_exp_f32 v38, v38
    v_exp_f32 v39, v39
    s_waitcnt lgkmcnt(5)
    v_mfma_f32_32x32x16_bf16 v[16:31], v[80:83], v[72:75], v[16:31]
    ds_read_b128 v[80:83], v8 offset:12160
    v_cvt_pk_bf16_f32 v66, v36, v37
    v_exp_f32 v40, v40
    v_cvt_pk_bf16_f32 v67, v38, v39
    v_exp_f32 v41, v41
    v_exp_f32 v42, v42
    v_exp_f32 v43, v43
    s_waitcnt lgkmcnt(4)
    v_mfma_f32_32x32x16_bf16 v[48:63], v[84:87], v[64:67], v[48:63]
    ds_read_b64_tr_b16 v[84:85], v10 offset:10752
    ds_read_b64_tr_b16 v[86:87], v11 offset:10752
    v_cvt_pk_bf16_f32 v68, v40, v41
    v_exp_f32 v44, v44
    v_cvt_pk_bf16_f32 v69, v42, v43
    v_exp_f32 v45, v45
    v_exp_f32 v46, v46
    v_exp_f32 v47, v47
    v_cvt_pk_bf16_f32 v70, v44, v45
    v_cvt_pk_bf16_f32 v71, v46, v47
    s_waitcnt lgkmcnt(5)
    v_mfma_f32_32x32x8_bf16 v[32:47], v[78:79], v[76:77], 0
    ds_read_b32 v78, v9 offset:16896
    v_exp_f32 v16, v16
    v_exp_f32 v17, v17
    v_exp_f32 v18, v18
    v_exp_f32 v19, v19
    s_waitcnt lgkmcnt(4)
    v_mfma_f32_32x32x16_bf16 v[48:63], v[88:91], v[68:71], v[48:63]
    ds_read_b64_tr_b16 v[88:89], v10 offset:11392
    ds_read_b64_tr_b16 v[90:91], v11 offset:11392
    v_cvt_pk_bf16_f32 v64, v16, v17
    v_exp_f32 v20, v20
    v_cvt_pk_bf16_f32 v65, v18, v19
    v_exp_f32 v21, v21
    v_exp_f32 v22, v22
    v_exp_f32 v23, v23
    s_waitcnt lgkmcnt(5)
    v_mfma_f32_32x32x16_bf16 v[32:47], v[80:83], v[72:75], v[32:47]
    ds_read_b128 v[80:83], v8 offset:14592
    v_cvt_pk_bf16_f32 v66, v20, v21
    v_exp_f32 v24, v24
    v_cvt_pk_bf16_f32 v67, v22, v23
    v_exp_f32 v25, v25
    v_exp_f32 v26, v26
    v_exp_f32 v27, v27
    s_waitcnt lgkmcnt(4)
    v_mfma_f32_32x32x16_bf16 v[48:63], v[84:87], v[64:67], v[48:63]
    ds_read_b64_tr_b16 v[84:85], v10 offset:13184
    ds_read_b64_tr_b16 v[86:87], v11 offset:13184
    v_cvt_pk_bf16_f32 v68, v24, v25
    v_exp_f32 v28, v28
    v_cvt_pk_bf16_f32 v69, v26, v27
    v_exp_f32 v29, v29
    v_exp_f32 v30, v30
    v_exp_f32 v31, v31
    v_cvt_pk_bf16_f32 v70, v28, v29
    v_cvt_pk_bf16_f32 v71, v30, v31
    s_waitcnt lgkmcnt(5)
    v_mfma_f32_32x32x8_bf16 v[16:31], v[78:79], v[76:77], 0
    ds_read_b32 v78, v9 offset:19328
    v_exp_f32 v32, v32
    v_exp_f32 v33, v33
    v_exp_f32 v34, v34
    v_exp_f32 v35, v35
    s_waitcnt lgkmcnt(4)
    v_mfma_f32_32x32x16_bf16 v[48:63], v[88:91], v[68:71], v[48:63]
    ds_read_b64_tr_b16 v[88:89], v10 offset:13824
    ds_read_b64_tr_b16 v[90:91], v11 offset:13824
    v_cvt_pk_bf16_f32 v64, v32, v33
    v_exp_f32 v36, v36
    v_cvt_pk_bf16_f32 v65, v34, v35
    v_exp_f32 v37, v37
    v_exp_f32 v38, v38
    v_exp_f32 v39, v39
    s_waitcnt lgkmcnt(5)
    v_mfma_f32_32x32x16_bf16 v[16:31], v[80:83], v[72:75], v[16:31]
    ds_read_b128 v[80:83], v8 offset:17024
    v_cvt_pk_bf16_f32 v66, v36, v37
    v_exp_f32 v40, v40
    v_cvt_pk_bf16_f32 v67, v38, v39
    v_exp_f32 v41, v41
    v_exp_f32 v42, v42
    v_exp_f32 v43, v43
    s_waitcnt lgkmcnt(4)
    v_mfma_f32_32x32x16_bf16 v[48:63], v[84:87], v[64:67], v[48:63]
    ds_read_b64_tr_b16 v[84:85], v10 offset:15616
    ds_read_b64_tr_b16 v[86:87], v11 offset:15616
    v_cvt_pk_bf16_f32 v68, v40, v41
    v_exp_f32 v44, v44
    v_cvt_pk_bf16_f32 v69, v42, v43
    v_exp_f32 v45, v45
    v_exp_f32 v46, v46
    v_exp_f32 v47, v47
    v_cvt_pk_bf16_f32 v70, v44, v45
    v_cvt_pk_bf16_f32 v71, v46, v47
    s_waitcnt lgkmcnt(5)
    v_mfma_f32_32x32x8_bf16 v[32:47], v[78:79], v[76:77], 0
    ds_read_b32 v78, v9 offset:21760
    v_exp_f32 v16, v16
    v_exp_f32 v17, v17
    v_exp_f32 v18, v18
    v_exp_f32 v19, v19
    s_waitcnt lgkmcnt(4)
    v_mfma_f32_32x32x16_bf16 v[48:63], v[88:91], v[68:71], v[48:63]
    ds_read_b64_tr_b16 v[88:89], v10 offset:16256
    ds_read_b64_tr_b16 v[90:91], v11 offset:16256
    v_cvt_pk_bf16_f32 v64, v16, v17
    v_exp_f32 v20, v20
    v_cvt_pk_bf16_f32 v65, v18, v19
    v_exp_f32 v21, v21
    v_exp_f32 v22, v22
    v_exp_f32 v23, v23
    s_waitcnt lgkmcnt(5)
    v_mfma_f32_32x32x16_bf16 v[32:47], v[80:83], v[72:75], v[32:47]
    ds_read_b128 v[80:83], v8 offset:19456
    v_cvt_pk_bf16_f32 v66, v20, v21
    v_exp_f32 v24, v24
    v_cvt_pk_bf16_f32 v67, v22, v23
    v_exp_f32 v25, v25
    v_exp_f32 v26, v26
    v_exp_f32 v27, v27
    s_waitcnt lgkmcnt(4)
    v_mfma_f32_32x32x16_bf16 v[48:63], v[84:87], v[64:67], v[48:63]
    ds_read_b64_tr_b16 v[84:85], v10 offset:18048
    ds_read_b64_tr_b16 v[86:87], v11 offset:18048
    v_cvt_pk_bf16_f32 v68, v24, v25
    v_exp_f32 v28, v28
    v_cvt_pk_bf16_f32 v69, v26, v27
    v_exp_f32 v29, v29
    v_exp_f32 v30, v30
    v_exp_f32 v31, v31
    v_cvt_pk_bf16_f32 v70, v28, v29
    v_cvt_pk_bf16_f32 v71, v30, v31
    s_waitcnt lgkmcnt(5)
    v_mfma_f32_32x32x8_bf16 v[16:31], v[78:79], v[76:77], 0
    ds_read_b32 v78, v9 offset:24192
    v_exp_f32 v32, v32
    v_exp_f32 v33, v33
    v_exp_f32 v34, v34
    v_exp_f32 v35, v35
    s_waitcnt lgkmcnt(4)
    v_mfma_f32_32x32x16_bf16 v[48:63], v[88:91], v[68:71], v[48:63]
    ds_read_b64_tr_b16 v[88:89], v10 offset:18688
    ds_read_b64_tr_b16 v[90:91], v11 offset:18688
    v_cvt_pk_bf16_f32 v64, v32, v33
    v_exp_f32 v36, v36
    v_cvt_pk_bf16_f32 v65, v34, v35
    v_exp_f32 v37, v37
    v_exp_f32 v38, v38
    v_exp_f32 v39, v39
    s_waitcnt lgkmcnt(5)
    v_mfma_f32_32x32x16_bf16 v[16:31], v[80:83], v[72:75], v[16:31]
    ds_read_b128 v[80:83], v8 offset:21888
    v_cvt_pk_bf16_f32 v66, v36, v37
    v_exp_f32 v40, v40
    v_cvt_pk_bf16_f32 v67, v38, v39
    v_exp_f32 v41, v41
    v_exp_f32 v42, v42
    v_exp_f32 v43, v43
    s_waitcnt lgkmcnt(4)
    v_mfma_f32_32x32x16_bf16 v[48:63], v[84:87], v[64:67], v[48:63]
    ds_read_b64_tr_b16 v[84:85], v10 offset:20480
    ds_read_b64_tr_b16 v[86:87], v11 offset:20480
    v_cvt_pk_bf16_f32 v68, v40, v41
    v_exp_f32 v44, v44
    v_cvt_pk_bf16_f32 v69, v42, v43
    v_exp_f32 v45, v45
    v_exp_f32 v46, v46
    v_exp_f32 v47, v47
    v_add_u32 v8, 19456, v8
    v_add_u32 v9, 19456, v9
    v_add_u32 v10, 19456, v10
    v_add_u32 v11, 19456, v11
    s_sub_u32 s42, s42, 1
    s_add_u32 s40, s40, 1
    s_cmp_lg_u32 s42, 0
    v_cvt_pk_bf16_f32 v70, v44, v45
    v_cvt_pk_bf16_f32 v71, v46, v47
    s_cbranch_scc1 K2_LOOP
    s_waitcnt lgkmcnt(0)
    v_mfma_f32_32x32x16_bf16 v[48:63], v[88:91], v[68:71], v[48:63]
    s_mul_i32 s4, s4, 36
    s_add_u32 s5, s4, s3
    s_lshl_b32 s5, s5, 10
    s_lshl_b32 s7, s3, 7
    s_add_u32 s31, s4, 32
    s_lshl_b32 s31, s31, 10
    s_add_u32 s7, s7, s31
    s_nop 4
    v_mov_b32 v4, v58
    s_nop 1
    v_permlane32_swap_b32 v58, v4
    v_cmp_gt_f32 vcc, 1568669696, v58
    v_rcp_f32 v4, v58
    s_cmp_eq_u64 vcc, -1
    s_cbranch_scc1 K2_OUT
    s_cmp_ge_u32 s40, 100
    s_cbranch_scc1 K2_OUT
    s_mov_b32 s40, 100
    s_mov_b32 s41, 64
    s_lshr_b32 s4, s2, 5
    s_lshl_b32 s4, s4, 3
    s_add_u32 s4, s4, s6
    s_branch K2_RESTART
K2_OUT:
    v_mul_f32 v48, v4, v48
    v_mul_f32 v49, v4, v49
    v_mul_f32 v50, v4, v50
    v_mul_f32 v51, v4, v51
    v_mul_f32 v52, v4, v52
    v_mul_f32 v53, v4, v53
    v_mul_f32 v54, v4, v54
    v_mul_f32 v55, v4, v55
    v_mul_f32 v56, v4, v56
    v_mul_f32 v57, v4, v57
    v_cvt_pk_bf16_f32 v64, v48, v49
    v_cvt_pk_bf16_f32 v65, v50, v51
    v_cvt_pk_bf16_f32 v66, v52, v53
    v_cvt_pk_bf16_f32 v67, v54, v55
    v_cvt_pk_bf16_f32 v68, v56, v57
    v_min_u32 v64, -2, v64
    v_min_u32 v65, -2, v65
    v_min_u32 v66, -2, v66
    v_min_u32 v67, -2, v67
    v_min_u32 v68, -2, v68
    buffer_store_dwordx4 v[64:67], v2, s[44:47], s5 offen sc1
    s_mov_b32 exec_hi, 0
    buffer_store_dword v68, v3, s[44:47], s7 offen sc1
    s_mov_b32 exec_hi, -1
    s_cmp_lg_u32 s6, s75
    s_cbranch_scc1 K2_NG
    ds_write_b16 v7, v7 offset:1550
K2_NG:
    s_cmp_ge_u32 s6, 4
    s_cbranch_scc1 K2_T
    buffer_load_dwordx4 v[92:95], v2, s[52:55], s57 offen offset:0
    buffer_load_dwordx4 v[96:99], v2, s[52:55], s57 offen offset:1024
    buffer_load_dwordx4 v[100:103], v2, s[52:55], s57 offen offset:2048
    s_add_u32 s57, s57, 9216
    buffer_load_dwordx4 v[104:107], v2, s[52:55], s57 offen offset:0
    buffer_load_dwordx4 v[108:111], v2, s[52:55], s57 offen offset:1024
    buffer_load_dwordx4 v[112:115], v2, s[52:55], s57 offen offset:2048
    s_add_u32 s57, s57, 9216
    buffer_load_dwordx4 v[116:119], v2, s[52:55], s57 offen offset:0
    buffer_load_dwordx4 v[120:123], v2, s[52:55], s57 offen offset:1024
    buffer_load_dwordx4 v[124:127], v2, s[52:55], s57 offen offset:2048
    s_add_u32 s57, s57, 9216
    buffer_load_dwordx4 v[128:131], v2, s[52:55], s57 offen offset:0
    buffer_load_dwordx4 v[132:135], v2, s[52:55], s57 offen offset:1024
    buffer_load_dwordx4 v[136:139], v2, s[52:55], s57 offen offset:2048
    s_add_u32 s57, s57, 9216
    buffer_load_dwordx4 v[140:143], v2, s[52:55], s57 offen offset:0
    buffer_load_dwordx4 v[144:147], v2, s[52:55], s57 offen offset:1024
    buffer_load_dwordx4 v[148:151], v2, s[52:55], s57 offen offset:2048
    s_add_u32 s57, s57, 9216
    buffer_load_dwordx4 v[152:155], v2, s[52:55], s57 offen offset:0
    buffer_load_dwordx4 v[156:159], v2, s[52:55], s57 offen offset:1024
    buffer_load_dwordx4 v[160:163], v2, s[52:55], s57 offen offset:2048
    s_add_u32 s57, s57, 9216
K2_T:
K2_T2:
    s_barrier
    s_cmp_eq_u32 s50, 2
    s_cbranch_scc1 K2_LB
K2_LA:
    buffer_load_dwordx4 v[16:19], v5, s[44:47], s59 offen offset:0
    buffer_load_dwordx4 v[20:23], v5, s[44:47], s59 offen offset:256
    buffer_load_dwordx4 v[24:27], v5, s[44:47], s59 offen offset:2048
    buffer_load_dwordx4 v[28:31], v5, s[44:47], s59 offen offset:2304
    buffer_load_dwordx4 v[32:35], v5, s[44:47], s60 offen offset:0
    buffer_load_dwordx4 v[36:39], v5, s[44:47], s60 offen offset:256
    buffer_load_dwordx4 v[40:43], v5, s[44:47], s60 offen offset:2048
    buffer_load_dwordx4 v[44:47], v5, s[44:47], s60 offen offset:2304
    buffer_load_dwordx4 v[48:51], v5, s[44:47], s61 offen offset:0
    buffer_load_dwordx4 v[52:55], v5, s[44:47], s61 offen offset:256
    buffer_load_dwordx4 v[56:59], v5, s[44:47], s61 offen offset:2048
    buffer_load_dwordx4 v[60:63], v5, s[44:47], s61 offen offset:2304
    v_lshrrev_b32 v4, 5, v1
    v_lshlrev_b32 v4, 4, v4
    v_and_b32 v3, 31, v1
    v_mul_u32_u24 v7, 592, v3
    v_lshl_add_u32 v7, v4, 1, v7
    v_add_u32 v7, s77, v7
    v_lshrrev_b32 v8, 4, v1
    v_and_b32 v9, 15, v1
    v_mul_u32_u24 v11, 592, v9
    v_lshl_add_u32 v11, v8, 4, v11
    v_add_u32 v11, s76, v11
    v_mov_b32 v64, 0
    v_mov_b32 v65, 0
    v_mov_b32 v66, 0
    v_mov_b32 v67, 0
    v_mov_b32 v68, 0
    v_mov_b32 v69, 0
    v_mov_b32 v70, 0
    v_mov_b32 v71, 0
    v_mov_b32 v72, 0
    v_mov_b32 v73, 0
    v_mov_b32 v74, 0
    v_mov_b32 v75, 0
    v_mov_b32 v76, 0
    v_mov_b32 v77, 0
    v_mov_b32 v78, 0
    v_mov_b32 v79, 0
    v_mov_b32 v80, 0
    v_mov_b32 v81, 0
    v_mov_b32 v82, 0
    v_mov_b32 v83, 0
    v_mov_b32 v84, 0
    v_mov_b32 v85, 0
    v_mov_b32 v86, 0
    v_mov_b32 v87, 0
    v_mov_b32 v88, s8
    v_mov_b32 v12, s16
    v_mov_b32 v89, s9
    v_mov_b32 v13, s17
    v_mov_b32 v90, s10
    v_mov_b32 v14, s18
    v_mov_b32 v91, s11
    v_mov_b32 v15, s19
    s_mov_b32 exec_lo, 0
    v_mov_b32 v88, s12
    v_mov_b32 v12, s20
    v_mov_b32 v89, s13
    v_mov_b32 v13, s21
    v_mov_b32 v90, s14
    v_mov_b32 v14, s22
    v_mov_b32 v91, s15
    v_mov_b32 v15, s23
    s_mov_b32 exec_lo, -1
K2_CA0:
    s_bitcmp0_b32 s73, 0
    s_cbranch_scc1 K2_CA1
    s_waitcnt vmcnt(10)
    v_max3_u32 v9, v16, v17, v18
    v_max3_u32 v10, v19, v20, v21
    v_max3_u32 v9, v9, v22, v23
    v_max_u32 v9, v9, v10
    v_cmp_eq_u32 vcc, -1, v9
    s_nop 1
    s_cbranch_vccnz K2_CA1
    s_bitset0_b32 s73, 0
    v_mfma_f32_16x16x32_bf16 v[64:67], v[92:95], v[16:19], v[64:67]
    v_mfma_f32_16x16x32_bf16 v[68:71], v[96:99], v[16:19], v[68:71]
    v_mfma_f32_16x16x32_bf16 v[72:75], v[100:103], v[16:19], v[72:75]
    v_mfma_f32_16x16x32_bf16 v[76:79], v[92:95], v[20:23], v[76:79]
    v_mfma_f32_16x16x32_bf16 v[80:83], v[96:99], v[20:23], v[80:83]
    v_mfma_f32_16x16x32_bf16 v[84:87], v[100:103], v[20:23], v[84:87]
K2_CA1:
    s_bitcmp0_b32 s73, 1
    s_cbranch_scc1 K2_CA2
    s_waitcnt vmcnt(8)
    v_max3_u32 v9, v24, v25, v26
    v_max3_u32 v10, v27, v28, v29
    v_max3_u32 v9, v9, v30, v31
    v_max_u32 v9, v9, v10
    v_cmp_eq_u32 vcc, -1, v9
    s_nop 1
    s_cbranch_vccnz K2_CA2
    s_bitset0_b32 s73, 1
    v_mfma_f32_16x16x32_bf16 v[64:67], v[104:107], v[24:27], v[64:67]
    v_mfma_f32_16x16x32_bf16 v[68:71], v[108:111], v[24:27], v[68:71]
    v_mfma_f32_16x16x32_bf16 v[72:75], v[112:115], v[24:27], v[72:75]
    v_mfma_f32_16x16x32_bf16 v[76:79], v[104:107], v[28:31], v[76:79]
    v_mfma_f32_16x16x32_bf16 v[80:83], v[108:111], v[28:31], v[80:83]
    v_mfma_f32_16x16x32_bf16 v[84:87], v[112:115], v[28:31], v[84:87]
K2_CA2:
    s_bitcmp0_b32 s73, 2
    s_cbranch_scc1 K2_CA3
    s_waitcnt vmcnt(6)
    v_max3_u32 v9, v32, v33, v34
    v_max3_u32 v10, v35, v36, v37
    v_max3_u32 v9, v9, v38, v39
    v_max_u32 v9, v9, v10
    v_cmp_eq_u32 vcc, -1, v9
    s_nop 1
    s_cbranch_vccnz K2_CA3
    s_bitset0_b32 s73, 2
    v_mfma_f32_16x16x32_bf16 v[64:67], v[116:119], v[32:35], v[64:67]
    v_mfma_f32_16x16x32_bf16 v[68:71], v[120:123], v[32:35], v[68:71]
    v_mfma_f32_16x16x32_bf16 v[72:75], v[124:127], v[32:35], v[72:75]
    v_mfma_f32_16x16x32_bf16 v[76:79], v[116:119], v[36:39], v[76:79]
    v_mfma_f32_16x16x32_bf16 v[80:83], v[120:123], v[36:39], v[80:83]
    v_mfma_f32_16x16x32_bf16 v[84:87], v[124:127], v[36:39], v[84:87]
K2_CA3:
    s_bitcmp0_b32 s73, 3
    s_cbranch_scc1 K2_CA4
    s_waitcnt vmcnt(4)
    v_max3_u32 v9, v40, v41, v42
    v_max3_u32 v10, v43, v44, v45
    v_max3_u32 v9, v9, v46, v47
    v_max_u32 v9, v9, v10
    v_cmp_eq_u32 vcc, -1, v9
    s_nop 1
    s_cbranch_vccnz K2_CA4
    s_bitset0_b32 s73, 3
    v_mfma_f32_16x16x32_bf16 v[64:67], v[128:131], v[40:43], v[64:67]
    v_mfma_f32_16x16x32_bf16 v[68:71], v[132:135], v[40:43], v[68:71]
    v_mfma_f32_16x16x32_bf16 v[72:75], v[136:139], v[40:43], v[72:75]
    v_mfma_f32_16x16x32_bf16 v[76:79], v[128:131], v[44:47], v[76:79]
    v_mfma_f32_16x16x32_bf16 v[80:83], v[132:135], v[44:47], v[80:83]
    v_mfma_f32_16x16x32_bf16 v[84:87], v[136:139], v[44:47], v[84:87]
K2_CA4:
    s_bitcmp0_b32 s73, 4
    s_cbranch_scc1 K2_CA5
    s_waitcnt vmcnt(2)
    v_max3_u32 v9, v48, v49, v50
    v_max3_u32 v10, v51, v52, v53
    v_max3_u32 v9, v9, v54, v55
    v_max_u32 v9, v9, v10
    v_cmp_eq_u32 vcc, -1, v9
    s_nop 1
    s_cbranch_vccnz K2_CA5
    s_bitset0_b32 s73, 4
    v_mfma_f32_16x16x32_bf16 v[64:67], v[140:143], v[48:51], v[64:67]
    v_mfma_f32_16x16x32_bf16 v[68:71], v[144:147], v[48:51], v[68:71]
    v_mfma_f32_16x16x32_bf16 v[72:75], v[148:151], v[48:51], v[72:75]
    v_mfma_f32_16x16x32_bf16 v[76:79], v[140:143], v[52:55], v[76:79]
    v_mfma_f32_16x16x32_bf16 v[80:83], v[144:147], v[52:55], v[80:83]
    v_mfma_f32_16x16x32_bf16 v[84:87], v[148:151], v[52:55], v[84:87]
K2_CA5:
    s_bitcmp0_b32 s73, 5
    s_cbranch_scc1 K2_CA6
    s_waitcnt vmcnt(0)
    v_max3_u32 v9, v56, v57, v58
    v_max3_u32 v10, v59, v60, v61
    v_max3_u32 v9, v9, v62, v63
    v_max_u32 v9, v9, v10
    v_cmp_eq_u32 vcc, -1, v9
    s_nop 1
    s_cbranch_vccnz K2_CA6
    s_bitset0_b32 s73, 5
    v_mfma_f32_16x16x32_bf16 v[64:67], v[152:155], v[56:59], v[64:67]
    v_mfma_f32_16x16x32_bf16 v[68:71], v[156:159], v[56:59], v[68:71]
    v_mfma_f32_16x16x32_bf16 v[72:75], v[160:163], v[56:59], v[72:75]
    v_mfma_f32_16x16x32_bf16 v[76:79], v[152:155], v[60:63], v[76:79]
    v_mfma_f32_16x16x32_bf16 v[80:83], v[156:159], v[60:63], v[80:83]
    v_mfma_f32_16x16x32_bf16 v[84:87], v[160:163], v[60:63], v[84:87]
K2_CA6:
    s_cmp_eq_u32 s73, 0
    s_cbranch_scc1 K2_E
    s_sub_u32 s72, s72, 1
    s_cbranch_scc1 K2_E
    s_sleep 3
    s_bitcmp0_b32 s73, 0
    s_cbranch_scc1 K2_RA0
    buffer_load_dwordx4 v[16:19], v5, s[44:47], s59 offen offset:0 sc1
    buffer_load_dwordx4 v[20:23], v5, s[44:47], s59 offen offset:256 sc1
K2_RA0:
    s_bitcmp0_b32 s73, 1
    s_cbranch_scc1 K2_RA1
    buffer_load_dwordx4 v[24:27], v5, s[44:47], s59 offen offset:2048 sc1
    buffer_load_dwordx4 v[28:31], v5, s[44:47], s59 offen offset:2304 sc1
K2_RA1:
    s_bitcmp0_b32 s73, 2
    s_cbranch_scc1 K2_RA2
    buffer_load_dwordx4 v[32:35], v5, s[44:47], s60 offen offset:0 sc1
    buffer_load_dwordx4 v[36:39], v5, s[44:47], s60 offen offset:256 sc1
K2_RA2:
    s_bitcmp0_b32 s73, 3
    s_cbranch_scc1 K2_RA3
    buffer_load_dwordx4 v[40:43], v5, s[44:47], s60 offen offset:2048 sc1
    buffer_load_dwordx4 v[44:47], v5, s[44:47], s60 offen offset:2304 sc1
K2_RA3:
    s_bitcmp0_b32 s73, 4
    s_cbranch_scc1 K2_RA4
    buffer_load_dwordx4 v[48:51], v5, s[44:47], s61 offen offset:0 sc1
    buffer_load_dwordx4 v[52:55], v5, s[44:47], s61 offen offset:256 sc1
K2_RA4:
    s_bitcmp0_b32 s73, 5
    s_cbranch_scc1 K2_RA5
    buffer_load_dwordx4 v[56:59], v5, s[44:47], s61 offen offset:2048 sc1
    buffer_load_dwordx4 v[60:63], v5, s[44:47], s61 offen offset:2304 sc1
K2_RA5:
    s_waitcnt vmcnt(0)
    s_branch K2_CA0
K2_LB:
    buffer_load_dwordx4 v[16:19], v5, s[44:47], s59 offen offset:0
    buffer_load_dwordx4 v[20:23], v5, s[44:47], s59 offen offset:256
    buffer_load_dwordx4 v[24:27], v5, s[44:47], s59 offen offset:2048
    buffer_load_dwordx4 v[28:31], v5, s[44:47], s59 offen offset:2304
    buffer_load_dwordx4 v[32:35], v5, s[44:47], s60 offen offset:0
    buffer_load_dwordx4 v[36:39], v5, s[44:47], s60 offen offset:256
    buffer_load_dwordx4 v[40:43], v5, s[44:47], s60 offen offset:2048
    buffer_load_dwordx4 v[44:47], v5, s[44:47], s60 offen offset:2304
    buffer_load_dword v48, v6, s[44:47], s61 offen offset:0
    buffer_load_dword v49, v6, s[44:47], s61 offen offset:128
    buffer_load_dword v50, v6, s[44:47], s61 offen offset:256
    buffer_load_dword v51, v6, s[44:47], s61 offen offset:384
    buffer_load_dword v52, v6, s[44:47], s61 offen offset:64
    buffer_load_dword v53, v6, s[44:47], s61 offen offset:192
    buffer_load_dword v54, v6, s[44:47], s61 offen offset:320
    buffer_load_dword v55, v6, s[44:47], s61 offen offset:448
    buffer_load_dword v56, v6, s[44:47], s61 offen offset:2048
    buffer_load_dword v57, v6, s[44:47], s61 offen offset:2176
    buffer_load_dword v58, v6, s[44:47], s61 offen offset:2304
    buffer_load_dword v59, v6, s[44:47], s61 offen offset:2432
    buffer_load_dword v60, v6, s[44:47], s61 offen offset:2112
    buffer_load_dword v61, v6, s[44:47], s61 offen offset:2240
    buffer_load_dword v62, v6, s[44:47], s61 offen offset:2368
    buffer_load_dword v63, v6, s[44:47], s61 offen offset:2496
    v_lshrrev_b32 v4, 5, v1
    v_lshlrev_b32 v4, 4, v4
    v_and_b32 v3, 31, v1
    v_mul_u32_u24 v7, 592, v3
    v_lshl_add_u32 v7, v4, 1, v7
    v_add_u32 v7, s77, v7
    v_lshrrev_b32 v8, 4, v1
    v_and_b32 v9, 15, v1
    v_mul_u32_u24 v11, 592, v9
    v_lshl_add_u32 v11, v8, 4, v11
    v_add_u32 v11, s76, v11
    v_mov_b32 v64, 0
    v_mov_b32 v65, 0
    v_mov_b32 v66, 0
    v_mov_b32 v67, 0
    v_mov_b32 v68, 0
    v_mov_b32 v69, 0
    v_mov_b32 v70, 0
    v_mov_b32 v71, 0
    v_mov_b32 v72, 0
    v_mov_b32 v73, 0
    v_mov_b32 v74, 0
    v_mov_b32 v75, 0
    v_mov_b32 v76, 0
    v_mov_b32 v77, 0
    v_mov_b32 v78, 0
    v_mov_b32 v79, 0
    v_mov_b32 v80, 0
    v_mov_b32 v81, 0
    v_mov_b32 v82, 0
    v_mov_b32 v83, 0
    v_mov_b32 v84, 0
    v_mov_b32 v85, 0
    v_mov_b32 v86, 0
    v_mov_b32 v87, 0
    v_mov_b32 v88, s8
    v_mov_b32 v12, s16
    v_mov_b32 v89, s9
    v_mov_b32 v13, s17
    v_mov_b32 v90, s10
    v_mov_b32 v14, s18
    v_mov_b32 v91, s11
    v_mov_b32 v15, s19
    s_mov_b32 exec_lo, 0
    v_mov_b32 v88, s12
    v_mov_b32 v12, s20
    v_mov_b32 v89, s13
    v_mov_b32 v13, s21
    v_mov_b32 v90, s14
    v_mov_b32 v14, s22
    v_mov_b32 v91, s15
    v_mov_b32 v15, s23
    s_mov_b32 exec_lo, -1
K2_CB0:
    s_bitcmp0_b32 s73, 0
    s_cbranch_scc1 K2_CB1
    s_waitcnt vmcnt(22)
    v_max3_u32 v9, v16, v17, v18
    v_max3_u32 v10, v19, v20, v21
    v_max3_u32 v9, v9, v22, v23
    v_max_u32 v9, v9, v10
    v_cmp_eq_u32 vcc, -1, v9
    s_nop 1
    s_cbranch_vccnz K2_CB1
    s_bitset0_b32 s73, 0
    v_mfma_f32_16x16x32_bf16 v[64:67], v[92:95], v[16:19], v[64:67]
    v_mfma_f32_16x16x32_bf16 v[68:71], v[96:99], v[16:19], v[68:71]
    v_mfma_f32_16x16x32_bf16 v[72:75], v[100:103], v[16:19], v[72:75]
    v_mfma_f32_16x16x32_bf16 v[76:79], v[92:95], v[20:23], v[76:79]
    v_mfma_f32_16x16x32_bf16 v[80:83], v[96:99], v[20:23], v[80:83]
    v_mfma_f32_16x16x32_bf16 v[84:87], v[100:103], v[20:23], v[84:87]
K2_CB1:
    s_bitcmp0_b32 s73, 1
    s_cbranch_scc1 K2_CB2
    s_waitcnt vmcnt(20)
    v_max3_u32 v9, v24, v25, v26
    v_max3_u32 v10, v27, v28, v29
    v_max3_u32 v9, v9, v30, v31
    v_max_u32 v9, v9, v10
    v_cmp_eq_u32 vcc, -1, v9
    s_nop 1
    s_cbranch_vccnz K2_CB2
    s_bitset0_b32 s73, 1
    v_mfma_f32_16x16x32_bf16 v[64:67], v[104:107], v[24:27], v[64:67]
    v_mfma_f32_16x16x32_bf16 v[68:71], v[108:111], v[24:27], v[68:71]
    v_mfma_f32_16x16x32_bf16 v[72:75], v[112:115], v[24:27], v[72:75]
    v_mfma_f32_16x16x32_bf16 v[76:79], v[104:107], v[28:31], v[76:79]
    v_mfma_f32_16x16x32_bf16 v[80:83], v[108:111], v[28:31], v[80:83]
    v_mfma_f32_16x16x32_bf16 v[84:87], v[112:115], v[28:31], v[84:87]
K2_CB2:
    s_bitcmp0_b32 s73, 2
    s_cbranch_scc1 K2_CB3
    s_waitcnt vmcnt(18)
    v_max3_u32 v9, v32, v33, v34
    v_max3_u32 v10, v35, v36, v37
    v_max3_u32 v9, v9, v38, v39
    v_max_u32 v9, v9, v10
    v_cmp_eq_u32 vcc, -1, v9
    s_nop 1
    s_cbranch_vccnz K2_CB3
    s_bitset0_b32 s73, 2
    v_mfma_f32_16x16x32_bf16 v[64:67], v[116:119], v[32:35], v[64:67]
    v_mfma_f32_16x16x32_bf16 v[68:71], v[120:123], v[32:35], v[68:71]
    v_mfma_f32_16x16x32_bf16 v[72:75], v[124:127], v[32:35], v[72:75]
    v_mfma_f32_16x16x32_bf16 v[76:79], v[116:119], v[36:39], v[76:79]
    v_mfma_f32_16x16x32_bf16 v[80:83], v[120:123], v[36:39], v[80:83]
    v_mfma_f32_16x16x32_bf16 v[84:87], v[124:127], v[36:39], v[84:87]
K2_CB3:
    s_bitcmp0_b32 s73, 3
    s_cbranch_scc1 K2_CB4
    s_waitcnt vmcnt(16)
    v_max3_u32 v9, v40, v41, v42
    v_max3_u32 v10, v43, v44, v45
    v_max3_u32 v9, v9, v46, v47
    v_max_u32 v9, v9, v10
    v_cmp_eq_u32 vcc, -1, v9
    s_nop 1
    s_cbranch_vccnz K2_CB4
    s_bitset0_b32 s73, 3
    v_mfma_f32_16x16x32_bf16 v[64:67], v[128:131], v[40:43], v[64:67]
    v_mfma_f32_16x16x32_bf16 v[68:71], v[132:135], v[40:43], v[68:71]
    v_mfma_f32_16x16x32_bf16 v[72:75], v[136:139], v[40:43], v[72:75]
    v_mfma_f32_16x16x32_bf16 v[76:79], v[128:131], v[44:47], v[76:79]
    v_mfma_f32_16x16x32_bf16 v[80:83], v[132:135], v[44:47], v[80:83]
    v_mfma_f32_16x16x32_bf16 v[84:87], v[136:139], v[44:47], v[84:87]
K2_CB4:
    s_bitcmp0_b32 s73, 4
    s_cbranch_scc1 K2_CB5
    s_waitcnt vmcnt(8)
    v_max3_u32 v9, v48, v49, v50
    v_max3_u32 v10, v51, v52, v53
    v_max3_u32 v9, v9, v54, v55
    v_max_u32 v9, v9, v10
    v_cmp_eq_u32 vcc, -1, v9
    s_nop 1
    s_cbranch_vccnz K2_CB5
    s_bitset0_b32 s73, 4
    v_mfma_f32_16x16x32_bf16 v[64:67], v[140:143], v[48:51], v[64:67]
    v_mfma_f32_16x16x32_bf16 v[68:71], v[144:147], v[48:51], v[68:71]
    v_mfma_f32_16x16x32_bf16 v[72:75], v[148:151], v[48:51], v[72:75]
    v_mfma_f32_16x16x32_bf16 v[76:79], v[140:143], v[52:55], v[76:79]
    v_mfma_f32_16x16x32_bf16 v[80:83], v[144:147], v[52:55], v[80:83]
    v_mfma_f32_16x16x32_bf16 v[84:87], v[148:151], v[52:55], v[84:87]
K2_CB5:
    s_bitcmp0_b32 s73, 5
    s_cbranch_scc1 K2_CB6
    s_waitcnt vmcnt(0)
    v_max3_u32 v9, v56, v57, v58
    v_max3_u32 v10, v59, v60, v61
    v_max3_u32 v9, v9, v62, v63
    v_max_u32 v9, v9, v10
    v_cmp_eq_u32 vcc, -1, v9
    s_nop 1
    s_cbranch_vccnz K2_CB6
    s_bitset0_b32 s73, 5
    v_mfma_f32_16x16x32_bf16 v[64:67], v[152:155], v[56:59], v[64:67]
    v_mfma_f32_16x16x32_bf16 v[68:71], v[156:159], v[56:59], v[68:71]
    v_mfma_f32_16x16x32_bf16 v[72:75], v[160:163], v[56:59], v[72:75]
    v_mfma_f32_16x16x32_bf16 v[76:79], v[152:155], v[60:63], v[76:79]
    v_mfma_f32_16x16x32_bf16 v[80:83], v[156:159], v[60:63], v[80:83]
    v_mfma_f32_16x16x32_bf16 v[84:87], v[160:163], v[60:63], v[84:87]
K2_CB6:
    s_cmp_eq_u32 s73, 0
    s_cbranch_scc1 K2_E
    s_sub_u32 s72, s72, 1
    s_cbranch_scc1 K2_E
    s_sleep 3
    s_bitcmp0_b32 s73, 0
    s_cbranch_scc1 K2_RB0
    buffer_load_dwordx4 v[16:19], v5, s[44:47], s59 offen offset:0 sc1
    buffer_load_dwordx4 v[20:23], v5, s[44:47], s59 offen offset:256 sc1
K2_RB0:
    s_bitcmp0_b32 s73, 1
    s_cbranch_scc1 K2_RB1
    buffer_load_dwordx4 v[24:27], v5, s[44:47], s59 offen offset:2048 sc1
    buffer_load_dwordx4 v[28:31], v5, s[44:47], s59 offen offset:2304 sc1
K2_RB1:
    s_bitcmp0_b32 s73, 2
    s_cbranch_scc1 K2_RB2
    buffer_load_dwordx4 v[32:35], v5, s[44:47], s60 offen offset:0 sc1
    buffer_load_dwordx4 v[36:39], v5, s[44:47], s60 offen offset:256 sc1
K2_RB2:
    s_bitcmp0_b32 s73, 3
    s_cbranch_scc1 K2_RB3
    buffer_load_dwordx4 v[40:43], v5, s[44:47], s60 offen offset:2048 sc1
    buffer_load_dwordx4 v[44:47], v5, s[44:47], s60 offen offset:2304 sc1
K2_RB3:
    s_bitcmp0_b32 s73, 4
    s_cbranch_scc1 K2_RB4
    buffer_load_dword v48, v6, s[44:47], s61 offen offset:0 sc1
    buffer_load_dword v49, v6, s[44:47], s61 offen offset:128 sc1
    buffer_load_dword v50, v6, s[44:47], s61 offen offset:256 sc1
    buffer_load_dword v51, v6, s[44:47], s61 offen offset:384 sc1
    buffer_load_dword v52, v6, s[44:47], s61 offen offset:64 sc1
    buffer_load_dword v53, v6, s[44:47], s61 offen offset:192 sc1
    buffer_load_dword v54, v6, s[44:47], s61 offen offset:320 sc1
    buffer_load_dword v55, v6, s[44:47], s61 offen offset:448 sc1
K2_RB4:
    s_bitcmp0_b32 s73, 5
    s_cbranch_scc1 K2_RB5
    buffer_load_dword v56, v6, s[44:47], s61 offen offset:2048 sc1
    buffer_load_dword v57, v6, s[44:47], s61 offen offset:2176 sc1
    buffer_load_dword v58, v6, s[44:47], s61 offen offset:2304 sc1
    buffer_load_dword v59, v6, s[44:47], s61 offen offset:2432 sc1
    buffer_load_dword v60, v6, s[44:47], s61 offen offset:2112 sc1
    buffer_load_dword v61, v6, s[44:47], s61 offen offset:2240 sc1
    buffer_load_dword v62, v6, s[44:47], s61 offen offset:2368 sc1
    buffer_load_dword v63, v6, s[44:47], s61 offen offset:2496 sc1
K2_RB5:
    s_waitcnt vmcnt(0)
    s_branch K2_CB0
K2_E:
    s_nop 4
    ds_write_b128 v11, v[64:67] offset:0
    ds_write_b128 v11, v[68:71] offset:64
    ds_write_b128 v11, v[72:75] offset:128
    ds_write_b128 v11, v[76:79] offset:9472
    ds_write_b128 v11, v[80:83] offset:9536
    ds_write_b128 v11, v[84:87] offset:9600
    v_lshlrev_b32 v40, 16, v164
    v_and_b32 v41, s74, v164
    v_lshlrev_b32 v42, 16, v165
    v_and_b32 v43, s74, v165
    v_lshlrev_b32 v44, 16, v166
    v_and_b32 v45, s74, v166
    v_lshlrev_b32 v46, 16, v167
    v_and_b32 v47, s74, v167
    v_lshlrev_b32 v48, 16, v88
    v_and_b32 v49, s74, v88
    v_lshlrev_b32 v50, 16, v89
    v_and_b32 v51, s74, v89
    v_lshlrev_b32 v52, 16, v90
    v_and_b32 v53, s74, v90
    v_lshlrev_b32 v54, 16, v91
    v_and_b32 v55, s74, v91
    v_lshlrev_b32 v56, 16, v12
    v_and_b32 v57, s74, v12
    v_lshlrev_b32 v58, 16, v13
    v_and_b32 v59, s74, v13
    v_lshlrev_b32 v60, 16, v14
    v_and_b32 v61, s74, v14
    v_lshlrev_b32 v62, 16, v15
    v_and_b32 v63, s74, v15
    v_lshlrev_b32 v5, 3, v3
    v_lshlrev_b32 v4, 3, v1
    s_lshl_b32 s30, s58, 9
    v_add_u32 v6, s30, v4
    s_waitcnt lgkmcnt(0)
    s_barrier
    ds_read_b128 v[16:19], v7 offset:0
    ds_read_b128 v[20:23], v7 offset:16
    ds_read_b128 v[24:27], v7 offset:18944
    ds_read_b128 v[28:31], v7 offset:18960
    ds_read_b128 v[32:35], v7 offset:37888
    ds_read_b128 v[36:39], v7 offset:37904
    s_waitcnt lgkmcnt(2)
    v_pk_add_f32 v[16:17], v[16:17], v[24:25]
    v_pk_add_f32 v[18:19], v[18:19], v[26:27]
    v_pk_add_f32 v[20:21], v[20:21], v[28:29]
    v_pk_add_f32 v[22:23], v[22:23], v[30:31]
    s_waitcnt lgkmcnt(0)
    v_pk_add_f32 v[16:17], v[16:17], v[32:33]
    v_pk_add_f32 v[18:19], v[18:19], v[34:35]
    v_pk_add_f32 v[20:21], v[20:21], v[36:37]
    v_pk_add_f32 v[22:23], v[22:23], v[38:39]
    v_pk_fma_f32 v[40:41], v[16:17], v[48:49], v[40:41]
    v_pk_fma_f32 v[42:43], v[18:19], v[50:51], v[42:43]
    v_pk_fma_f32 v[44:45], v[20:21], v[52:53], v[44:45]
    v_pk_fma_f32 v[46:47], v[22:23], v[54:55], v[46:47]
    v_cvt_pk_bf16_f32 v164, v40, v41
    v_cvt_pk_bf16_f32 v165, v42, v43
    v_cvt_pk_bf16_f32 v166, v44, v45
    v_cvt_pk_bf16_f32 v167, v46, v47
    v_lshlrev_b32 v40, 16, v164
    v_and_b32 v41, s74, v164
    v_lshlrev_b32 v42, 16, v165
    v_and_b32 v43, s74, v165
    v_lshlrev_b32 v44, 16, v166
    v_and_b32 v45, s74, v166
    v_lshlrev_b32 v46, 16, v167
    v_and_b32 v47, s74, v167
    v_pk_mul_f32 v[56:57], v[40:41], v[56:57]
    v_pk_mul_f32 v[58:59], v[42:43], v[58:59]
    v_pk_mul_f32 v[60:61], v[44:45], v[60:61]
    v_pk_mul_f32 v[62:63], v[46:47], v[62:63]
    v_cvt_pk_bf16_f32 v12, v56, v57
    v_cvt_pk_bf16_f32 v13, v58, v59
    v_cvt_pk_bf16_f32 v14, v60, v61
    v_cvt_pk_bf16_f32 v15, v62, v63
    buffer_store_dwordx4 v[12:15], v2, s[32:35], s69 offen sc1
    v_pk_add_f32 v[16:17], v[40:41], v[42:43]
    v_pk_mul_f32 v[18:19], v[40:41], v[40:41]
    v_pk_add_f32 v[16:17], v[16:17], v[44:45]
    v_pk_fma_f32 v[18:19], v[42:43], v[42:43], v[18:19]
    v_pk_add_f32 v[16:17], v[16:17], v[46:47]
    v_pk_fma_f32 v[18:19], v[44:45], v[44:45], v[18:19]
    v_add_f32 v16, v16, v17
    v_pk_fma_f32 v[18:19], v[46:47], v[46:47], v[18:19]
    v_add_f32 v17, v18, v19
    ds_write_b64 v6, v[16:17] offset:56832
    buffer_store_dwordx4 v[164:167], v2, s[32:35], s68 offen sc1
    s_cmp_lg_u32 s6, 0
    s_waitcnt lgkmcnt(0)
    s_barrier
    s_cbranch_scc1 K2_X
    ds_read_b64 v[16:17], v4 offset:56832
    ds_read_b64 v[18:19], v4 offset:57344
    ds_read_b64 v[20:21], v4 offset:57856
    ds_read_b64 v[22:23], v4 offset:58368
    ds_read_b64 v[24:25], v4 offset:58880
    ds_read_b64 v[26:27], v4 offset:59392
    ds_read_b64 v[28:29], v4 offset:59904
    ds_read_b64 v[30:31], v4 offset:60416
    ds_read_b64 v[32:33], v4 offset:60928
    s_waitcnt lgkmcnt(6)
    v_pk_add_f32 v[16:17], v[16:17], v[18:19]
    v_pk_add_f32 v[16:17], v[16:17], v[20:21]
    s_waitcnt lgkmcnt(4)
    v_pk_add_f32 v[16:17], v[16:17], v[22:23]
    v_pk_add_f32 v[16:17], v[16:17], v[24:25]
    s_waitcnt lgkmcnt(2)
    v_pk_add_f32 v[16:17], v[16:17], v[26:27]
    v_pk_add_f32 v[16:17], v[16:17], v[28:29]
    s_waitcnt lgkmcnt(0)
    v_pk_add_f32 v[16:17], v[16:17], v[30:31]
    v_pk_add_f32 v[16:17], v[16:17], v[32:33]
    v_mov_b32 v18, v16
    v_mov_b32 v19, v17
    s_nop 0
    v_permlane32_swap_b32 v16, v18
    v_permlane32_swap_b32 v17, v19
    v_pk_add_f32 v[16:17], v[16:17], v[18:19]
    s_mov_b32 exec_hi, 0
    buffer_store_dwordx2 v[16:17], v5, s[36:39], s70 offen sc1
K2_X:
    s_endpgm
K2_SYNC:
    s_cmp_eq_u32 s40, 1
    s_cbranch_scc1 K2_S1
    s_cmp_eq_u32 s40, 2
    s_cbranch_scc1 K2_S2
    s_cmp_eq_u32 s40, 3
    s_cbranch_scc1 K2_S3
    s_cmp_eq_u32 s40, 4
    s_cbranch_scc1 K2_S4
    s_cmp_eq_u32 s40, 5
    s_cbranch_scc1 K2_S5
    s_cmp_eq_u32 s40, 6
    s_cbranch_scc1 K2_S6
    s_cmp_eq_u32 s40, 7
    s_cbranch_scc1 K2_S7
    s_setprio 0
    s_branch K2_BACK
K2_S2:
    s_cmp_lt_u32 s6, 4
    s_cbranch_scc1 K2_BACK
    buffer_load_dwordx4 v[92:95], v2, s[52:55], s57 offen offset:0
    buffer_load_dwordx4 v[96:99], v2, s[52:55], s57 offen offset:1024
    buffer_load_dwordx4 v[100:103], v2, s[52:55], s57 offen offset:2048
    s_add_u32 s57, s57, 9216
    s_branch K2_BACK
K2_S3:
    s_cmp_lt_u32 s6, 4
    s_cbranch_scc1 K2_BACK
    buffer_load_dwordx4 v[104:107], v2, s[52:55], s57 offen offset:0
    buffer_load_dwordx4 v[108:111], v2, s[52:55], s57 offen offset:1024
    buffer_load_dwordx4 v[112:115], v2, s[52:55], s57 offen offset:2048
    s_add_u32 s57, s57, 9216
    s_branch K2_BACK
K2_S4:
    s_setprio 2
    s_cmp_lt_u32 s6, 4
    s_cbranch_scc1 K2_BACK
    buffer_load_dwordx4 v[116:119], v2, s[52:55], s57 offen offset:0
    buffer_load_dwordx4 v[120:123], v2, s[52:55], s57 offen offset:1024
    buffer_load_dwordx4 v[124:127], v2, s[52:55], s57 offen offset:2048
    s_add_u32 s57, s57, 9216
    s_branch K2_BACK
K2_S5:
    v_lshrrev_b32 v164, 5, v1
    v_mul_u32_u24 v4, 288, v3
    v_lshl_add_u32 v4, v164, 4, v4
    buffer_load_dwordx4 v[164:167], v4, s[64:67], s62 offen
    s_cmp_lt_u32 s6, 4
    s_cbranch_scc1 K2_BACK
    buffer_load_dwordx4 v[128:131], v2, s[52:55], s57 offen offset:0
    buffer_load_dwordx4 v[132:135], v2, s[52:55], s57 offen offset:1024
    buffer_load_dwordx4 v[136:139], v2, s[52:55], s57 offen offset:2048
    s_add_u32 s57, s57, 9216
    s_branch K2_BACK
K2_S6:
    s_setprio 1
    s_cmp_lt_u32 s6, 4
    s_cbranch_scc1 K2_BACK
    buffer_load_dwordx4 v[140:143], v2, s[52:55], s57 offen offset:0
    buffer_load_dwordx4 v[144:147], v2, s[52:55], s57 offen offset:1024
    buffer_load_dwordx4 v[148:151], v2, s[52:55], s57 offen offset:2048
    s_add_u32 s57, s57, 9216
    s_branch K2_BACK
K2_S7:
    s_setprio 0
    s_cmp_lt_u32 s6, 4
    s_cbranch_scc1 K2_BACK
    buffer_load_dwordx4 v[152:155], v2, s[52:55], s57 offen offset:0
    buffer_load_dwordx4 v[156:159], v2, s[52:55], s57 offen offset:1024
    buffer_load_dwordx4 v[160:163], v2, s[52:55], s57 offen offset:2048
    s_add_u32 s57, s57, 9216
    s_branch K2_BACK
K2_S1:
    ds_read_u16 v4, v7 offset:1542
    s_waitcnt lgkmcnt(0)
    v_readfirstlane_b32 s26, v4
    s_nop 0
    s_cmp_eq_u32 s26, 0
    s_cbranch_scc1 K2_S1_X
    s_sleep 0
    s_branch K2_S1
K2_S1_X:
    s_branch K2_BACK
K2_HELP:
    v_mov_b32 v7, 0
    s_cmp_lg_u32 s6, 10
    s_cbranch_scc1 K2_HJ
    s_setprio 0
    s_add_u32 s36, s28, 9437184
    s_addc_u32 s37, s29, 0
    s_add_u32 s5, s5, 24576
    s_mov_b32 m0, 24576
    s_nop 0
    buffer_load_dwordx4 v2, s[36:39], s5 offen offset:0 lds
    buffer_load_dwordx4 v2, s[36:39], s5 offen offset:1024 lds
    buffer_load_dwordx4 v2, s[36:39], s5 offen offset:2048 lds
    buffer_load_dwordx4 v2, s[36:39], s5 offen offset:3072 lds
    s_mov_b32 m0, 28672
    s_add_u32 s5, s5, 4096
    buffer_load_dwordx4 v2, s[36:39], s5 offen offset:0 lds
    buffer_load_dwordx4 v2, s[36:39], s5 offen offset:1024 lds
    buffer_load_dwordx4 v2, s[36:39], s5 offen offset:2048 lds
    buffer_load_dwordx4 v2, s[36:39], s5 offen offset:3072 lds
    s_mov_b32 m0, 32768
    s_add_u32 s5, s5, 4096
    buffer_load_dwordx4 v2, s[36:39], s5 offen offset:0 lds
    buffer_load_dwordx4 v2, s[36:39], s5 offen offset:1024 lds
    buffer_load_dwordx4 v2, s[36:39], s5 offen offset:2048 lds
    buffer_load_dwordx4 v2, s[36:39], s5 offen offset:3072 lds
    s_mov_b32 m0, 36864
    s_add_u32 s5, s5, 4096
    buffer_load_dwordx4 v2, s[36:39], s5 offen offset:0 lds
    buffer_load_dwordx4 v2, s[36:39], s5 offen offset:1024 lds
    buffer_load_dwordx4 v2, s[36:39], s5 offen offset:2048 lds
    buffer_load_dwordx4 v2, s[36:39], s5 offen offset:3072 lds
    s_mov_b32 m0, 40960
    s_add_u32 s5, s5, 4096
    buffer_load_dwordx4 v2, s[36:39], s5 offen offset:0 lds
    buffer_load_dwordx4 v2, s[36:39], s5 offen offset:1024 lds
    buffer_load_dwordx4 v2, s[36:39], s5 offen offset:2048 lds
    buffer_load_dwordx4 v2, s[36:39], s5 offen offset:3072 lds
    s_mov_b32 m0, 45056
    s_add_u32 s5, s5, 4096
    buffer_load_dwordx4 v2, s[36:39], s5 offen offset:0 lds
    buffer_load_dwordx4 v2, s[36:39], s5 offen offset:1024 lds
    buffer_load_dwordx4 v2, s[36:39], s5 offen offset:2048 lds
    buffer_load_dwordx4 v2, s[36:39], s5 offen offset:3072 lds
    s_mov_b32 m0, 49152
    s_add_u32 s5, s5, 4096
    buffer_load_dwordx4 v2, s[36:39], s5 offen offset:0 lds
    buffer_load_dwordx4 v2, s[36:39], s5 offen offset:1024 lds
    buffer_load_dwordx4 v2, s[36:39], s5 offen offset:2048 lds
    buffer_load_dwordx4 v2, s[36:39], s5 offen offset:3072 lds
    s_mov_b32 m0, 53248
    s_add_u32 s5, s5, 4096
    buffer_load_dwordx4 v2, s[36:39], s5 offen offset:0 lds
    buffer_load_dwordx4 v2, s[36:39], s5 offen offset:1024 lds
    buffer_load_dwordx4 v2, s[36:39], s5 offen offset:2048 lds
    buffer_load_dwordx4 v2, s[36:39], s5 offen offset:3072 lds
    s_mov_b32 m0, 57344
    s_add_u32 s5, s5, 4096
    buffer_load_dwordx4 v2, s[36:39], s5 offen offset:0 lds
    buffer_load_dwordx4 v2, s[36:39], s5 offen offset:1024 lds
    buffer_load_dwordx4 v2, s[36:39], s5 offen offset:2048 lds
    buffer_load_dwordx4 v2, s[36:39], s5 offen offset:3072 lds
    s_mov_b32 m0, 61440
    s_add_u32 s5, s5, 4096
    buffer_load_dwordx4 v2, s[36:39], s5 offen offset:0 lds
    buffer_load_dwordx4 v2, s[36:39], s5 offen offset:1024 lds
    buffer_load_dwordx4 v2, s[36:39], s5 offen offset:2048 lds
    buffer_load_dwordx4 v2, s[36:39], s5 offen offset:3072 lds
    s_mov_b32 m0, 65536
    s_add_u32 s5, s5, 4096
    buffer_load_dwordx4 v2, s[36:39], s5 offen offset:0 lds
    buffer_load_dwordx4 v2, s[36:39], s5 offen offset:1024 lds
    buffer_load_dwordx4 v2, s[36:39], s5 offen offset:2048 lds
    buffer_load_dwordx4 v2, s[36:39], s5 offen offset:3072 lds
    s_mov_b32 m0, 69632
    s_add_u32 s5, s5, 4096
    buffer_load_dwordx4 v2, s[36:39], s5 offen offset:0 lds
    buffer_load_dwordx4 v2, s[36:39], s5 offen offset:1024 lds
    buffer_load_dwordx4 v2, s[36:39], s5 offen offset:2048 lds
    buffer_load_dwordx4 v2, s[36:39], s5 offen offset:3072 lds
    s_barrier
    s_setprio 3
    s_mov_b32 m0, 73728
    s_add_u32 s5, s5, 4096
    buffer_load_dwordx4 v2, s[36:39], s5 offen offset:0 lds
    buffer_load_dwordx4 v2, s[36:39], s5 offen offset:1024 lds
    buffer_load_dwordx4 v2, s[36:39], s5 offen offset:2048 lds
    buffer_load_dwordx4 v2, s[36:39], s5 offen offset:3072 lds
    s_mov_b32 m0, 77824
    s_add_u32 s5, s5, 4096
    buffer_load_dwordx4 v2, s[36:39], s5 offen offset:0 lds
    buffer_load_dwordx4 v2, s[36:39], s5 offen offset:1024 lds
    buffer_load_dwordx4 v2, s[36:39], s5 offen offset:2048 lds
    buffer_load_dwordx4 v2, s[36:39], s5 offen offset:3072 lds
    s_mov_b32 m0, 81920
    s_add_u32 s5, s5, 4096
    buffer_load_dwordx4 v2, s[36:39], s5 offen offset:0 lds
    buffer_load_dwordx4 v2, s[36:39], s5 offen offset:1024 lds
    buffer_load_dwordx4 v2, s[36:39], s5 offen offset:2048 lds
    buffer_load_dwordx4 v2, s[36:39], s5 offen offset:3072 lds
    s_mov_b32 m0, 86016
    s_add_u32 s5, s5, 4096
    buffer_load_dwordx4 v2, s[36:39], s5 offen offset:0 lds
    buffer_load_dwordx4 v2, s[36:39], s5 offen offset:1024 lds
    buffer_load_dwordx4 v2, s[36:39], s5 offen offset:2048 lds
    buffer_load_dwordx4 v2, s[36:39], s5 offen offset:3072 lds
    s_mov_b32 m0, 90112
    s_add_u32 s5, s5, 4096
    buffer_load_dwordx4 v2, s[36:39], s5 offen offset:0 lds
    buffer_load_dwordx4 v2, s[36:39], s5 offen offset:1024 lds
    buffer_load_dwordx4 v2, s[36:39], s5 offen offset:2048 lds
    buffer_load_dwordx4 v2, s[36:39], s5 offen offset:3072 lds
    s_mov_b32 m0, 94208
    s_add_u32 s5, s5, 4096
    buffer_load_dwordx4 v2, s[36:39], s5 offen offset:0 lds
    buffer_load_dwordx4 v2, s[36:39], s5 offen offset:1024 lds
    buffer_load_dwordx4 v2, s[36:39], s5 offen offset:2048 lds
    buffer_load_dwordx4 v2, s[36:39], s5 offen offset:3072 lds
    s_mov_b32 m0, 98304
    s_add_u32 s5, s5, 4096
    buffer_load_dwordx4 v2, s[36:39], s5 offen offset:0 lds
    buffer_load_dwordx4 v2, s[36:39], s5 offen offset:1024 lds
    buffer_load_dwordx4 v2, s[36:39], s5 offen offset:2048 lds
    buffer_load_dwordx4 v2, s[36:39], s5 offen offset:3072 lds
    s_mov_b32 m0, 102400
    s_add_u32 s5, s5, 4096
    buffer_load_dwordx4 v2, s[36:39], s5 offen offset:0 lds
    buffer_load_dwordx4 v2, s[36:39], s5 offen offset:1024 lds
    buffer_load_dwordx4 v2, s[36:39], s5 offen offset:2048 lds
    buffer_load_dwordx4 v2, s[36:39], s5 offen offset:3072 lds
    s_mov_b32 m0, 106496
    s_add_u32 s5, s5, 4096
    buffer_load_dwordx4 v2, s[36:39], s5 offen offset:0 lds
    buffer_load_dwordx4 v2, s[36:39], s5 offen offset:1024 lds
    buffer_load_dwordx4 v2, s[36:39], s5 offen offset:2048 lds
    buffer_load_dwordx4 v2, s[36:39], s5 offen offset:3072 lds
    s_mov_b32 m0, 110592
    s_add_u32 s5, s5, 4096
    buffer_load_dwordx4 v2, s[36:39], s5 offen offset:0 lds
    buffer_load_dwordx4 v2, s[36:39], s5 offen offset:1024 lds
    buffer_load_dwordx4 v2, s[36:39], s5 offen offset:2048 lds
    buffer_load_dwordx4 v2, s[36:39], s5 offen offset:3072 lds
    s_mov_b32 m0, 114688
    s_add_u32 s5, s5, 4096
    buffer_load_dwordx4 v2, s[36:39], s5 offen offset:0 lds
    buffer_load_dwordx4 v2, s[36:39], s5 offen offset:1024 lds
    buffer_load_dwordx4 v2, s[36:39], s5 offen offset:2048 lds
    buffer_load_dwordx4 v2, s[36:39], s5 offen offset:3072 lds
    s_mov_b32 m0, 118784
    s_add_u32 s5, s5, 4096
    buffer_load_dwordx4 v2, s[36:39], s5 offen offset:0 lds
    buffer_load_dwordx4 v2, s[36:39], s5 offen offset:1024 lds
    buffer_load_dwordx4 v2, s[36:39], s5 offen offset:2048 lds
    buffer_load_dwordx4 v2, s[36:39], s5 offen offset:3072 lds
    s_mov_b32 m0, 122880
    s_add_u32 s5, s5, 4096
    buffer_load_dwordx4 v2, s[36:39], s5 offen offset:0 lds
    buffer_load_dwordx4 v2, s[36:39], s5 offen offset:1024 lds
    buffer_load_dwordx4 v2, s[36:39], s5 offen offset:2048 lds
    buffer_load_dwordx4 v2, s[36:39], s5 offen offset:3072 lds
    s_mov_b32 m0, 126976
    s_add_u32 s5, s5, 4096
    buffer_load_dwordx4 v2, s[36:39], s5 offen offset:0 lds
    buffer_load_dwordx4 v2, s[36:39], s5 offen offset:1024 lds
    buffer_load_dwordx4 v2, s[36:39], s5 offen offset:2048 lds
    buffer_load_dwordx4 v2, s[36:39], s5 offen offset:3072 lds
    s_mov_b32 m0, 131072
    s_add_u32 s5, s5, 4096
    buffer_load_dwordx4 v2, s[36:39], s5 offen offset:0 lds
    buffer_load_dwordx4 v2, s[36:39], s5 offen offset:1024 lds
    buffer_load_dwordx4 v2, s[36:39], s5 offen offset:2048 lds
    buffer_load_dwordx4 v2, s[36:39], s5 offen offset:3072 lds
    s_mov_b32 m0, 135168
    s_add_u32 s5, s5, 4096
    buffer_load_dwordx4 v2, s[36:39], s5 offen offset:0 lds
    buffer_load_dwordx4 v2, s[36:39], s5 offen offset:1024 lds
    buffer_load_dwordx4 v2, s[36:39], s5 offen offset:2048 lds
    buffer_load_dwordx4 v2, s[36:39], s5 offen offset:3072 lds
    s_mov_b32 m0, 139264
    s_add_u32 s5, s5, 4096
    buffer_load_dwordx4 v2, s[36:39], s5 offen offset:0 lds
    buffer_load_dwordx4 v2, s[36:39], s5 offen offset:1024 lds
    buffer_load_dwordx4 v2, s[36:39], s5 offen offset:2048 lds
    buffer_load_dwordx4 v2, s[36:39], s5 offen offset:3072 lds
    s_mov_b32 m0, 143360
    s_add_u32 s5, s5, 4096
    buffer_load_dwordx4 v2, s[36:39], s5 offen offset:0 lds
    buffer_load_dwordx4 v2, s[36:39], s5 offen offset:1024 lds
    buffer_load_dwordx4 v2, s[36:39], s5 offen offset:2048 lds
    buffer_load_dwordx4 v2, s[36:39], s5 offen offset:3072 lds
    s_mov_b32 m0, 147456
    s_add_u32 s5, s5, 4096
    buffer_load_dwordx4 v2, s[36:39], s5 offen offset:0 lds
    buffer_load_dwordx4 v2, s[36:39], s5 offen offset:1024 lds
    buffer_load_dwordx4 v2, s[36:39], s5 offen offset:2048 lds
    buffer_load_dwordx4 v2, s[36:39], s5 offen offset:3072 lds
    s_mov_b32 m0, 151552
    s_add_u32 s5, s5, 4096
    buffer_load_dwordx4 v2, s[36:39], s5 offen offset:0 lds
    buffer_load_dwordx4 v2, s[36:39], s5 offen offset:1024 lds
    buffer_load_dwordx4 v2, s[36:39], s5 offen offset:2048 lds
    buffer_load_dwordx4 v2, s[36:39], s5 offen offset:3072 lds
    s_waitcnt vmcnt(0)
    ds_write_b16 v7, v7 offset:1542
    s_endpgm
K2_HJ:
    s_setprio 2
    s_cmp_eq_u32 s6, 11
    s_cbranch_scc1 K2_H3
    s_mov_b32 s32, s16
    s_mov_b32 s33, s17
    s_mov_b32 s34, 5308416
    s_mov_b32 s35, 0x20000
    s_mov_b32 s40, s18
    s_mov_b32 s41, s19
    s_mov_b32 s42, 5308416
    s_mov_b32 s43, 0x20000
    s_add_u32 s44, s28, 24641536
    s_addc_u32 s45, s29, 0
    s_mov_b32 s46, 73728
    s_mov_b32 s47, 0x20000
    s_add_u32 s52, s28, 81920
    s_addc_u32 s53, s29, 0
    s_mov_b32 s54, 6912
    s_mov_b32 s55, 0x20000
    s_add_u32 s56, s28, 54525952
    s_addc_u32 s57, s29, 0
    s_mov_b32 s58, 16842752
    s_mov_b32 s59, 0x20000
    v_lshrrev_b32 v4, 4, v1
    v_bfe_u32 v5, v1, 2, 2
    v_and_b32 v6, 3, v1
    s_and_b32 s3, s2, 7
    s_lshr_b32 s4, s2, 3
    s_sub_u32 s31, s6, 8
    s_lshr_b32 s5, s3, 1
    s_mul_i32 s5, s5, 18
    s_add_u32 s5, s5, s4
    s_lshl_b32 s64, s5, 7
    s_mul_i32 s7, s31, 2654208
    s_add_u32 s64, s64, s7
    s_lshl_b32 s61, s5, 10
    s_mul_i32 s65, s5, 73728
    s_and_b32 s7, s3, 1
    s_mul_i32 s7, s7, 5308416
    s_add_u32 s65, s65, s7
    s_mul_i32 s7, s31, 18432
    s_add_u32 s65, s65, s7
    s_mul_i32 s60, s31, 576
    s_lshl_b32 s62, s31, 12
    s_add_u32 s62, s62, 155648
    v_lshrrev_b32 v19, 1, v6
    v_mul_u32_u24 v19, 1152, v19
    v_sub_u32 v19, 4608, v19
    v_lshl_add_u32 v19, v5, 5, v19
    v_lshrrev_b32 v8, 1, v4
    v_lshl_add_u32 v19, v8, 4, v19
    v_xor_b32 v9, v4, v6
    v_and_b32 v9, 1, v9
    v_and_b32 v10, 2, v5
    v_or_b32 v9, v9, v10
    v_lshl_add_u32 v19, v9, 20, v19
    v_lshrrev_b32 v9, 3, v1
    v_and_b32 v10, 7, v1
    v_lshlrev_b32 v10, 4, v10
    v_mad_u32_u24 v11, v9, 36, 0
    v_lshl_add_u32 v12, v11, 8, v10
    v_lshl_add_u32 v13, v11, 5, v10
    v_and_b32 v9, 3, v9
    v_lshlrev_b32 v9, 5, v9
    v_xor_b32 v14, v9, v2
    v_add_u32 v14, s62, v14
    v_and_b32 v4, 1, v4
    v_lshlrev_b32 v9, 5, v5
    v_lshl_add_u32 v10, v8, 3, v5
    v_lshlrev_b32 v10, 7, v10
    v_lshl_add_u32 v10, v4, 5, v10
    v_lshl_add_u32 v10, v6, 3, v10
    v_xor_b32 v10, v9, v10
    v_add_u32 v15, s62, v10
    v_xor_b32 v16, 64, v15
    v_lshl_add_u32 v10, v8, 4, v5
    v_lshl_add_u32 v10, v4, 2, v10
    v_lshlrev_b32 v10, 7, v10
    v_add_u32 v10, s62, v10
    v_lshl_add_u32 v17, v6, 4, v10
    v_xor_b32 v17, v9, v17
    v_xor_b32 v18, 64, v17
    v_lshl_add_u32 v20, v6, 3, v10
    v_xor_b32 v20, v9, v20
    v_xor_b32 v21, 32, v20
    v_xor_b32 v22, 64, v20
    v_xor_b32 v23, 64, v21
    s_barrier
K2_HW:
    ds_read_u16 v4, v7 offset:1542
    s_waitcnt lgkmcnt(0)
    v_readfirstlane_b32 s26, v4
    s_nop 0
    s_cmp_eq_u32 s26, 0
    s_cbranch_scc1 K2_HW_X
    s_sleep 4
    s_branch K2_HW
K2_HW_X:
    s_cmp_ge_u32 s4, 18
    s_cbranch_scc1 K2_H2
    s_add_u32 s30, s64, 0
    buffer_load_dwordx4 v[24:27], v12, s[32:35], s30 offen nt
    s_add_u32 s30, s64, 73728
    buffer_load_dwordx4 v[28:31], v12, s[32:35], s30 offen nt
    s_add_u32 s30, s64, 147456
    buffer_load_dwordx4 v[32:35], v12, s[32:35], s30 offen nt
    s_add_u32 s30, s64, 221184
    buffer_load_dwordx4 v[36:39], v12, s[32:35], s30 offen nt
    buffer_load_dwordx4 v[40:43], v19, s[52:55], s60 offen offset:0
    s_add_u32 s30, s64, 294912
    buffer_load_dwordx4 v[44:47], v12, s[32:35], s30 offen nt
    s_add_u32 s30, s64, 368640
    buffer_load_dwordx4 v[48:51], v12, s[32:35], s30 offen nt
    s_add_u32 s30, s64, 442368
    buffer_load_dwordx4 v[52:55], v12, s[32:35], s30 offen nt
    s_add_u32 s30, s64, 516096
    buffer_load_dwordx4 v[56:59], v12, s[32:35], s30 offen nt
    buffer_load_dwordx4 v[60:63], v19, s[52:55], s60 offen offset:64
    s_add_u32 s30, s64, 589824
    buffer_load_dwordx4 v[64:67], v12, s[32:35], s30 offen nt
    s_add_u32 s30, s64, 663552
    buffer_load_dwordx4 v[68:71], v12, s[32:35], s30 offen nt
    s_add_u32 s30, s64, 737280
    buffer_load_dwordx4 v[72:75], v12, s[32:35], s30 offen nt
    s_add_u32 s30, s64, 811008
    buffer_load_dwordx4 v[76:79], v12, s[32:35], s30 offen nt
    buffer_load_dwordx4 v[80:83], v19, s[52:55], s60 offen offset:128
    s_add_u32 s30, s64, 884736
    buffer_load_dwordx4 v[84:87], v12, s[32:35], s30 offen nt
    s_add_u32 s30, s64, 958464
    buffer_load_dwordx4 v[88:91], v12, s[32:35], s30 offen nt
    s_add_u32 s30, s64, 1032192
    buffer_load_dwordx4 v[92:95], v12, s[32:35], s30 offen nt
    s_add_u32 s30, s64, 1105920
    buffer_load_dwordx4 v[96:99], v12, s[32:35], s30 offen nt
    buffer_load_dwordx4 v[100:103], v19, s[52:55], s60 offen offset:192
    s_add_u32 s30, s64, 1179648
    buffer_load_dwordx4 v[104:107], v12, s[32:35], s30 offen nt
    s_add_u32 s30, s64, 1253376
    buffer_load_dwordx4 v[108:111], v12, s[32:35], s30 offen nt
    s_add_u32 s30, s64, 1327104
    buffer_load_dwordx4 v[112:115], v12, s[32:35], s30 offen nt
    s_add_u32 s30, s64, 1400832
    buffer_load_dwordx4 v[116:119], v12, s[32:35], s30 offen nt
    buffer_load_dwordx4 v[120:123], v19, s[52:55], s60 offen offset:256
    s_add_u32 s30, s64, 1474560
    buffer_load_dwordx4 v[124:127], v12, s[32:35], s30 offen nt
    s_add_u32 s30, s64, 1548288
    buffer_load_dwordx4 v[128:131], v12, s[32:35], s30 offen nt
    s_add_u32 s30, s64, 1622016
    buffer_load_dwordx4 v[132:135], v12, s[32:35], s30 offen nt
    s_add_u32 s30, s64, 1695744
    buffer_load_dwordx4 v[136:139], v12, s[32:35], s30 offen nt
    buffer_load_dwordx4 v[140:143], v19, s[52:55], s60 offen offset:320
    s_waitcnt vmcnt(25)
    ds_write_b128 v14, v[24:27] offset:0
    ds_write_b128 v14, v[28:31] offset:1024
    ds_write_b128 v14, v[32:35] offset:2048
    ds_write_b128 v14, v[36:39] offset:3072
    s_waitcnt lgkmcnt(0)
    ds_read_b64_tr_b16 v[24:25], v15 offset:0
    ds_read_b64_tr_b16 v[26:27], v15 offset:512
    ds_read_b64_tr_b16 v[28:29], v16 offset:0
    ds_read_b64_tr_b16 v[30:31], v16 offset:512
    ds_read_b64_tr_b16 v[32:33], v15 offset:2048
    ds_read_b64_tr_b16 v[34:35], v15 offset:2560
    ds_read_b64_tr_b16 v[36:37], v16 offset:2048
    ds_read_b64_tr_b16 v[38:39], v16 offset:2560
    s_add_u32 s30, s65, 0
    s_waitcnt lgkmcnt(6)
    buffer_store_dwordx4 v[24:27], v2, s[56:59], s30 offen sc1
    v_mfma_f32_16x16x32_bf16 v[148:151], v[40:43], v[24:27], 0
    s_add_u32 s30, s65, 36864
    s_waitcnt lgkmcnt(4)
    buffer_store_dwordx4 v[28:31], v2, s[56:59], s30 offen sc1
    v_mfma_f32_16x16x32_bf16 v[152:155], v[40:43], v[28:31], 0
    s_add_u32 s30, s65, 1024
    s_waitcnt lgkmcnt(2)
    buffer_store_dwordx4 v[32:35], v2, s[56:59], s30 offen sc1
    v_mfma_f32_16x16x32_bf16 v[156:159], v[40:43], v[32:35], 0
    s_add_u32 s30, s65, 37888
    s_waitcnt lgkmcnt(0)
    buffer_store_dwordx4 v[36:39], v2, s[56:59], s30 offen sc1
    v_mfma_f32_16x16x32_bf16 v[160:163], v[40:43], v[36:39], 0
    s_add_u32 s30, s64, 1769472
    buffer_load_dwordx4 v[24:27], v12, s[32:35], s30 offen nt
    s_add_u32 s30, s64, 1843200
    buffer_load_dwordx4 v[28:31], v12, s[32:35], s30 offen nt
    s_add_u32 s30, s64, 1916928
    buffer_load_dwordx4 v[32:35], v12, s[32:35], s30 offen nt
    s_add_u32 s30, s64, 1990656
    buffer_load_dwordx4 v[36:39], v12, s[32:35], s30 offen nt
    buffer_load_dwordx4 v[40:43], v19, s[52:55], s60 offen offset:384
    s_waitcnt vmcnt(29)
    ds_write_b128 v14, v[44:47] offset:0
    ds_write_b128 v14, v[48:51] offset:1024
    ds_write_b128 v14, v[52:55] offset:2048
    ds_write_b128 v14, v[56:59] offset:3072
    s_waitcnt lgkmcnt(0)
    ds_read_b64_tr_b16 v[44:45], v15 offset:0
    ds_read_b64_tr_b16 v[46:47], v15 offset:512
    ds_read_b64_tr_b16 v[48:49], v16 offset:0
    ds_read_b64_tr_b16 v[50:51], v16 offset:512
    ds_read_b64_tr_b16 v[52:53], v15 offset:2048
    ds_read_b64_tr_b16 v[54:55], v15 offset:2560
    ds_read_b64_tr_b16 v[56:57], v16 offset:2048
    ds_read_b64_tr_b16 v[58:59], v16 offset:2560
    s_add_u32 s30, s65, 2048
    s_waitcnt lgkmcnt(6)
    buffer_store_dwordx4 v[44:47], v2, s[56:59], s30 offen sc1
    v_mfma_f32_16x16x32_bf16 v[148:151], v[60:63], v[44:47], v[148:151]
    s_add_u32 s30, s65, 38912
    s_waitcnt lgkmcnt(4)
    buffer_store_dwordx4 v[48:51], v2, s[56:59], s30 offen sc1
    v_mfma_f32_16x16x32_bf16 v[152:155], v[60:63], v[48:51], v[152:155]
    s_add_u32 s30, s65, 3072
    s_waitcnt lgkmcnt(2)
    buffer_store_dwordx4 v[52:55], v2, s[56:59], s30 offen sc1
    v_mfma_f32_16x16x32_bf16 v[156:159], v[60:63], v[52:55], v[156:159]
    s_add_u32 s30, s65, 39936
    s_waitcnt lgkmcnt(0)
    buffer_store_dwordx4 v[56:59], v2, s[56:59], s30 offen sc1
    v_mfma_f32_16x16x32_bf16 v[160:163], v[60:63], v[56:59], v[160:163]
    s_add_u32 s30, s64, 2064384
    buffer_load_dwordx4 v[44:47], v12, s[32:35], s30 offen nt
    s_add_u32 s30, s64, 2138112
    buffer_load_dwordx4 v[48:51], v12, s[32:35], s30 offen nt
    s_add_u32 s30, s64, 2211840
    buffer_load_dwordx4 v[52:55], v12, s[32:35], s30 offen nt
    s_add_u32 s30, s64, 2285568
    buffer_load_dwordx4 v[56:59], v12, s[32:35], s30 offen nt
    buffer_load_dwordx4 v[60:63], v19, s[52:55], s60 offen offset:448
    s_waitcnt vmcnt(33)
    ds_write_b128 v14, v[64:67] offset:0
    ds_write_b128 v14, v[68:71] offset:1024
    ds_write_b128 v14, v[72:75] offset:2048
    ds_write_b128 v14, v[76:79] offset:3072
    s_waitcnt lgkmcnt(0)
    ds_read_b64_tr_b16 v[64:65], v15 offset:0
    ds_read_b64_tr_b16 v[66:67], v15 offset:512
    ds_read_b64_tr_b16 v[68:69], v16 offset:0
    ds_read_b64_tr_b16 v[70:71], v16 offset:512
    ds_read_b64_tr_b16 v[72:73], v15 offset:2048
    ds_read_b64_tr_b16 v[74:75], v15 offset:2560
    ds_read_b64_tr_b16 v[76:77], v16 offset:2048
    ds_read_b64_tr_b16 v[78:79], v16 offset:2560
    s_add_u32 s30, s65, 4096
    s_waitcnt lgkmcnt(6)
    buffer_store_dwordx4 v[64:67], v2, s[56:59], s30 offen sc1
    v_mfma_f32_16x16x32_bf16 v[148:151], v[80:83], v[64:67], v[148:151]
    s_add_u32 s30, s65, 40960
    s_waitcnt lgkmcnt(4)
    buffer_store_dwordx4 v[68:71], v2, s[56:59], s30 offen sc1
    v_mfma_f32_16x16x32_bf16 v[152:155], v[80:83], v[68:71], v[152:155]
    s_add_u32 s30, s65, 5120
    s_waitcnt lgkmcnt(2)
    buffer_store_dwordx4 v[72:75], v2, s[56:59], s30 offen sc1
    v_mfma_f32_16x16x32_bf16 v[156:159], v[80:83], v[72:75], v[156:159]
    s_add_u32 s30, s65, 41984
    s_waitcnt lgkmcnt(0)
    buffer_store_dwordx4 v[76:79], v2, s[56:59], s30 offen sc1
    v_mfma_f32_16x16x32_bf16 v[160:163], v[80:83], v[76:79], v[160:163]
    s_add_u32 s30, s64, 2359296
    buffer_load_dwordx4 v[64:67], v12, s[32:35], s30 offen nt
    s_add_u32 s30, s64, 2433024
    buffer_load_dwordx4 v[68:71], v12, s[32:35], s30 offen nt
    s_add_u32 s30, s64, 2506752
    buffer_load_dwordx4 v[72:75], v12, s[32:35], s30 offen nt
    s_add_u32 s30, s64, 2580480
    buffer_load_dwordx4 v[76:79], v12, s[32:35], s30 offen nt
    buffer_load_dwordx4 v[80:83], v19, s[52:55], s60 offen offset:512
    s_waitcnt vmcnt(37)
    ds_write_b128 v14, v[84:87] offset:0
    ds_write_b128 v14, v[88:91] offset:1024
    ds_write_b128 v14, v[92:95] offset:2048
    ds_write_b128 v14, v[96:99] offset:3072
    s_waitcnt lgkmcnt(0)
    ds_read_b64_tr_b16 v[84:85], v15 offset:0
    ds_read_b64_tr_b16 v[86:87], v15 offset:512
    ds_read_b64_tr_b16 v[88:89], v16 offset:0
    ds_read_b64_tr_b16 v[90:91], v16 offset:512
    ds_read_b64_tr_b16 v[92:93], v15 offset:2048
    ds_read_b64_tr_b16 v[94:95], v15 offset:2560
    ds_read_b64_tr_b16 v[96:97], v16 offset:2048
    ds_read_b64_tr_b16 v[98:99], v16 offset:2560
    s_add_u32 s30, s65, 6144
    s_waitcnt lgkmcnt(6)
    buffer_store_dwordx4 v[84:87], v2, s[56:59], s30 offen sc1
    v_mfma_f32_16x16x32_bf16 v[148:151], v[100:103], v[84:87], v[148:151]
    s_add_u32 s30, s65, 43008
    s_waitcnt lgkmcnt(4)
    buffer_store_dwordx4 v[88:91], v2, s[56:59], s30 offen sc1
    v_mfma_f32_16x16x32_bf16 v[152:155], v[100:103], v[88:91], v[152:155]
    s_add_u32 s30, s65, 7168
    s_waitcnt lgkmcnt(2)
    buffer_store_dwordx4 v[92:95], v2, s[56:59], s30 offen sc1
    v_mfma_f32_16x16x32_bf16 v[156:159], v[100:103], v[92:95], v[156:159]
    s_add_u32 s30, s65, 44032
    s_waitcnt lgkmcnt(0)
    buffer_store_dwordx4 v[96:99], v2, s[56:59], s30 offen sc1
    v_mfma_f32_16x16x32_bf16 v[160:163], v[100:103], v[96:99], v[160:163]
    s_waitcnt vmcnt(36)
    ds_write_b128 v14, v[104:107] offset:0
    ds_write_b128 v14, v[108:111] offset:1024
    ds_write_b128 v14, v[112:115] offset:2048
    ds_write_b128 v14, v[116:119] offset:3072
    s_waitcnt lgkmcnt(0)
    ds_read_b64_tr_b16 v[104:105], v15 offset:0
    ds_read_b64_tr_b16 v[106:107], v15 offset:512
    ds_read_b64_tr_b16 v[108:109], v16 offset:0
    ds_read_b64_tr_b16 v[110:111], v16 offset:512
    ds_read_b64_tr_b16 v[112:113], v15 offset:2048
    ds_read_b64_tr_b16 v[114:115], v15 offset:2560
    ds_read_b64_tr_b16 v[116:117], v16 offset:2048
    ds_read_b64_tr_b16 v[118:119], v16 offset:2560
    s_add_u32 s30, s65, 8192
    s_waitcnt lgkmcnt(6)
    buffer_store_dwordx4 v[104:107], v2, s[56:59], s30 offen sc1
    v_mfma_f32_16x16x32_bf16 v[148:151], v[120:123], v[104:107], v[148:151]
    s_add_u32 s30, s65, 45056
    s_waitcnt lgkmcnt(4)
    buffer_store_dwordx4 v[108:111], v2, s[56:59], s30 offen sc1
    v_mfma_f32_16x16x32_bf16 v[152:155], v[120:123], v[108:111], v[152:155]
    s_add_u32 s30, s65, 9216
    s_waitcnt lgkmcnt(2)
    buffer_store_dwordx4 v[112:115], v2, s[56:59], s30 offen sc1
    v_mfma_f32_16x16x32_bf16 v[156:159], v[120:123], v[112:115], v[156:159]
    s_add_u32 s30, s65, 46080
    s_waitcnt lgkmcnt(0)
    buffer_store_dwordx4 v[116:119], v2, s[56:59], s30 offen sc1
    v_mfma_f32_16x16x32_bf16 v[160:163], v[120:123], v[116:119], v[160:163]
    s_waitcnt vmcnt(35)
    ds_write_b128 v14, v[124:127] offset:0
    ds_write_b128 v14, v[128:131] offset:1024
    ds_write_b128 v14, v[132:135] offset:2048
    ds_write_b128 v14, v[136:139] offset:3072
    s_waitcnt lgkmcnt(0)
    ds_read_b64_tr_b16 v[124:125], v15 offset:0
    ds_read_b64_tr_b16 v[126:127], v15 offset:512
    ds_read_b64_tr_b16 v[128:129], v16 offset:0
    ds_read_b64_tr_b16 v[130:131], v16 offset:512
    ds_read_b64_tr_b16 v[132:133], v15 offset:2048
    ds_read_b64_tr_b16 v[134:135], v15 offset:2560
    ds_read_b64_tr_b16 v[136:137], v16 offset:2048
    ds_read_b64_tr_b16 v[138:139], v16 offset:2560
    s_add_u32 s30, s65, 10240
    s_waitcnt lgkmcnt(6)
    buffer_store_dwordx4 v[124:127], v2, s[56:59], s30 offen sc1
    v_mfma_f32_16x16x32_bf16 v[148:151], v[140:143], v[124:127], v[148:151]
    s_add_u32 s30, s65, 47104
    s_waitcnt lgkmcnt(4)
    buffer_store_dwordx4 v[128:131], v2, s[56:59], s30 offen sc1
    v_mfma_f32_16x16x32_bf16 v[152:155], v[140:143], v[128:131], v[152:155]
    s_add_u32 s30, s65, 11264
    s_waitcnt lgkmcnt(2)
    buffer_store_dwordx4 v[132:135], v2, s[56:59], s30 offen sc1
    v_mfma_f32_16x16x32_bf16 v[156:159], v[140:143], v[132:135], v[156:159]
    s_add_u32 s30, s65, 48128
    s_waitcnt lgkmcnt(0)
    buffer_store_dwordx4 v[136:139], v2, s[56:59], s30 offen sc1
    v_mfma_f32_16x16x32_bf16 v[160:163], v[140:143], v[136:139], v[160:163]
    s_waitcnt vmcnt(30)
    ds_write_b128 v14, v[24:27] offset:0
    ds_write_b128 v14, v[28:31] offset:1024
    ds_write_b128 v14, v[32:35] offset:2048
    ds_write_b128 v14, v[36:39] offset:3072
    s_waitcnt lgkmcnt(0)
    ds_read_b64_tr_b16 v[24:25], v15 offset:0
    ds_read_b64_tr_b16 v[26:27], v15 offset:512
    ds_read_b64_tr_b16 v[28:29], v16 offset:0
    ds_read_b64_tr_b16 v[30:31], v16 offset:512
    ds_read_b64_tr_b16 v[32:33], v15 offset:2048
    ds_read_b64_tr_b16 v[34:35], v15 offset:2560
    ds_read_b64_tr_b16 v[36:37], v16 offset:2048
    ds_read_b64_tr_b16 v[38:39], v16 offset:2560
    s_add_u32 s30, s65, 12288
    s_waitcnt lgkmcnt(6)
    buffer_store_dwordx4 v[24:27], v2, s[56:59], s30 offen sc1
    v_mfma_f32_16x16x32_bf16 v[148:151], v[40:43], v[24:27], v[148:151]
    s_add_u32 s30, s65, 49152
    s_waitcnt lgkmcnt(4)
    buffer_store_dwordx4 v[28:31], v2, s[56:59], s30 offen sc1
    v_mfma_f32_16x16x32_bf16 v[152:155], v[40:43], v[28:31], v[152:155]
    s_add_u32 s30, s65, 13312
    s_waitcnt lgkmcnt(2)
    buffer_store_dwordx4 v[32:35], v2, s[56:59], s30 offen sc1
    v_mfma_f32_16x16x32_bf16 v[156:159], v[40:43], v[32:35], v[156:159]
    s_add_u32 s30, s65, 50176
    s_waitcnt lgkmcnt(0)
    buffer_store_dwordx4 v[36:39], v2, s[56:59], s30 offen sc1
    v_mfma_f32_16x16x32_bf16 v[160:163], v[40:43], v[36:39], v[160:163]
    s_waitcnt vmcnt(25)
    ds_write_b128 v14, v[44:47] offset:0
    ds_write_b128 v14, v[48:51] offset:1024
    ds_write_b128 v14, v[52:55] offset:2048
    ds_write_b128 v14, v[56:59] offset:3072
    s_waitcnt lgkmcnt(0)
    ds_read_b64_tr_b16 v[44:45], v15 offset:0
    ds_read_b64_tr_b16 v[46:47], v15 offset:512
    ds_read_b64_tr_b16 v[48:49], v16 offset:0
    ds_read_b64_tr_b16 v[50:51], v16 offset:512
    ds_read_b64_tr_b16 v[52:53], v15 offset:2048
    ds_read_b64_tr_b16 v[54:55], v15 offset:2560
    ds_read_b64_tr_b16 v[56:57], v16 offset:2048
    ds_read_b64_tr_b16 v[58:59], v16 offset:2560
    s_add_u32 s30, s65, 14336
    s_waitcnt lgkmcnt(6)
    buffer_store_dwordx4 v[44:47], v2, s[56:59], s30 offen sc1
    v_mfma_f32_16x16x32_bf16 v[148:151], v[60:63], v[44:47], v[148:151]
    s_add_u32 s30, s65, 51200
    s_waitcnt lgkmcnt(4)
    buffer_store_dwordx4 v[48:51], v2, s[56:59], s30 offen sc1
    v_mfma_f32_16x16x32_bf16 v[152:155], v[60:63], v[48:51], v[152:155]
    s_add_u32 s30, s65, 15360
    s_waitcnt lgkmcnt(2)
    buffer_store_dwordx4 v[52:55], v2, s[56:59], s30 offen sc1
    v_mfma_f32_16x16x32_bf16 v[156:159], v[60:63], v[52:55], v[156:159]
    s_add_u32 s30, s65, 52224
    s_waitcnt lgkmcnt(0)
    buffer_store_dwordx4 v[56:59], v2, s[56:59], s30 offen sc1
    v_mfma_f32_16x16x32_bf16 v[160:163], v[60:63], v[56:59], v[160:163]
    s_waitcnt vmcnt(20)
    ds_write_b128 v14, v[64:67] offset:0
    ds_write_b128 v14, v[68:71] offset:1024
    ds_write_b128 v14, v[72:75] offset:2048
    ds_write_b128 v14, v[76:79] offset:3072
    s_waitcnt lgkmcnt(0)
    ds_read_b64_tr_b16 v[64:65], v15 offset:0
    ds_read_b64_tr_b16 v[66:67], v15 offset:512
    ds_read_b64_tr_b16 v[68:69], v16 offset:0
    ds_read_b64_tr_b16 v[70:71], v16 offset:512
    ds_read_b64_tr_b16 v[72:73], v15 offset:2048
    ds_read_b64_tr_b16 v[74:75], v15 offset:2560
    ds_read_b64_tr_b16 v[76:77], v16 offset:2048
    ds_read_b64_tr_b16 v[78:79], v16 offset:2560
    s_add_u32 s30, s65, 16384
    s_waitcnt lgkmcnt(6)
    buffer_store_dwordx4 v[64:67], v2, s[56:59], s30 offen sc1
    v_mfma_f32_16x16x32_bf16 v[148:151], v[80:83], v[64:67], v[148:151]
    s_add_u32 s30, s65, 53248
    s_waitcnt lgkmcnt(4)
    buffer_store_dwordx4 v[68:71], v2, s[56:59], s30 offen sc1
    v_mfma_f32_16x16x32_bf16 v[152:155], v[80:83], v[68:71], v[152:155]
    s_add_u32 s30, s65, 17408
    s_waitcnt lgkmcnt(2)
    buffer_store_dwordx4 v[72:75], v2, s[56:59], s30 offen sc1
    v_mfma_f32_16x16x32_bf16 v[156:159], v[80:83], v[72:75], v[156:159]
    s_add_u32 s30, s65, 54272
    s_waitcnt lgkmcnt(0)
    buffer_store_dwordx4 v[76:79], v2, s[56:59], s30 offen sc1
    v_mfma_f32_16x16x32_bf16 v[160:163], v[80:83], v[76:79], v[160:163]
    v_lshlrev_b32 v19, 3, v1
    v_lshlrev_b32 v8, 7, v1
    v_add_u32 v9, 159744, v2
    s_nop 0
    v_permlane16_swap_b32 v156, v24
    v_permlane16_swap_b32 v157, v25
    v_permlane16_swap_b32 v158, v26
    v_permlane16_swap_b32 v159, v27
    v_permlane16_swap_b32 v160, v28
    v_permlane16_swap_b32 v161, v29
    v_permlane16_swap_b32 v162, v30
    v_permlane16_swap_b32 v163, v31
    v_add_f32 v148, v148, v24
    v_add_f32 v149, v149, v25
    v_add_f32 v150, v150, v26
    v_add_f32 v151, v151, v27
    v_add_f32 v152, v152, v28
    v_add_f32 v153, v153, v29
    v_add_f32 v154, v154, v30
    v_add_f32 v155, v155, v31
    s_cmp_eq_u32 s6, 8
    s_cbranch_scc1 K2_U0
    ds_write_b128 v9, v[148:151]
    ds_write_b128 v9, v[152:155] offset:1024
    s_waitcnt lgkmcnt(0)
    ds_write_b16 v7, v7 offset:1558
    s_branch K2_U1
K2_U0:
    ds_read_u16 v4, v7 offset:1558
    s_waitcnt lgkmcnt(0)
    v_readfirstlane_b32 s26, v4
    s_nop 0
    s_cmp_eq_u32 s26, 0
    s_cbranch_scc1 K2_U0_X
    s_sleep 4
    s_branch K2_U0
K2_U0_X:
    ds_read_b128 v[24:27], v9
    ds_read_b128 v[28:31], v9 offset:1024
    s_mov_b64 exec, 0xffff
    s_waitcnt lgkmcnt(0)
    v_add_f32 v20, v148, v24
    v_cvt_pk_bf16_f32 v33, v20, 0
    v_lshlrev_b32 v21, 16, v33
    v_sub_f32 v21, v20, v21
    v_cvt_pk_bf16_f32 v32, v20, v21
    buffer_store_dwordx2 v[32:33], v19, s[44:47], s61 offen offset:0
    v_add_f32 v20, v149, v25
    v_cvt_pk_bf16_f32 v35, v20, 0
    v_lshlrev_b32 v21, 16, v35
    v_sub_f32 v21, v20, v21
    v_cvt_pk_bf16_f32 v34, v20, v21
    buffer_store_dwordx2 v[34:35], v19, s[44:47], s61 offen offset:128
    v_add_f32 v20, v150, v26
    v_cvt_pk_bf16_f32 v37, v20, 0
    v_lshlrev_b32 v21, 16, v37
    v_sub_f32 v21, v20, v21
    v_cvt_pk_bf16_f32 v36, v20, v21
    buffer_store_dwordx2 v[36:37], v19, s[44:47], s61 offen offset:256
    v_add_f32 v20, v151, v27
    v_cvt_pk_bf16_f32 v39, v20, 0
    v_lshlrev_b32 v21, 16, v39
    v_sub_f32 v21, v20, v21
    v_cvt_pk_bf16_f32 v38, v20, v21
    buffer_store_dwordx2 v[38:39], v19, s[44:47], s61 offen offset:384
    v_add_f32 v20, v152, v28
    v_cvt_pk_bf16_f32 v41, v20, 0
    v_lshlrev_b32 v21, 16, v41
    v_sub_f32 v21, v20, v21
    v_cvt_pk_bf16_f32 v40, v20, v21
    buffer_store_dwordx2 v[40:41], v19, s[44:47], s61 offen offset:512
    v_add_f32 v20, v153, v29
    v_cvt_pk_bf16_f32 v43, v20, 0
    v_lshlrev_b32 v21, 16, v43
    v_sub_f32 v21, v20, v21
    v_cvt_pk_bf16_f32 v42, v20, v21
    buffer_store_dwordx2 v[42:43], v19, s[44:47], s61 offen offset:640
    v_add_f32 v20, v154, v30
    v_cvt_pk_bf16_f32 v45, v20, 0
    v_lshlrev_b32 v21, 16, v45
    v_sub_f32 v21, v20, v21
    v_cvt_pk_bf16_f32 v44, v20, v21
    buffer_store_dwordx2 v[44:45], v19, s[44:47], s61 offen offset:768
    v_add_f32 v20, v155, v31
    v_cvt_pk_bf16_f32 v47, v20, 0
    v_lshlrev_b32 v21, 16, v47
    v_sub_f32 v21, v20, v21
    v_cvt_pk_bf16_f32 v46, v20, v21
    buffer_store_dwordx2 v[46:47], v19, s[44:47], s61 offen offset:896
K2_U1:
    s_mov_b32 exec_lo, -1
    s_mov_b32 exec_hi, 0xffff
    s_waitcnt vmcnt(0)
    s_add_u32 s30, s65, 0
    buffer_load_dword v23, v8, s[56:59], s30 offen
    s_add_u32 s30, s65, 6144
    buffer_load_dword v23, v8, s[56:59], s30 offen
    s_add_u32 s30, s65, 12288
    buffer_load_dword v23, v8, s[56:59], s30 offen
    s_add_u32 s30, s65, 36864
    buffer_load_dword v23, v8, s[56:59], s30 offen
    s_add_u32 s30, s65, 43008
    buffer_load_dword v23, v8, s[56:59], s30 offen
    s_add_u32 s30, s65, 49152
    buffer_load_dword v23, v8, s[56:59], s30 offen
    s_endpgm
K2_H2:
    s_mul_i32 s31, s31, 14
    s_add_u32 s4, s4, s31
    s_cmp_ge_u32 s4, 36
    s_cbranch_scc1 END_k2_kernel
    s_mul_i32 s5, s3, 18
    s_add_u32 s5, s5, s4
    s_sub_u32 s5, s5, 18
    s_mul_i32 s66, s5, 36864
    s_lshr_b32 s7, s3, 1
    s_mul_i32 s30, s7, 36
    s_sub_u32 s5, s5, s30
    s_mul_i32 s30, s5, 57
    s_lshr_b32 s30, s30, 9
    s_mul_i32 s30, s30, 35
    s_lshl_b32 s5, s5, 2
    s_sub_u32 s5, s5, s30
    s_mul_i32 s67, s5, 9216
    s_mul_i32 s30, s7, 1327104
    s_add_u32 s67, s67, s30
    s_add_u32 s67, s67, 11534336
    s_and_b32 s7, s7, 1
    s_mul_i32 s7, s7, 5120
    s_add_u32 s68, s67, s7
    s_sub_u32 s69, s67, s7
    s_add_u32 s69, s69, 5120
    s_add_u32 s30, s66, 0
    buffer_load_dwordx4 v[24:27], v13, s[40:43], s30 offen nt
    s_add_u32 s30, s66, 9216
    buffer_load_dwordx4 v[28:31], v13, s[40:43], s30 offen nt
    s_add_u32 s30, s66, 18432
    buffer_load_dwordx4 v[32:35], v13, s[40:43], s30 offen nt
    s_add_u32 s30, s66, 27648
    buffer_load_dwordx4 v[36:39], v13, s[40:43], s30 offen nt
    s_add_u32 s30, s66, 128
    buffer_load_dwordx4 v[40:43], v13, s[40:43], s30 offen nt
    s_add_u32 s30, s66, 9344
    buffer_load_dwordx4 v[44:47], v13, s[40:43], s30 offen nt
    s_add_u32 s30, s66, 18560
    buffer_load_dwordx4 v[48:51], v13, s[40:43], s30 offen nt
    s_add_u32 s30, s66, 27776
    buffer_load_dwordx4 v[52:55], v13, s[40:43], s30 offen nt
    s_add_u32 s30, s66, 256
    buffer_load_dwordx4 v[56:59], v13, s[40:43], s30 offen nt
    s_add_u32 s30, s66, 9472
    buffer_load_dwordx4 v[60:63], v13, s[40:43], s30 offen nt
    s_add_u32 s30, s66, 18688
    buffer_load_dwordx4 v[64:67], v13, s[40:43], s30 offen nt
    s_add_u32 s30, s66, 27904
    buffer_load_dwordx4 v[68:71], v13, s[40:43], s30 offen nt
    s_add_u32 s30, s66, 384
    buffer_load_dwordx4 v[72:75], v13, s[40:43], s30 offen nt
    s_add_u32 s30, s66, 9600
    buffer_load_dwordx4 v[76:79], v13, s[40:43], s30 offen nt
    s_add_u32 s30, s66, 18816
    buffer_load_dwordx4 v[80:83], v13, s[40:43], s30 offen nt
    s_add_u32 s30, s66, 28032
    buffer_load_dwordx4 v[84:87], v13, s[40:43], s30 offen nt
    s_add_u32 s30, s66, 512
    buffer_load_dwordx4 v[88:91], v13, s[40:43], s30 offen nt
    s_add_u32 s30, s66, 9728
    buffer_load_dwordx4 v[92:95], v13, s[40:43], s30 offen nt
    s_add_u32 s30, s66, 18944
    buffer_load_dwordx4 v[96:99], v13, s[40:43], s30 offen nt
    s_add_u32 s30, s66, 28160
    buffer_load_dwordx4 v[100:103], v13, s[40:43], s30 offen nt
    s_add_u32 s30, s66, 640
    buffer_load_dwordx4 v[104:107], v13, s[40:43], s30 offen nt
    s_add_u32 s30, s66, 9856
    buffer_load_dwordx4 v[108:111], v13, s[40:43], s30 offen nt
    s_add_u32 s30, s66, 19072
    buffer_load_dwordx4 v[112:115], v13, s[40:43], s30 offen nt
    s_add_u32 s30, s66, 28288
    buffer_load_dwordx4 v[116:119], v13, s[40:43], s30 offen nt
    s_add_u32 s30, s66, 768
    buffer_load_dwordx4 v[120:123], v13, s[40:43], s30 offen nt
    s_add_u32 s30, s66, 9984
    buffer_load_dwordx4 v[124:127], v13, s[40:43], s30 offen nt
    s_add_u32 s30, s66, 19200
    buffer_load_dwordx4 v[128:131], v13, s[40:43], s30 offen nt
    s_add_u32 s30, s66, 28416
    buffer_load_dwordx4 v[132:135], v13, s[40:43], s30 offen nt
    s_add_u32 s30, s66, 896
    buffer_load_dwordx4 v[136:139], v13, s[40:43], s30 offen nt
    s_add_u32 s30, s66, 10112
    buffer_load_dwordx4 v[140:143], v13, s[40:43], s30 offen nt
    s_add_u32 s30, s66, 19328
    buffer_load_dwordx4 v[144:147], v13, s[40:43], s30 offen nt
    s_add_u32 s30, s66, 28544
    buffer_load_dwordx4 v[148:151], v13, s[40:43], s30 offen nt
    s_add_u32 s30, s66, 1024
    buffer_load_dwordx4 v[152:155], v13, s[40:43], s30 offen nt
    s_add_u32 s30, s66, 10240
    buffer_load_dwordx4 v[156:159], v13, s[40:43], s30 offen nt
    s_add_u32 s30, s66, 19456
    buffer_load_dwordx4 v[160:163], v13, s[40:43], s30 offen nt
    s_add_u32 s30, s66, 28672
    buffer_load_dwordx4 v[164:167], v13, s[40:43], s30 offen nt
    s_waitcnt vmcnt(32)
    ds_write_b128 v14, v[24:27] offset:0
    ds_write_b128 v14, v[28:31] offset:1024
    ds_write_b128 v14, v[32:35] offset:2048
    ds_write_b128 v14, v[36:39] offset:3072
    s_waitcnt lgkmcnt(0)
    ds_read_b64_tr_b16 v[24:25], v17 offset:0
    ds_read_b64_tr_b16 v[26:27], v17 offset:1024
    ds_read_b64_tr_b16 v[28:29], v17 offset:8
    ds_read_b64_tr_b16 v[30:31], v17 offset:1032
    ds_read_b64_tr_b16 v[32:33], v18 offset:0
    ds_read_b64_tr_b16 v[34:35], v18 offset:1024
    ds_read_b64_tr_b16 v[36:37], v18 offset:8
    ds_read_b64_tr_b16 v[38:39], v18 offset:1032
    s_add_u32 s30, s68, 0
    s_waitcnt lgkmcnt(6)
    buffer_store_dwordx4 v[24:27], v2, s[56:59], s30 offen sc1
    s_add_u32 s30, s68, 1024
    s_waitcnt lgkmcnt(4)
    buffer_store_dwordx4 v[28:31], v2, s[56:59], s30 offen sc1
    s_add_u32 s30, s68, 2048
    s_waitcnt lgkmcnt(2)
    buffer_store_dwordx4 v[32:35], v2, s[56:59], s30 offen sc1
    s_add_u32 s30, s68, 3072
    s_waitcnt lgkmcnt(0)
    buffer_store_dwordx4 v[36:39], v2, s[56:59], s30 offen sc1
    s_waitcnt vmcnt(32)
    ds_write_b128 v14, v[40:43] offset:0
    ds_write_b128 v14, v[44:47] offset:1024
    ds_write_b128 v14, v[48:51] offset:2048
    ds_write_b128 v14, v[52:55] offset:3072
    s_waitcnt lgkmcnt(0)
    ds_read_b64_tr_b16 v[40:41], v17 offset:0
    ds_read_b64_tr_b16 v[42:43], v17 offset:1024
    ds_read_b64_tr_b16 v[44:45], v17 offset:8
    ds_read_b64_tr_b16 v[46:47], v17 offset:1032
    ds_read_b64_tr_b16 v[48:49], v18 offset:0
    ds_read_b64_tr_b16 v[50:51], v18 offset:1024
    ds_read_b64_tr_b16 v[52:53], v18 offset:8
    ds_read_b64_tr_b16 v[54:55], v18 offset:1032
    s_add_u32 s30, s69, 0
    s_waitcnt lgkmcnt(6)
    buffer_store_dwordx4 v[40:43], v2, s[56:59], s30 offen sc1
    s_add_u32 s30, s69, 1024
    s_waitcnt lgkmcnt(4)
    buffer_store_dwordx4 v[44:47], v2, s[56:59], s30 offen sc1
    s_add_u32 s30, s69, 2048
    s_waitcnt lgkmcnt(2)
    buffer_store_dwordx4 v[48:51], v2, s[56:59], s30 offen sc1
    s_add_u32 s30, s69, 3072
    s_waitcnt lgkmcnt(0)
    buffer_store_dwordx4 v[52:55], v2, s[56:59], s30 offen sc1
    s_waitcnt vmcnt(32)
    ds_write_b128 v14, v[56:59] offset:0
    ds_write_b128 v14, v[60:63] offset:1024
    ds_write_b128 v14, v[64:67] offset:2048
    ds_write_b128 v14, v[68:71] offset:3072
    s_waitcnt lgkmcnt(0)
    ds_read_b64_tr_b16 v[56:57], v17 offset:0
    ds_read_b64_tr_b16 v[58:59], v17 offset:1024
    ds_read_b64_tr_b16 v[60:61], v17 offset:8
    ds_read_b64_tr_b16 v[62:63], v17 offset:1032
    ds_read_b64_tr_b16 v[64:65], v18 offset:0
    ds_read_b64_tr_b16 v[66:67], v18 offset:1024
    ds_read_b64_tr_b16 v[68:69], v18 offset:8
    ds_read_b64_tr_b16 v[70:71], v18 offset:1032
    s_add_u32 s30, s68, 331776
    s_waitcnt lgkmcnt(6)
    buffer_store_dwordx4 v[56:59], v2, s[56:59], s30 offen sc1
    s_add_u32 s30, s68, 332800
    s_waitcnt lgkmcnt(4)
    buffer_store_dwordx4 v[60:63], v2, s[56:59], s30 offen sc1
    s_add_u32 s30, s68, 333824
    s_waitcnt lgkmcnt(2)
    buffer_store_dwordx4 v[64:67], v2, s[56:59], s30 offen sc1
    s_add_u32 s30, s68, 334848
    s_waitcnt lgkmcnt(0)
    buffer_store_dwordx4 v[68:71], v2, s[56:59], s30 offen sc1
    s_waitcnt vmcnt(32)
    ds_write_b128 v14, v[72:75] offset:0
    ds_write_b128 v14, v[76:79] offset:1024
    ds_write_b128 v14, v[80:83] offset:2048
    ds_write_b128 v14, v[84:87] offset:3072
    s_waitcnt lgkmcnt(0)
    ds_read_b64_tr_b16 v[72:73], v17 offset:0
    ds_read_b64_tr_b16 v[74:75], v17 offset:1024
    ds_read_b64_tr_b16 v[76:77], v17 offset:8
    ds_read_b64_tr_b16 v[78:79], v17 offset:1032
    ds_read_b64_tr_b16 v[80:81], v18 offset:0
    ds_read_b64_tr_b16 v[82:83], v18 offset:1024
    ds_read_b64_tr_b16 v[84:85], v18 offset:8
    ds_read_b64_tr_b16 v[86:87], v18 offset:1032
    s_add_u32 s30, s69, 331776
    s_waitcnt lgkmcnt(6)
    buffer_store_dwordx4 v[72:75], v2, s[56:59], s30 offen sc1
    s_add_u32 s30, s69, 332800
    s_waitcnt lgkmcnt(4)
    buffer_store_dwordx4 v[76:79], v2, s[56:59], s30 offen sc1
    s_add_u32 s30, s69, 333824
    s_waitcnt lgkmcnt(2)
    buffer_store_dwordx4 v[80:83], v2, s[56:59], s30 offen sc1
    s_add_u32 s30, s69, 334848
    s_waitcnt lgkmcnt(0)
    buffer_store_dwordx4 v[84:87], v2, s[56:59], s30 offen sc1
    s_waitcnt vmcnt(32)
    ds_write_b128 v14, v[88:91] offset:0
    ds_write_b128 v14, v[92:95] offset:1024
    ds_write_b128 v14, v[96:99] offset:2048
    ds_write_b128 v14, v[100:103] offset:3072
    s_waitcnt lgkmcnt(0)
    ds_read_b64_tr_b16 v[88:89], v17 offset:0
    ds_read_b64_tr_b16 v[90:91], v17 offset:1024
    ds_read_b64_tr_b16 v[92:93], v17 offset:8
    ds_read_b64_tr_b16 v[94:95], v17 offset:1032
    ds_read_b64_tr_b16 v[96:97], v18 offset:0
    ds_read_b64_tr_b16 v[98:99], v18 offset:1024
    ds_read_b64_tr_b16 v[100:101], v18 offset:8
    ds_read_b64_tr_b16 v[102:103], v18 offset:1032
    s_add_u32 s30, s68, 663552
    s_waitcnt lgkmcnt(6)
    buffer_store_dwordx4 v[88:91], v2, s[56:59], s30 offen sc1
    s_add_u32 s30, s68, 664576
    s_waitcnt lgkmcnt(4)
    buffer_store_dwordx4 v[92:95], v2, s[56:59], s30 offen sc1
    s_add_u32 s30, s68, 665600
    s_waitcnt lgkmcnt(2)
    buffer_store_dwordx4 v[96:99], v2, s[56:59], s30 offen sc1
    s_add_u32 s30, s68, 666624
    s_waitcnt lgkmcnt(0)
    buffer_store_dwordx4 v[100:103], v2, s[56:59], s30 offen sc1
    s_waitcnt vmcnt(32)
    ds_write_b128 v14, v[104:107] offset:0
    ds_write_b128 v14, v[108:111] offset:1024
    ds_write_b128 v14, v[112:115] offset:2048
    ds_write_b128 v14, v[116:119] offset:3072
    s_waitcnt lgkmcnt(0)
    ds_read_b64_tr_b16 v[104:105], v17 offset:0
    ds_read_b64_tr_b16 v[106:107], v17 offset:1024
    ds_read_b64_tr_b16 v[108:109], v17 offset:8
    ds_read_b64_tr_b16 v[110:111], v17 offset:1032
    ds_read_b64_tr_b16 v[112:113], v18 offset:0
    ds_read_b64_tr_b16 v[114:115], v18 offset:1024
    ds_read_b64_tr_b16 v[116:117], v18 offset:8
    ds_read_b64_tr_b16 v[118:119], v18 offset:1032
    s_add_u32 s30, s69, 663552
    s_waitcnt lgkmcnt(6)
    buffer_store_dwordx4 v[104:107], v2, s[56:59], s30 offen sc1
    s_add_u32 s30, s69, 664576
    s_waitcnt lgkmcnt(4)
    buffer_store_dwordx4 v[108:111], v2, s[56:59], s30 offen sc1
    s_add_u32 s30, s69, 665600
    s_waitcnt lgkmcnt(2)
    buffer_store_dwordx4 v[112:115], v2, s[56:59], s30 offen sc1
    s_add_u32 s30, s69, 666624
    s_waitcnt lgkmcnt(0)
    buffer_store_dwordx4 v[116:119], v2, s[56:59], s30 offen sc1
    s_waitcnt vmcnt(32)
    ds_write_b128 v14, v[120:123] offset:0
    ds_write_b128 v14, v[124:127] offset:1024
    ds_write_b128 v14, v[128:131] offset:2048
    ds_write_b128 v14, v[132:135] offset:3072
    s_waitcnt lgkmcnt(0)
    ds_read_b64_tr_b16 v[120:121], v17 offset:0
    ds_read_b64_tr_b16 v[122:123], v17 offset:1024
    ds_read_b64_tr_b16 v[124:125], v17 offset:8
    ds_read_b64_tr_b16 v[126:127], v17 offset:1032
    ds_read_b64_tr_b16 v[128:129], v18 offset:0
    ds_read_b64_tr_b16 v[130:131], v18 offset:1024
    ds_read_b64_tr_b16 v[132:133], v18 offset:8
    ds_read_b64_tr_b16 v[134:135], v18 offset:1032
    s_add_u32 s30, s68, 995328
    s_waitcnt lgkmcnt(6)
    buffer_store_dwordx4 v[120:123], v2, s[56:59], s30 offen sc1
    s_add_u32 s30, s68, 996352
    s_waitcnt lgkmcnt(4)
    buffer_store_dwordx4 v[124:127], v2, s[56:59], s30 offen sc1
    s_add_u32 s30, s68, 997376
    s_waitcnt lgkmcnt(2)
    buffer_store_dwordx4 v[128:131], v2, s[56:59], s30 offen sc1
    s_add_u32 s30, s68, 998400
    s_waitcnt lgkmcnt(0)
    buffer_store_dwordx4 v[132:135], v2, s[56:59], s30 offen sc1
    s_waitcnt vmcnt(32)
    ds_write_b128 v14, v[136:139] offset:0
    ds_write_b128 v14, v[140:143] offset:1024
    ds_write_b128 v14, v[144:147] offset:2048
    ds_write_b128 v14, v[148:151] offset:3072
    s_waitcnt lgkmcnt(0)
    ds_read_b64_tr_b16 v[136:137], v17 offset:0
    ds_read_b64_tr_b16 v[138:139], v17 offset:1024
    ds_read_b64_tr_b16 v[140:141], v17 offset:8
    ds_read_b64_tr_b16 v[142:143], v17 offset:1032
    ds_read_b64_tr_b16 v[144:145], v18 offset:0
    ds_read_b64_tr_b16 v[146:147], v18 offset:1024
    ds_read_b64_tr_b16 v[148:149], v18 offset:8
    ds_read_b64_tr_b16 v[150:151], v18 offset:1032
    s_add_u32 s30, s69, 995328
    s_waitcnt lgkmcnt(6)
    buffer_store_dwordx4 v[136:139], v2, s[56:59], s30 offen sc1
    s_add_u32 s30, s69, 996352
    s_waitcnt lgkmcnt(4)
    buffer_store_dwordx4 v[140:143], v2, s[56:59], s30 offen sc1
    s_add_u32 s30, s69, 997376
    s_waitcnt lgkmcnt(2)
    buffer_store_dwordx4 v[144:147], v2, s[56:59], s30 offen sc1
    s_add_u32 s30, s69, 998400
    s_waitcnt lgkmcnt(0)
    buffer_store_dwordx4 v[148:151], v2, s[56:59], s30 offen sc1
    s_waitcnt vmcnt(32)
    ds_write_b128 v14, v[152:155] offset:0
    ds_write_b128 v14, v[156:159] offset:1024
    ds_write_b128 v14, v[160:163] offset:2048
    ds_write_b128 v14, v[164:167] offset:3072
    s_waitcnt lgkmcnt(0)
    ds_read_b64_tr_b16 v[152:153], v20 offset:0
    ds_read_b64_tr_b16 v[154:155], v20 offset:1024
    ds_read_b64_tr_b16 v[156:157], v21 offset:0
    ds_read_b64_tr_b16 v[158:159], v21 offset:1024
    ds_read_b64_tr_b16 v[160:161], v22 offset:0
    ds_read_b64_tr_b16 v[162:163], v22 offset:1024
    ds_read_b64_tr_b16 v[164:165], v23 offset:0
    ds_read_b64_tr_b16 v[166:167], v23 offset:1024
    s_add_u32 s30, s67, 4096
    s_waitcnt lgkmcnt(6)
    buffer_store_dwordx4 v[152:155], v2, s[56:59], s30 offen sc1
    s_add_u32 s30, s67, 335872
    s_waitcnt lgkmcnt(4)
    buffer_store_dwordx4 v[156:159], v2, s[56:59], s30 offen sc1
    s_add_u32 s30, s67, 667648
    s_waitcnt lgkmcnt(2)
    buffer_store_dwordx4 v[160:163], v2, s[56:59], s30 offen sc1
    s_add_u32 s30, s67, 999424
    s_waitcnt lgkmcnt(0)
    buffer_store_dwordx4 v[164:167], v2, s[56:59], s30 offen sc1
    s_endpgm
K2_H3:
    s_setprio 2
    s_barrier
K2_HX:
    ds_read_u16 v4, v7 offset:1542
    s_waitcnt lgkmcnt(0)
    v_readfirstlane_b32 s26, v4
    s_nop 0
    s_cmp_eq_u32 s26, 0
    s_cbranch_scc1 K2_HX_X
    s_sleep 4
    s_branch K2_HX
K2_HX_X:
    s_add_u32 s32, s28, 44040192
    s_addc_u32 s33, s29, 0
    s_mov_b32 s34, 9437184
    s_mov_b32 s35, 0x20000
    s_add_u32 s40, s28, 196608
    s_addc_u32 s41, s29, 0
    s_mov_b32 s42, 32768
    s_mov_b32 s43, 0x20000
    s_mul_i32 s30, s2, 36864
    s_lshl_b32 s31, s2, 7
    v_mov_b32 v28, -1
    v_mov_b32 v29, -1
    v_mov_b32 v30, -1
    v_mov_b32 v31, -1
    v_mov_b32 v32, 0
    v_lshlrev_b32 v33, 20, v1
    buffer_store_dword v32, v33, s[40:43], s31 offen sc1
    buffer_store_dwordx4 v[28:31], v2, s[32:35], s30 offen offset:0 sc1
    buffer_store_dwordx4 v[28:31], v2, s[32:35], s30 offen offset:1024 sc1
    buffer_store_dwordx4 v[28:31], v2, s[32:35], s30 offen offset:2048 sc1
    buffer_store_dwordx4 v[28:31], v2, s[32:35], s30 offen offset:3072 sc1
    s_add_u32 s30, s30, 4096
    buffer_store_dwordx4 v[28:31], v2, s[32:35], s30 offen offset:0 sc1
    buffer_store_dwordx4 v[28:31], v2, s[32:35], s30 offen offset:1024 sc1
    buffer_store_dwordx4 v[28:31], v2, s[32:35], s30 offen offset:2048 sc1
    buffer_store_dwordx4 v[28:31], v2, s[32:35], s30 offen offset:3072 sc1
    s_add_u32 s30, s30, 4096
    buffer_store_dwordx4 v[28:31], v2, s[32:35], s30 offen offset:0 sc1
    buffer_store_dwordx4 v[28:31], v2, s[32:35], s30 offen offset:1024 sc1
    buffer_store_dwordx4 v[28:31], v2, s[32:35], s30 offen offset:2048 sc1
    buffer_store_dwordx4 v[28:31], v2, s[32:35], s30 offen offset:3072 sc1
    s_add_u32 s30, s30, 4096
    buffer_store_dwordx4 v[28:31], v2, s[32:35], s30 offen offset:0 sc1
    buffer_store_dwordx4 v[28:31], v2, s[32:35], s30 offen offset:1024 sc1
    buffer_store_dwordx4 v[28:31], v2, s[32:35], s30 offen offset:2048 sc1
    buffer_store_dwordx4 v[28:31], v2, s[32:35], s30 offen offset:3072 sc1
    s_add_u32 s30, s30, 4096
    buffer_store_dwordx4 v[28:31], v2, s[32:35], s30 offen offset:0 sc1
    buffer_store_dwordx4 v[28:31], v2, s[32:35], s30 offen offset:1024 sc1
    buffer_store_dwordx4 v[28:31], v2, s[32:35], s30 offen offset:2048 sc1
    buffer_store_dwordx4 v[28:31], v2, s[32:35], s30 offen offset:3072 sc1
    s_add_u32 s30, s30, 4096
    buffer_store_dwordx4 v[28:31], v2, s[32:35], s30 offen offset:0 sc1
    buffer_store_dwordx4 v[28:31], v2, s[32:35], s30 offen offset:1024 sc1
    buffer_store_dwordx4 v[28:31], v2, s[32:35], s30 offen offset:2048 sc1
    buffer_store_dwordx4 v[28:31], v2, s[32:35], s30 offen offset:3072 sc1
    s_add_u32 s30, s30, 4096
    buffer_store_dwordx4 v[28:31], v2, s[32:35], s30 offen offset:0 sc1
    buffer_store_dwordx4 v[28:31], v2, s[32:35], s30 offen offset:1024 sc1
    buffer_store_dwordx4 v[28:31], v2, s[32:35], s30 offen offset:2048 sc1
    buffer_store_dwordx4 v[28:31], v2, s[32:35], s30 offen offset:3072 sc1
    s_add_u32 s30, s30, 4096
    buffer_store_dwordx4 v[28:31], v2, s[32:35], s30 offen offset:0 sc1
    buffer_store_dwordx4 v[28:31], v2, s[32:35], s30 offen offset:1024 sc1
    buffer_store_dwordx4 v[28:31], v2, s[32:35], s30 offen offset:2048 sc1
    buffer_store_dwordx4 v[28:31], v2, s[32:35], s30 offen offset:3072 sc1
    s_add_u32 s30, s30, 4096
    buffer_store_dwordx4 v[28:31], v2, s[32:35], s30 offen offset:0 sc1
    buffer_store_dwordx4 v[28:31], v2, s[32:35], s30 offen offset:1024 sc1
    buffer_store_dwordx4 v[28:31], v2, s[32:35], s30 offen offset:2048 sc1
    buffer_store_dwordx4 v[28:31], v2, s[32:35], s30 offen offset:3072 sc1
    s_getpc_b64 s[40:41]
PC_k2_kernel:
    s_add_u32 s40, s40, km_kernel-PC_k2_kernel
    s_addc_u32 s41, s41, 0
    s_lshr_b32 s42, s2, 3
    s_lshl_b32 s42, s42, 12
    v_lshlrev_b32 v24, 6, v1
    v_add_u32 v24, s42, v24
    v_mov_b32 v25, CODE_END-km_kernel
    v_cmp_lt_u32 vcc, v24, v25
    v_mov_b32 v27, s41
    v_add_co_u32 v26, s[44:45], s40, v24
    s_nop 1
    v_addc_co_u32 v27, s[44:45], 0, v27, s[44:45]
    s_and_saveexec_b64 s[42:43], vcc
    s_cbranch_execz PFX_k2_kernel
    global_load_dword v24, v[26:27], off
PFX_k2_kernel:
    s_mov_b64 exec, s[42:43]
    s_add_u32 s44, s28, 14680064
    s_addc_u32 s45, s29, 0
    s_mov_b32 s46, 2359296
    s_mov_b32 s47, 0x20000
    s_add_u32 s52, s28, 72351744
    s_addc_u32 s53, s29, 0
    s_mov_b32 s54, 663552
    s_mov_b32 s55, 0x20000
    s_mov_b32 s64, s8
    s_mov_b32 s65, s9
    s_mov_b32 s66, 2359296
    s_mov_b32 s67, 0x20000
    s_add_u32 s40, s28, 81920
    s_addc_u32 s41, s29, 0
    s_mov_b32 s42, 6912
    s_mov_b32 s43, 0x20000
    s_add_u32 s32, s28, 17825792
    s_addc_u32 s33, s29, 0
    s_mov_b32 s34, 5505024
    s_mov_b32 s35, 0x20000
    s_add_u32 s36, s28, 24117248
    s_addc_u32 s37, s29, 0
    s_mov_b32 s38, 65536
    s_mov_b32 s39, 0x20000
    s_min_u32 s58, s6, 8
    s_mul_i32 s50, s58, 11
    s_lshr_b32 s50, s50, 5
    s_mul_i32 s51, s50, 3
    s_sub_u32 s51, s58, s51
    s_bfe_u32 s56, s2, 0x20003
    s_mul_i32 s57, s56, 3
    s_add_u32 s57, s57, s50
    s_mul_i32 s57, s57, 55296
    s_mul_i32 s68, s51, 3072
    s_add_u32 s57, s57, s68
    s_and_b32 s70, s2, 7
    s_lshl_b32 s70, s70, 3
    s_lshr_b32 s75, s2, 5
    s_add_u32 s70, s70, s75
    s_mul_i32 s68, s56, 9
    s_add_u32 s68, s68, s58
    s_lshl_b32 s71, s68, 5
    s_mul_i32 s59, s70, 36864
    s_add_u32 s62, s59, s71
    s_add_u32 s63, s71, 2304
    s_add_u32 s71, s71, 4608
    s_buffer_load_dwordx8 s[8:15], s[40:43], s63
    s_buffer_load_dwordx8 s[16:23], s[40:43], s71
    s_lshl_b32 s68, s68, 10
    s_add_u32 s68, s68, s59
    s_add_u32 s69, s68, 3145728
    s_mul_i32 s72, s50, 12288
    s_add_u32 s59, s59, s72
    s_add_u32 s60, s59, 4096
    s_add_u32 s61, s59, 8192
    s_lshl_b32 s70, s70, 2
    s_add_u32 s70, s70, s56
    s_lshl_b32 s70, s70, 8
    s_mul_i32 s76, s50, 18944
    s_mul_i32 s77, s51, 192
    s_add_u32 s76, s76, s77
    s_lshl_b32 s77, s58, 6
    s_mov_b32 s72, 0x100000
    s_mov_b32 s73, 63
    s_mov_b32 s74, 0xffff0000
    v_lshrrev_b32 v5, 4, v1
    v_and_b32 v7, 15, v1
    v_lshlrev_b32 v5, 9, v5
    v_lshl_add_u32 v6, v7, 2, v5
    v_lshl_add_u32 v5, v7, 4, v5
    v_mov_b32 v7, 0
    v_lshrrev_b32 v164, 5, v1
    v_mul_u32_u24 v4, 288, v3
    v_lshl_add_u32 v4, v164, 4, v4
    buffer_load_dwordx4 v[164:167], v4, s[64:67], s62 offen
    buffer_load_dwordx4 v[92:95], v2, s[52:55], s57 offen offset:0
    buffer_load_dwordx4 v[96:99], v2, s[52:55], s57 offen offset:1024
    buffer_load_dwordx4 v[100:103], v2, s[52:55], s57 offen offset:2048
    s_add_u32 s57, s57, 9216
    buffer_load_dwordx4 v[104:107], v2, s[52:55], s57 offen offset:0
    buffer_load_dwordx4 v[108:111], v2, s[52:55], s57 offen offset:1024
    buffer_load_dwordx4 v[112:115], v2, s[52:55], s57 offen offset:2048
    s_add_u32 s57, s57, 9216
    buffer_load_dwordx4 v[116:119], v2, s[52:55], s57 offen offset:0
    buffer_load_dwordx4 v[120:123], v2, s[52:55], s57 offen offset:1024
    buffer_load_dwordx4 v[124:127], v2, s[52:55], s57 offen offset:2048
    s_add_u32 s57, s57, 9216
    buffer_load_dwordx4 v[128:131], v2, s[52:55], s57 offen offset:0
    buffer_load_dwordx4 v[132:135], v2, s[52:55], s57 offen offset:1024
    buffer_load_dwordx4 v[136:139], v2, s[52:55], s57 offen offset:2048
    s_add_u32 s57, s57, 9216
    buffer_load_dwordx4 v[140:143], v2, s[52:55], s57 offen offset:0
    buffer_load_dwordx4 v[144:147], v2, s[52:55], s57 offen offset:1024
    buffer_load_dwordx4 v[148:151], v2, s[52:55], s57 offen offset:2048
    s_add_u32 s57, s57, 9216
    buffer_load_dwordx4 v[152:155], v2, s[52:55], s57 offen offset:0
    buffer_load_dwordx4 v[156:159], v2, s[52:55], s57 offen offset:1024
    buffer_load_dwordx4 v[160:163], v2, s[52:55], s57 offen offset:2048
    s_add_u32 s57, s57, 9216
K2_HG:
    ds_read_u16 v4, v7 offset:1550
    s_waitcnt lgkmcnt(0)
    v_readfirstlane_b32 s26, v4
    s_nop 0
    s_cmp_eq_u32 s26, 0
    s_cbranch_scc1 K2_HG_X
    s_sleep 8
    s_branch K2_HG
K2_HG_X:
    s_branch K2_T2
END_k2_kernel:
    s_endpgm
.globl km_kernel
.p2align 8
.type km_kernel,@function
km_kernel:
    s_load_dwordx16 s[8:23], s[0:1], 0
    s_load_dwordx2 s[24:25], s[0:1], 64
    s_load_dwordx2 s[28:29], s[0:1], 80
    s_cmp_ge_u32 s2, 256
    s_cbranch_scc1 END_km_kernel
    v_lshrrev_b32 v2, 6, v0
    v_and_b32 v1, 63, v0
    v_readfirstlane_b32 s6, v2
    s_and_b32 s3, s2, 1
    s_lshl_b32 s3, s3, 3
    s_lshr_b32 s4, s2, 5
    s_add_u32 s3, s3, s4
    s_bfe_u32 s4, s2, 0x20001
    s_bfe_u32 s5, s2, 0x20003
    s_and_b32 s26, s6, 3
    s_cmp_ge_u32 s6, 4
    s_cbranch_scc1 KM_LD
    s_lshl_b32 s7, s3, 2
    s_add_u32 s7, s7, s26
    s_lshl_b32 s56, s3, 2
    s_add_u32 s56, s56, s5
    s_lshl_b32 s56, s56, 2
    s_add_u32 s56, s56, s26
    s_mul_i32 s30, s7, 36864
    s_add_u32 s48, s30, 0
    s_add_u32 s49, s30, 9216
    s_add_u32 s50, s30, 18432
    s_add_u32 s51, s30, 27648
    s_mul_i32 s53, s7, 1024
    v_lshlrev_b32 v3, 3, v1
    v_lshrrev_b32 v11, 5, v1
    v_and_b32 v10, 31, v1
    v_cmp_gt_u32 vcc, 32, v1
    v_lshlrev_b32 v1, 4, v1
    s_waitcnt lgkmcnt(0)
    s_add_u32 s32, s28, 20971520
    s_addc_u32 s33, s29, 0
    s_mov_b32 s34, 2359296
    s_mov_b32 s35, 0x20000
    buffer_load_dwordx4 a[0:3], v1, s[32:35], s48 offen offset:0
    buffer_load_dwordx4 a[4:7], v1, s[32:35], s48 offen offset:1024
    buffer_load_dwordx4 a[8:11], v1, s[32:35], s48 offen offset:2048
    buffer_load_dwordx4 a[12:15], v1, s[32:35], s48 offen offset:3072
    s_add_u32 s48, s48, 4096
    buffer_load_dwordx4 a[16:19], v1, s[32:35], s48 offen offset:0
    buffer_load_dwordx4 a[20:23], v1, s[32:35], s48 offen offset:1024
    buffer_load_dwordx4 a[24:27], v1, s[32:35], s48 offen offset:2048
    buffer_load_dwordx4 a[28:31], v1, s[32:35], s48 offen offset:3072
    s_add_u32 s48, s48, 4096
    buffer_load_dwordx4 a[32:35], v1, s[32:35], s48 offen offset:0
    buffer_load_dwordx4 a[36:39], v1, s[32:35], s49 offen offset:0
    buffer_load_dwordx4 a[40:43], v1, s[32:35], s49 offen offset:1024
    buffer_load_dwordx4 a[44:47], v1, s[32:35], s49 offen offset:2048
    buffer_load_dwordx4 a[48:51], v1, s[32:35], s49 offen offset:3072
    s_add_u32 s49, s49, 4096
    buffer_load_dwordx4 a[52:55], v1, s[32:35], s49 offen offset:0
    buffer_load_dwordx4 a[56:59], v1, s[32:35], s49 offen offset:1024
    buffer_load_dwordx4 a[60:63], v1, s[32:35], s49 offen offset:2048
    s_add_u32 s36, s28, 24117248
    s_addc_u32 s37, s29, 0
    s_mov_b32 s38, 65536
    s_mov_b32 s39, 0x20000
    s_add_u32 s40, s28, 25165824
    s_addc_u32 s41, s29, 0
    s_mov_b32 s42, 18874368
    s_mov_b32 s43, 0x20000
    s_add_u32 s44, s28, 44040192
    s_addc_u32 s45, s29, 0
    s_mov_b32 s46, 9437184
    s_mov_b32 s47, 0x20000
    s_add_u32 s60, s28, 81920
    s_addc_u32 s61, s29, 0
    s_mov_b32 s62, 6912
    s_mov_b32 s63, 0x20000
    s_mov_b32 s64, s24
    s_mov_b32 s65, s25
    s_mov_b32 s66, 2359296
    s_mov_b32 s67, 0x20000
    s_add_u32 s68, s28, 17825792
    s_addc_u32 s69, s29, 0
    s_mov_b32 s70, 2359296
    s_mov_b32 s71, 0x20000
    v_mul_u32_u24 v4, 512, v11
    v_lshl_add_u32 v92, v10, 3, v4
    s_mov_b32 s16, s53
    buffer_load_dwordx2 v[80:81], v92, s[36:39], s16 offen offset:0
    buffer_load_dwordx2 v[82:83], v92, s[36:39], s16 offen offset:256
    v_lshrrev_b32 v4, 4, v10
    s_mov_b32 s31, 147456
    v_mul_lo_u32 v4, v4, s31
    v_and_b32 v5, 15, v10
    v_lshl_add_u32 v4, v11, 8, v4
    v_lshl_add_u32 v2, v5, 4, v4
    v_mov_b32 v0, v1
    v_add_u32 v3, 147456, v3
    s_mul_i32 s52, s7, 294912
    s_mul_i32 s31, s4, 36864
    s_add_u32 s52, s52, s31
    s_lshr_b32 s26, s4, 1
    s_and_b32 s27, s4, 1
    s_mul_i32 s31, s26, 147456
    s_add_u32 s54, s52, s31
    s_sub_u32 s55, s52, s31
    s_add_u32 s55, s55, 147456
    s_lshl_b32 s31, s5, 10
    s_add_u32 s52, s52, s31
    s_mul_i32 s56, s56, 36864
    s_lshl_b32 s57, s5, 1
    s_add_u32 s57, s57, s27
    s_lshl_b32 s58, s57, 12
    s_add_u32 s58, s58, s30
    s_lshl_b32 s31, s26, 8
    s_add_u32 s58, s58, s31
    s_add_u32 s59, s30, s31
    s_lshl_b32 s31, s5, 10
    s_add_u32 s59, s59, s31
    s_add_u32 s59, s59, 32768
    s_lshl_b32 s57, s57, 7
    s_lshl_b32 s53, s5, 5
    s_add_u32 s53, s53, 1024
    s_lshl_b32 s7, s7, 1
    s_add_u32 s7, s7, s26
    s_mul_i32 s7, s7, 18432
    s_add_u32 s31, s5, 0
    s_and_b32 s31, s31, 3
    s_lshl_b32 s31, s31, 10
    s_add_u32 s8, s54, s31
    s_add_u32 s12, s55, s31
    s_add_u32 s31, s5, 1
    s_and_b32 s31, s31, 3
    s_lshl_b32 s31, s31, 10
    s_add_u32 s9, s54, s31
    s_add_u32 s13, s55, s31
    s_add_u32 s31, s5, 2
    s_and_b32 s31, s31, 3
    s_lshl_b32 s31, s31, 10
    s_add_u32 s10, s54, s31
    s_add_u32 s14, s55, s31
    s_add_u32 s31, s5, 3
    s_and_b32 s31, s31, 3
    s_lshl_b32 s31, s31, 10
    s_add_u32 s11, s54, s31
    s_add_u32 s15, s55, s31
    s_barrier
    ds_read_b128 v[16:19], v0 offset:0
    ds_read_b128 v[20:23], v0 offset:12288
    ds_read_b128 v[24:27], v0 offset:1024
    ds_read_b128 v[28:31], v0 offset:13312
    ds_read_b128 v[32:35], v0 offset:2048
    ds_read_b128 v[36:39], v0 offset:14336
    s_waitcnt vmcnt(17) lgkmcnt(4)
    v_mfma_f32_32x32x16_bf16 v[48:63], v[16:19], a[0:3], 0
    ds_read_b128 v[40:43], v0 offset:3072
    v_mfma_f32_32x32x16_bf16 v[64:79], v[20:23], a[0:3], 0
    ds_read_b128 v[44:47], v0 offset:15360
    buffer_load_dwordx4 a[64:67], v1, s[32:35], s49 offen offset:3072
    s_waitcnt vmcnt(17) lgkmcnt(4)
    v_mfma_f32_32x32x16_bf16 v[48:63], v[24:27], a[4:7], v[48:63]
    ds_read_b128 v[16:19], v0 offset:4096
    v_mfma_f32_32x32x16_bf16 v[64:79], v[28:31], a[4:7], v[64:79]
    ds_read_b128 v[20:23], v0 offset:16384
    s_add_u32 s49, s49, 4096
    buffer_load_dwordx4 a[68:71], v1, s[32:35], s49 offen offset:0
    s_waitcnt vmcnt(17) lgkmcnt(4)
    v_mfma_f32_32x32x16_bf16 v[48:63], v[32:35], a[8:11], v[48:63]
    ds_read_b128 v[24:27], v0 offset:5120
    v_mfma_f32_32x32x16_bf16 v[64:79], v[36:39], a[8:11], v[64:79]
    ds_read_b128 v[28:31], v0 offset:17408
    buffer_load_dwordx4 a[72:75], v1, s[32:35], s50 offen offset:0
    s_waitcnt vmcnt(17) lgkmcnt(4)
    v_mfma_f32_32x32x16_bf16 v[48:63], v[40:43], a[12:15], v[48:63]
    ds_read_b128 v[32:35], v0 offset:6144
    v_mfma_f32_32x32x16_bf16 v[64:79], v[44:47], a[12:15], v[64:79]
    ds_read_b128 v[36:39], v0 offset:18432
    buffer_load_dwordx4 a[76:79], v1, s[32:35], s50 offen offset:1024
    s_waitcnt vmcnt(17) lgkmcnt(4)
    v_mfma_f32_32x32x16_bf16 v[48:63], v[16:19], a[16:19], v[48:63]
    ds_read_b128 v[40:43], v0 offset:7168
    v_mfma_f32_32x32x16_bf16 v[64:79], v[20:23], a[16:19], v[64:79]
    ds_read_b128 v[44:47], v0 offset:19456
    buffer_load_dwordx4 a[80:83], v1, s[32:35], s50 offen offset:2048
    s_waitcnt vmcnt(17) lgkmcnt(4)
    v_mfma_f32_32x32x16_bf16 v[48:63], v[24:27], a[20:23], v[48:63]
    ds_read_b128 v[16:19], v0 offset:8192
    v_mfma_f32_32x32x16_bf16 v[64:79], v[28:31], a[20:23], v[64:79]
    ds_read_b128 v[20:23], v0 offset:20480
    buffer_load_dwordx4 a[84:87], v1, s[32:35], s50 offen offset:3072
    s_waitcnt vmcnt(17) lgkmcnt(4)
    v_mfma_f32_32x32x16_bf16 v[48:63], v[32:35], a[24:27], v[48:63]
    ds_read_b128 v[24:27], v0 offset:9216
    v_mfma_f32_32x32x16_bf16 v[64:79], v[36:39], a[24:27], v[64:79]
    ds_read_b128 v[28:31], v0 offset:21504
    s_add_u32 s50, s50, 4096
    buffer_load_dwordx4 a[88:91], v1, s[32:35], s50 offen offset:0
    s_waitcnt vmcnt(17) lgkmcnt(4)
    v_mfma_f32_32x32x16_bf16 v[48:63], v[40:43], a[28:31], v[48:63]
    ds_read_b128 v[32:35], v0 offset:10240
    v_mfma_f32_32x32x16_bf16 v[64:79], v[44:47], a[28:31], v[64:79]
    ds_read_b128 v[36:39], v0 offset:22528
    buffer_load_dwordx4 a[92:95], v1, s[32:35], s50 offen offset:1024
    s_waitcnt vmcnt(17) lgkmcnt(4)
    v_mfma_f32_32x32x16_bf16 v[48:63], v[16:19], a[32:35], v[48:63]
    ds_read_b128 v[40:43], v0 offset:11264
    v_mfma_f32_32x32x16_bf16 v[64:79], v[20:23], a[32:35], v[64:79]
    ds_read_b128 v[44:47], v0 offset:23552
    buffer_load_dwordx4 a[96:99], v1, s[32:35], s50 offen offset:2048
    s_waitcnt vmcnt(17) lgkmcnt(4)
    v_mfma_f32_32x32x16_bf16 v[48:63], v[24:27], a[36:39], v[48:63]
    s_barrier
    ds_read_b128 v[16:19], v0 offset:24576
    v_mfma_f32_32x32x16_bf16 v[64:79], v[28:31], a[36:39], v[64:79]
    ds_read_b128 v[20:23], v0 offset:36864
    buffer_load_dwordx4 a[100:103], v1, s[32:35], s50 offen offset:3072
    s_waitcnt vmcnt(17) lgkmcnt(4)
    v_mfma_f32_32x32x16_bf16 v[48:63], v[32:35], a[40:43], v[48:63]
    ds_read_b128 v[24:27], v0 offset:25600
    v_mfma_f32_32x32x16_bf16 v[64:79], v[36:39], a[40:43], v[64:79]
    ds_read_b128 v[28:31], v0 offset:37888
    s_add_u32 s50, s50, 4096
    buffer_load_dwordx4 a[104:107], v1, s[32:35], s50 offen offset:0
    s_waitcnt vmcnt(17) lgkmcnt(4)
    v_mfma_f32_32x32x16_bf16 v[48:63], v[40:43], a[44:47], v[48:63]
    ds_read_b128 v[32:35], v0 offset:26624
    v_mfma_f32_32x32x16_bf16 v[64:79], v[44:47], a[44:47], v[64:79]
    ds_read_b128 v[36:39], v0 offset:38912
    buffer_load_dwordx4 a[108:111], v1, s[32:35], s51 offen offset:0
    s_waitcnt vmcnt(17) lgkmcnt(4)
    v_mfma_f32_32x32x16_bf16 v[48:63], v[16:19], a[48:51], v[48:63]
    ds_read_b128 v[40:43], v0 offset:27648
    v_mfma_f32_32x32x16_bf16 v[64:79], v[20:23], a[48:51], v[64:79]
    ds_read_b128 v[44:47], v0 offset:39936
    buffer_load_dwordx4 a[112:115], v1, s[32:35], s51 offen offset:1024
    s_waitcnt vmcnt(17) lgkmcnt(4)
    v_mfma_f32_32x32x16_bf16 v[48:63], v[24:27], a[52:55], v[48:63]
    ds_read_b128 v[16:19], v0 offset:28672
    v_mfma_f32_32x32x16_bf16 v[64:79], v[28:31], a[52:55], v[64:79]
    ds_read_b128 v[20:23], v0 offset:40960
    buffer_load_dwordx4 a[116:119], v1, s[32:35], s51 offen offset:2048
    s_waitcnt vmcnt(17) lgkmcnt(4)
    v_mfma_f32_32x32x16_bf16 v[48:63], v[32:35], a[56:59], v[48:63]
    ds_read_b128 v[24:27], v0 offset:29696
    v_mfma_f32_32x32x16_bf16 v[64:79], v[36:39], a[56:59], v[64:79]
    ds_read_b128 v[28:31], v0 offset:41984
    buffer_load_dwordx4 a[120:123], v1, s[32:35], s51 offen offset:3072
    s_waitcnt vmcnt(17) lgkmcnt(4)
    v_mfma_f32_32x32x16_bf16 v[48:63], v[40:43], a[60:63], v[48:63]
    ds_read_b128 v[32:35], v0 offset:30720
    v_mfma_f32_32x32x16_bf16 v[64:79], v[44:47], a[60:63], v[64:79]
    ds_read_b128 v[36:39], v0 offset:43008
    s_add_u32 s51, s51, 4096
    buffer_load_dwordx4 a[124:127], v1, s[32:35], s51 offen offset:0
    s_waitcnt vmcnt(15) lgkmcnt(4)
    v_mfma_f32_32x32x16_bf16 v[48:63], v[16:19], a[64:67], v[48:63]
    ds_read_b128 v[40:43], v0 offset:31744
    v_mfma_f32_32x32x16_bf16 v[64:79], v[20:23], a[64:67], v[64:79]
    ds_read_b128 v[44:47], v0 offset:44032
    buffer_load_dwordx4 a[128:131], v1, s[32:35], s51 offen offset:1024
    s_waitcnt vmcnt(15) lgkmcnt(4)
    v_mfma_f32_32x32x16_bf16 v[48:63], v[24:27], a[68:71], v[48:63]
    ds_read_b128 v[16:19], v0 offset:32768
    s_waitcnt vmcnt(17)
    v_mfma_f32_32x32x16_bf16 v[64:79], v[28:31], a[68:71], v[64:79]
    ds_read_b128 v[20:23], v0 offset:45056
    buffer_load_dwordx4 a[132:135], v1, s[32:35], s51 offen offset:2048
    v_pk_add_f32 v[80:81], v[80:81], v[82:83]
    s_waitcnt vmcnt(15) lgkmcnt(4)
    v_mfma_f32_32x32x16_bf16 v[48:63], v[32:35], a[72:75], v[48:63]
    ds_read_b128 v[24:27], v0 offset:33792
    v_mov_b32 v82, v80
    v_mfma_f32_32x32x16_bf16 v[64:79], v[36:39], a[72:75], v[64:79]
    ds_read_b128 v[28:31], v0 offset:46080
    buffer_load_dwordx4 a[136:139], v1, s[32:35], s51 offen offset:3072
    s_waitcnt vmcnt(15) lgkmcnt(4)
    v_mfma_f32_32x32x16_bf16 v[48:63], v[40:43], a[76:79], v[48:63]
    ds_read_b128 v[32:35], v0 offset:34816
    v_mov_b32 v83, v81
    v_mfma_f32_32x32x16_bf16 v[64:79], v[44:47], a[76:79], v[64:79]
    ds_read_b128 v[36:39], v0 offset:47104
    s_add_u32 s51, s51, 4096
    buffer_load_dwordx4 a[140:143], v1, s[32:35], s51 offen offset:0
    v_permlane32_swap_b32 v80, v82
    s_waitcnt vmcnt(15) lgkmcnt(4)
    v_mfma_f32_32x32x16_bf16 v[48:63], v[16:19], a[80:83], v[48:63]
    ds_read_b128 v[40:43], v0 offset:35840
    v_permlane32_swap_b32 v81, v83
    v_mfma_f32_32x32x16_bf16 v[64:79], v[20:23], a[80:83], v[64:79]
    ds_read_b128 v[44:47], v0 offset:48128
    v_pk_add_f32 v[80:81], v[80:81], v[82:83]
    s_waitcnt vmcnt(14) lgkmcnt(4)
    v_mfma_f32_32x32x16_bf16 v[48:63], v[24:27], a[84:87], v[48:63]
    s_barrier
    v_add_u32 v0, 49152, v1
    ds_read_b128 v[16:19], v0 offset:0
    v_mul_f32 v80, 3135475257, v80
    v_mfma_f32_32x32x16_bf16 v[64:79], v[28:31], a[84:87], v[64:79]
    ds_read_b128 v[20:23], v0 offset:12288
    s_waitcnt vmcnt(13) lgkmcnt(4)
    v_mfma_f32_32x32x16_bf16 v[48:63], v[32:35], a[88:91], v[48:63]
    ds_read_b128 v[24:27], v0 offset:1024
    v_mul_f32 v81, 987991609, v81
    v_mfma_f32_32x32x16_bf16 v[64:79], v[36:39], a[88:91], v[64:79]
    ds_read_b128 v[28:31], v0 offset:13312
    v_fma_f32 v81, -v80, v80, v81
    s_waitcnt vmcnt(12) lgkmcnt(4)
    v_mfma_f32_32x32x16_bf16 v[48:63], v[40:43], a[92:95], v[48:63]
    ds_read_b128 v[32:35], v0 offset:2048
    v_max_f32 v81, 0, v81
    v_mfma_f32_32x32x16_bf16 v[64:79], v[44:47], a[92:95], v[64:79]
    ds_read_b128 v[36:39], v0 offset:14336
    v_add_f32 v81, 925353388, v81
    s_waitcnt vmcnt(11) lgkmcnt(4)
    v_mfma_f32_32x32x16_bf16 v[48:63], v[16:19], a[96:99], v[48:63]
    ds_read_b128 v[40:43], v0 offset:3072
    v_sqrt_f32 v7, v81
    v_mfma_f32_32x32x16_bf16 v[64:79], v[20:23], a[96:99], v[64:79]
    ds_read_b128 v[44:47], v0 offset:15360
    s_waitcnt vmcnt(10) lgkmcnt(4)
    v_mfma_f32_32x32x16_bf16 v[48:63], v[24:27], a[100:103], v[48:63]
    ds_read_b128 v[16:19], v0 offset:4096
    v_rsq_f32 v6, v81
    v_mfma_f32_32x32x16_bf16 v[64:79], v[28:31], a[100:103], v[64:79]
    ds_read_b128 v[20:23], v0 offset:16384
    v_cndmask_b32 v80, v7, v80, vcc
    s_waitcnt vmcnt(9) lgkmcnt(4)
    v_mfma_f32_32x32x16_bf16 v[48:63], v[32:35], a[104:107], v[48:63]
    ds_read_b64 v[12:13], v3 offset:0
    ds_read_b64 v[14:15], v3 offset:512
    ds_read_b128 v[24:27], v0 offset:5120
    v_mul_f32 v6, 3216550459, v6
    v_mfma_f32_32x32x16_bf16 v[64:79], v[36:39], a[104:107], v[64:79]
    ds_read_b128 v[28:31], v0 offset:17408
    v_cvt_pk_bf16_f32 v4, v80, v80
    s_waitcnt vmcnt(8) lgkmcnt(6)
    v_mfma_f32_32x32x16_bf16 v[48:63], v[40:43], a[108:111], v[48:63]
    ds_read_b128 v[32:35], v0 offset:6144
    v_lshlrev_b32 v81, 16, v4
    v_mfma_f32_32x32x16_bf16 v[64:79], v[44:47], a[108:111], v[64:79]
    ds_read_b128 v[36:39], v0 offset:18432
    s_waitcnt vmcnt(7) lgkmcnt(6)
    v_mfma_f32_32x32x16_bf16 v[48:63], v[16:19], a[112:115], v[48:63]
    ds_read_b128 v[40:43], v0 offset:7168
    v_sub_f32 v81, v80, v81
    v_mfma_f32_32x32x16_bf16 v[64:79], v[20:23], a[112:115], v[64:79]
    ds_read_b128 v[44:47], v0 offset:19456
    v_cvt_pk_bf16_f32 v5, v81, 0
    s_waitcnt vmcnt(6) lgkmcnt(4)
    v_mfma_f32_32x32x16_bf16 v[48:63], v[24:27], a[116:119], v[48:63]
    ds_read_b128 v[16:19], v0 offset:8192
    v_mfma_f32_32x32x16_bf16 v[64:79], v[28:31], a[116:119], v[64:79]
    ds_read_b128 v[20:23], v0 offset:20480
    s_waitcnt vmcnt(5) lgkmcnt(4)
    v_mfma_f32_32x32x16_bf16 v[48:63], v[32:35], a[120:123], v[48:63]
    ds_read_b128 v[24:27], v0 offset:9216
    v_mfma_f32_32x32x16_bf16 v[64:79], v[36:39], a[120:123], v[64:79]
    ds_read_b128 v[28:31], v0 offset:21504
    v_mfma_f32_32x32x8_bf16 v[48:63], v[12:13], v[4:5], v[48:63]
    v_mfma_f32_32x32x8_bf16 v[64:79], v[14:15], v[4:5], v[64:79]
    s_waitcnt vmcnt(4) lgkmcnt(4)
    v_mfma_f32_32x32x16_bf16 v[48:63], v[40:43], a[124:127], v[48:63]
    ds_read_b128 v[32:35], v0 offset:10240
    v_mfma_f32_32x32x16_bf16 v[64:79], v[44:47], a[124:127], v[64:79]
    ds_read_b128 v[36:39], v0 offset:22528
    s_waitcnt vmcnt(3) lgkmcnt(4)
    v_mfma_f32_32x32x16_bf16 v[48:63], v[16:19], a[128:131], v[48:63]
    ds_read_b128 v[40:43], v0 offset:11264
    v_mfma_f32_32x32x16_bf16 v[64:79], v[20:23], a[128:131], v[64:79]
    ds_read_b128 v[44:47], v0 offset:23552
    s_waitcnt vmcnt(2) lgkmcnt(4)
    v_mfma_f32_32x32x16_bf16 v[48:63], v[24:27], a[132:135], v[48:63]
    s_barrier
    v_mfma_f32_32x32x16_bf16 v[64:79], v[28:31], a[132:135], v[64:79]
    ds_read_b128 v[16:19], v0 offset:24576
    s_waitcnt vmcnt(1) lgkmcnt(3)
    v_mfma_f32_32x32x16_bf16 v[48:63], v[32:35], a[136:139], v[48:63]
    ds_read_b128 v[24:27], v0 offset:25600
    v_mfma_f32_32x32x16_bf16 v[64:79], v[36:39], a[136:139], v[64:79]
    s_waitcnt vmcnt(0) lgkmcnt(2)
    v_mfma_f32_32x32x16_bf16 v[48:63], v[40:43], a[140:143], v[48:63]
    ds_read_b128 v[32:35], v0 offset:26624
    v_mfma_f32_32x32x16_bf16 v[64:79], v[44:47], a[140:143], v[64:79]
    s_waitcnt lgkmcnt(2)
    v_mfma_f32_32x32x16_bf16 v[80:95], v[16:19], a[0:3], 0
    ds_read_b128 v[40:43], v0 offset:27648
    s_waitcnt lgkmcnt(2)
    v_mfma_f32_32x32x16_bf16 v[80:95], v[24:27], a[4:7], v[80:95]
    ds_read_b128 v[16:19], v0 offset:28672
    s_nop 3
    v_mul_f32 v8, v6, v48
    v_mul_f32 v9, v6, v49
    v_mul_f32 v10, v6, v50
    v_mul_f32 v11, v6, v51
    s_waitcnt lgkmcnt(2)
    v_mfma_f32_32x32x16_bf16 v[80:95], v[32:35], a[8:11], v[80:95]
    ds_read_b128 v[24:27], v0 offset:29696
    v_exp_f32 v8, v8
    v_exp_f32 v9, v9
    s_waitcnt lgkmcnt(2)
    v_mfma_f32_32x32x16_bf16 v[80:95], v[40:43], a[12:15], v[80:95]
    ds_read_b128 v[32:35], v0 offset:30720
    v_exp_f32 v10, v10
    s_waitcnt lgkmcnt(2)
    v_mfma_f32_32x32x16_bf16 v[80:95], v[16:19], a[16:19], v[80:95]
    ds_read_b128 v[40:43], v0 offset:31744
    v_exp_f32 v11, v11
    v_fma_f32 v8, v8, v7, v7
    v_fma_f32 v9, v9, v7, v7
    s_waitcnt lgkmcnt(2)
    v_mfma_f32_32x32x16_bf16 v[80:95], v[24:27], a[20:23], v[80:95]
    ds_read_b128 v[16:19], v0 offset:32768
    v_fma_f32 v10, v10, v7, v7
    v_fma_f32 v11, v11, v7, v7
    v_rcp_f32 v8, v8
    s_waitcnt lgkmcnt(2)
    v_mfma_f32_32x32x16_bf16 v[80:95], v[32:35], a[24:27], v[80:95]
    ds_read_b128 v[24:27], v0 offset:33792
    v_rcp_f32 v9, v9
    v_rcp_f32 v10, v10
    s_waitcnt lgkmcnt(2)
    v_mfma_f32_32x32x16_bf16 v[80:95], v[40:43], a[28:31], v[80:95]
    ds_read_b128 v[32:35], v0 offset:34816
    v_rcp_f32 v11, v11
    v_mul_f32 v8, v48, v8
    s_waitcnt lgkmcnt(2)
    v_mfma_f32_32x32x16_bf16 v[80:95], v[16:19], a[32:35], v[80:95]
    ds_read_b128 v[40:43], v0 offset:35840
    v_mul_f32 v9, v49, v9
    v_mul_f32 v10, v50, v10
    v_mul_f32 v11, v51, v11
    s_waitcnt lgkmcnt(2)
    v_mfma_f32_32x32x16_bf16 v[80:95], v[24:27], a[36:39], v[80:95]
    s_barrier
    v_add_u32 v0, 98304, v1
    ds_read_b128 v[16:19], v0 offset:0
    v_cvt_pk_bf16_f32 v48, v8, v9
    v_cvt_pk_bf16_f32 v49, v10, v11
    v_mul_f32 v8, v6, v52
    v_mul_f32 v9, v6, v53
    s_waitcnt lgkmcnt(2)
    v_mfma_f32_32x32x16_bf16 v[80:95], v[32:35], a[40:43], v[80:95]
    ds_read_b128 v[24:27], v0 offset:1024
    v_mul_f32 v10, v6, v54
    v_mul_f32 v11, v6, v55
    v_exp_f32 v8, v8
    s_waitcnt lgkmcnt(2)
    v_mfma_f32_32x32x16_bf16 v[80:95], v[40:43], a[44:47], v[80:95]
    ds_read_b128 v[32:35], v0 offset:2048
    v_exp_f32 v9, v9
    s_waitcnt lgkmcnt(2)
    v_mfma_f32_32x32x16_bf16 v[80:95], v[16:19], a[48:51], v[80:95]
    ds_read_b128 v[40:43], v0 offset:3072
    v_exp_f32 v10, v10
    v_exp_f32 v11, v11
    s_waitcnt lgkmcnt(2)
    v_mfma_f32_32x32x16_bf16 v[80:95], v[24:27], a[52:55], v[80:95]
    ds_read_b128 v[16:19], v0 offset:4096
    v_fma_f32 v8, v8, v7, v7
    v_fma_f32 v9, v9, v7, v7
    v_fma_f32 v10, v10, v7, v7
    v_fma_f32 v11, v11, v7, v7
    s_waitcnt lgkmcnt(2)
    v_mfma_f32_32x32x16_bf16 v[80:95], v[32:35], a[56:59], v[80:95]
    ds_read_b128 v[24:27], v0 offset:5120
    v_rcp_f32 v8, v8
    v_rcp_f32 v9, v9
    s_waitcnt lgkmcnt(2)
    v_mfma_f32_32x32x16_bf16 v[80:95], v[40:43], a[60:63], v[80:95]
    ds_read_b128 v[32:35], v0 offset:6144
    v_rcp_f32 v10, v10
    s_waitcnt lgkmcnt(2)
    v_mfma_f32_32x32x16_bf16 v[80:95], v[16:19], a[64:67], v[80:95]
    ds_read_b128 v[40:43], v0 offset:7168
    v_rcp_f32 v11, v11
    v_mul_f32 v8, v52, v8
    v_mul_f32 v9, v53, v9
    s_waitcnt lgkmcnt(2)
    v_mfma_f32_32x32x16_bf16 v[80:95], v[24:27], a[68:71], v[80:95]
    ds_read_b128 v[16:19], v0 offset:8192
    v_mul_f32 v10, v54, v10
    v_mul_f32 v11, v55, v11
    v_cvt_pk_bf16_f32 v50, v8, v9
    v_cvt_pk_bf16_f32 v51, v10, v11
    s_waitcnt lgkmcnt(2)
    v_mfma_f32_32x32x16_bf16 v[80:95], v[32:35], a[72:75], v[80:95]
    ds_read_b128 v[24:27], v0 offset:9216
    buffer_store_dwordx4 v[48:51], v2, s[40:43], s52 offen offset:0 sc1
    v_mul_f32 v8, v6, v56
    v_mul_f32 v9, v6, v57
    s_waitcnt lgkmcnt(2)
    v_mfma_f32_32x32x16_bf16 v[80:95], v[40:43], a[76:79], v[80:95]
    ds_read_b128 v[32:35], v0 offset:10240
    v_mul_f32 v10, v6, v58
    v_mul_f32 v11, v6, v59
    v_exp_f32 v8, v8
    s_waitcnt lgkmcnt(2)
    v_mfma_f32_32x32x16_bf16 v[80:95], v[16:19], a[80:83], v[80:95]
    ds_read_b128 v[40:43], v0 offset:11264
    v_exp_f32 v9, v9
    v_exp_f32 v10, v10
    s_waitcnt lgkmcnt(2)
    v_mfma_f32_32x32x16_bf16 v[80:95], v[24:27], a[84:87], v[80:95]
    s_barrier
    ds_read_b128 v[16:19], v0 offset:24576
    v_exp_f32 v11, v11
    v_fma_f32 v8, v8, v7, v7
    s_waitcnt lgkmcnt(2)
    v_mfma_f32_32x32x16_bf16 v[80:95], v[32:35], a[88:91], v[80:95]
    ds_read_b128 v[24:27], v0 offset:25600
    v_fma_f32 v9, v9, v7, v7
    v_fma_f32 v10, v10, v7, v7
    v_fma_f32 v11, v11, v7, v7
    s_waitcnt lgkmcnt(2)
    v_mfma_f32_32x32x16_bf16 v[80:95], v[40:43], a[92:95], v[80:95]
    ds_read_b128 v[32:35], v0 offset:26624
    v_rcp_f32 v8, v8
    v_rcp_f32 v9, v9
    s_waitcnt lgkmcnt(2)
    v_mfma_f32_32x32x16_bf16 v[80:95], v[16:19], a[96:99], v[80:95]
    ds_read_b128 v[40:43], v0 offset:27648
    v_rcp_f32 v10, v10
    v_rcp_f32 v11, v11
    s_waitcnt lgkmcnt(2)
    v_mfma_f32_32x32x16_bf16 v[80:95], v[24:27], a[100:103], v[80:95]
    ds_read_b128 v[16:19], v0 offset:28672
    v_mul_f32 v8, v56, v8
    v_mul_f32 v9, v57, v9
    v_mul_f32 v10, v58, v10
    s_waitcnt lgkmcnt(2)
    v_mfma_f32_32x32x16_bf16 v[80:95], v[32:35], a[104:107], v[80:95]
    ds_read_b64 v[12:13], v3 offset:1024
    ds_read_b128 v[24:27], v0 offset:29696
    v_mul_f32 v11, v59, v11
    v_cvt_pk_bf16_f32 v56, v8, v9
    v_cvt_pk_bf16_f32 v57, v10, v11
    s_waitcnt lgkmcnt(3)
    v_mfma_f32_32x32x16_bf16 v[80:95], v[40:43], a[108:111], v[80:95]
    ds_read_b128 v[32:35], v0 offset:30720
    v_mul_f32 v8, v6, v60
    v_mul_f32 v9, v6, v61
    v_mul_f32 v10, v6, v62
    v_mul_f32 v11, v6, v63
    s_waitcnt lgkmcnt(3)
    v_mfma_f32_32x32x16_bf16 v[80:95], v[16:19], a[112:115], v[80:95]
    ds_read_b128 v[40:43], v0 offset:31744
    v_exp_f32 v8, v8
    v_exp_f32 v9, v9
    s_waitcnt lgkmcnt(2)
    v_mfma_f32_32x32x16_bf16 v[80:95], v[24:27], a[116:119], v[80:95]
    ds_read_b128 v[16:19], v0 offset:32768
    v_exp_f32 v10, v10
    s_waitcnt lgkmcnt(2)
    v_mfma_f32_32x32x16_bf16 v[80:95], v[32:35], a[120:123], v[80:95]
    ds_read_b128 v[24:27], v0 offset:33792
    v_exp_f32 v11, v11
    v_fma_f32 v8, v8, v7, v7
    v_fma_f32 v9, v9, v7, v7
    v_mfma_f32_32x32x8_bf16 v[80:95], v[12:13], v[4:5], v[80:95]
    s_waitcnt lgkmcnt(2)
    v_mfma_f32_32x32x16_bf16 v[80:95], v[40:43], a[124:127], v[80:95]
    ds_read_b128 v[32:35], v0 offset:34816
    v_fma_f32 v10, v10, v7, v7
    v_fma_f32 v11, v11, v7, v7
    v_rcp_f32 v8, v8
    s_waitcnt lgkmcnt(2)
    v_mfma_f32_32x32x16_bf16 v[80:95], v[16:19], a[128:131], v[80:95]
    ds_read_b128 v[40:43], v0 offset:35840
    v_rcp_f32 v9, v9
    v_rcp_f32 v10, v10
    s_waitcnt lgkmcnt(2)
    v_mfma_f32_32x32x16_bf16 v[80:95], v[24:27], a[132:135], v[80:95]
    s_barrier
    v_add_u32 v0, 0, v1
    ds_read_b128 v[16:19], v0 offset:0
    ds_read_b128 v[20:23], v0 offset:12288
    v_rcp_f32 v11, v11
    v_mul_f32 v8, v60, v8
    s_waitcnt lgkmcnt(3)
    v_mfma_f32_32x32x16_bf16 v[80:95], v[32:35], a[136:139], v[80:95]
    ds_read_b128 v[24:27], v0 offset:1024
    ds_read_b128 v[28:31], v0 offset:13312
    v_mul_f32 v9, v61, v9
    v_mul_f32 v10, v62, v10
    v_mul_f32 v11, v63, v11
    s_waitcnt lgkmcnt(4)
    v_mfma_f32_32x32x16_bf16 v[80:95], v[40:43], a[140:143], v[80:95]
    ds_read_b128 v[32:35], v0 offset:2048
    ds_read_b128 v[36:39], v0 offset:14336
    v_cvt_pk_bf16_f32 v58, v8, v9
    v_cvt_pk_bf16_f32 v59, v10, v11
    buffer_store_dwordx4 v[56:59], v2, s[40:43], s52 offen offset:512 sc1
    s_add_u32 s52, s52, 4096
    s_waitcnt lgkmcnt(4)
    v_mfma_f32_32x32x16_bf16 v[96:111], v[16:19], a[0:3], 0
    ds_read_b128 v[40:43], v0 offset:3072
    v_mfma_f32_32x32x16_bf16 v[48:63], v[20:23], a[0:3], 0
    ds_read_b128 v[44:47], v0 offset:15360
    s_waitcnt lgkmcnt(4)
    v_mfma_f32_32x32x16_bf16 v[96:111], v[24:27], a[4:7], v[96:111]
    ds_read_b128 v[16:19], v0 offset:4096
    v_mul_f32 v8, v6, v64
    v_mul_f32 v9, v6, v65
    v_mul_f32 v10, v6, v66
    v_mul_f32 v11, v6, v67
    v_mfma_f32_32x32x16_bf16 v[48:63], v[28:31], a[4:7], v[48:63]
    ds_read_b128 v[20:23], v0 offset:16384
    v_exp_f32 v8, v8
    v_exp_f32 v9, v9
    s_waitcnt lgkmcnt(4)
    v_mfma_f32_32x32x16_bf16 v[96:111], v[32:35], a[8:11], v[96:111]
    ds_read_b128 v[24:27], v0 offset:5120
    v_exp_f32 v10, v10
    v_mfma_f32_32x32x16_bf16 v[48:63], v[36:39], a[8:11], v[48:63]
    ds_read_b128 v[28:31], v0 offset:17408
    v_exp_f32 v11, v11
    v_fma_f32 v8, v8, v7, v7
    v_fma_f32 v9, v9, v7, v7
    s_waitcnt lgkmcnt(4)
    v_mfma_f32_32x32x16_bf16 v[96:111], v[40:43], a[12:15], v[96:111]
    ds_read_b128 v[32:35], v0 offset:6144
    v_fma_f32 v10, v10, v7, v7
    v_fma_f32 v11, v11, v7, v7
    v_rcp_f32 v8, v8
    v_mfma_f32_32x32x16_bf16 v[48:63], v[44:47], a[12:15], v[48:63]
    ds_read_b128 v[36:39], v0 offset:18432
    v_rcp_f32 v9, v9
    v_rcp_f32 v10, v10
    s_waitcnt lgkmcnt(4)
    v_mfma_f32_32x32x16_bf16 v[96:111], v[16:19], a[16:19], v[96:111]
    ds_read_b128 v[40:43], v0 offset:7168
    v_rcp_f32 v11, v11
    v_mul_f32 v8, v64, v8
    v_mfma_f32_32x32x16_bf16 v[48:63], v[20:23], a[16:19], v[48:63]
    ds_read_b128 v[44:47], v0 offset:19456
    v_mul_f32 v9, v65, v9
    v_mul_f32 v10, v66, v10
    v_mul_f32 v11, v67, v11
    s_waitcnt lgkmcnt(4)
    v_mfma_f32_32x32x16_bf16 v[96:111], v[24:27], a[20:23], v[96:111]
    ds_read_b128 v[16:19], v0 offset:8192
    v_cvt_pk_bf16_f32 v64, v8, v9
    v_cvt_pk_bf16_f32 v65, v10, v11
    v_mul_f32 v8, v6, v68
    v_mul_f32 v9, v6, v69
    v_mfma_f32_32x32x16_bf16 v[48:63], v[28:31], a[20:23], v[48:63]
    ds_read_b128 v[20:23], v0 offset:20480
    v_mul_f32 v10, v6, v70
    v_mul_f32 v11, v6, v71
    v_exp_f32 v8, v8
    s_waitcnt lgkmcnt(4)
    v_mfma_f32_32x32x16_bf16 v[96:111], v[32:35], a[24:27], v[96:111]
    ds_read_b128 v[24:27], v0 offset:9216
    v_exp_f32 v9, v9
    v_mfma_f32_32x32x16_bf16 v[48:63], v[36:39], a[24:27], v[48:63]
    ds_read_b128 v[28:31], v0 offset:21504
    v_exp_f32 v10, v10
    v_exp_f32 v11, v11
    s_waitcnt lgkmcnt(4)
    v_mfma_f32_32x32x16_bf16 v[96:111], v[40:43], a[28:31], v[96:111]
    ds_read_b128 v[32:35], v0 offset:10240
    v_fma_f32 v8, v8, v7, v7
    v_fma_f32 v9, v9, v7, v7
    v_fma_f32 v10, v10, v7, v7
    v_fma_f32 v11, v11, v7, v7
    v_mfma_f32_32x32x16_bf16 v[48:63], v[44:47], a[28:31], v[48:63]
    ds_read_b128 v[36:39], v0 offset:22528
    v_rcp_f32 v8, v8
    v_rcp_f32 v9, v9
    s_waitcnt lgkmcnt(4)
    v_mfma_f32_32x32x16_bf16 v[96:111], v[16:19], a[32:35], v[96:111]
    ds_read_b128 v[40:43], v0 offset:11264
    v_rcp_f32 v10, v10
    v_mfma_f32_32x32x16_bf16 v[48:63], v[20:23], a[32:35], v[48:63]
    ds_read_b128 v[44:47], v0 offset:23552
    v_rcp_f32 v11, v11
    v_mul_f32 v8, v68, v8
    v_mul_f32 v9, v69, v9
    s_waitcnt lgkmcnt(4)
    v_mfma_f32_32x32x16_bf16 v[96:111], v[24:27], a[36:39], v[96:111]
    s_barrier
    ds_read_b128 v[16:19], v0 offset:24576
    v_mul_f32 v10, v70, v10
    v_mul_f32 v11, v71, v11
    v_cvt_pk_bf16_f32 v66, v8, v9
    v_cvt_pk_bf16_f32 v67, v10, v11
    v_mfma_f32_32x32x16_bf16 v[48:63], v[28:31], a[36:39], v[48:63]
    ds_read_b128 v[20:23], v0 offset:36864
    buffer_store_dwordx4 v[64:67], v2, s[40:43], s52 offen offset:0 sc1
    v_mul_f32 v8, v6, v72
    v_mul_f32 v9, v6, v73
    s_waitcnt lgkmcnt(4)
    v_mfma_f32_32x32x16_bf16 v[96:111], v[32:35], a[40:43], v[96:111]
    ds_read_b128 v[24:27], v0 offset:25600
    v_mul_f32 v10, v6, v74
    v_mul_f32 v11, v6, v75
    v_exp_f32 v8, v8
    v_mfma_f32_32x32x16_bf16 v[48:63], v[36:39], a[40:43], v[48:63]
    ds_read_b128 v[28:31], v0 offset:37888
    v_exp_f32 v9, v9
    v_exp_f32 v10, v10
    s_waitcnt lgkmcnt(4)
    v_mfma_f32_32x32x16_bf16 v[96:111], v[40:43], a[44:47], v[96:111]
    ds_read_b128 v[32:35], v0 offset:26624
    v_exp_f32 v11, v11
    v_fma_f32 v8, v8, v7, v7
    v_mfma_f32_32x32x16_bf16 v[48:63], v[44:47], a[44:47], v[48:63]
    ds_read_b128 v[36:39], v0 offset:38912
    v_fma_f32 v9, v9, v7, v7
    v_fma_f32 v10, v10, v7, v7
    v_fma_f32 v11, v11, v7, v7
    s_waitcnt lgkmcnt(4)
    v_mfma_f32_32x32x16_bf16 v[96:111], v[16:19], a[48:51], v[96:111]
    ds_read_b128 v[40:43], v0 offset:27648
    v_rcp_f32 v8, v8
    v_rcp_f32 v9, v9
    v_mfma_f32_32x32x16_bf16 v[48:63], v[20:23], a[48:51], v[48:63]
    ds_read_b128 v[44:47], v0 offset:39936
    v_rcp_f32 v10, v10
    v_rcp_f32 v11, v11
    s_waitcnt lgkmcnt(4)
    v_mfma_f32_32x32x16_bf16 v[96:111], v[24:27], a[52:55], v[96:111]
    ds_read_b128 v[16:19], v0 offset:28672
    v_mul_f32 v8, v72, v8
    v_mul_f32 v9, v73, v9
    v_mul_f32 v10, v74, v10
    v_mfma_f32_32x32x16_bf16 v[48:63], v[28:31], a[52:55], v[48:63]
    ds_read_b128 v[20:23], v0 offset:40960
    v_mul_f32 v11, v75, v11
    v_cvt_pk_bf16_f32 v72, v8, v9
    v_cvt_pk_bf16_f32 v73, v10, v11
    s_waitcnt lgkmcnt(4)
    v_mfma_f32_32x32x16_bf16 v[96:111], v[32:35], a[56:59], v[96:111]
    ds_read_b128 v[24:27], v0 offset:29696
    v_mul_f32 v8, v6, v76
    v_mul_f32 v9, v6, v77
    v_mul_f32 v10, v6, v78
    v_mul_f32 v11, v6, v79
    v_mfma_f32_32x32x16_bf16 v[48:63], v[36:39], a[56:59], v[48:63]
    ds_read_b128 v[28:31], v0 offset:41984
    v_exp_f32 v8, v8
    v_exp_f32 v9, v9
    s_waitcnt lgkmcnt(4)
    v_mfma_f32_32x32x16_bf16 v[96:111], v[40:43], a[60:63], v[96:111]
    ds_read_b128 v[32:35], v0 offset:30720
    v_exp_f32 v10, v10
    v_mfma_f32_32x32x16_bf16 v[48:63], v[44:47], a[60:63], v[48:63]
    ds_read_b128 v[36:39], v0 offset:43008
    v_exp_f32 v11, v11
    v_fma_f32 v8, v8, v7, v7
    v_fma_f32 v9, v9, v7, v7
    s_waitcnt lgkmcnt(4)
    v_mfma_f32_32x32x16_bf16 v[96:111], v[16:19], a[64:67], v[96:111]
    ds_read_b128 v[40:43], v0 offset:31744
    v_fma_f32 v10, v10, v7, v7
    v_fma_f32 v11, v11, v7, v7
    v_rcp_f32 v8, v8
    v_mfma_f32_32x32x16_bf16 v[48:63], v[20:23], a[64:67], v[48:63]
    ds_read_b128 v[44:47], v0 offset:44032
    v_rcp_f32 v9, v9
    v_rcp_f32 v10, v10
    s_waitcnt lgkmcnt(4)
    v_mfma_f32_32x32x16_bf16 v[96:111], v[24:27], a[68:71], v[96:111]
    ds_read_b128 v[16:19], v0 offset:32768
    v_rcp_f32 v11, v11
    v_mul_f32 v8, v76, v8
    v_mfma_f32_32x32x16_bf16 v[48:63], v[28:31], a[68:71], v[48:63]
    ds_read_b128 v[20:23], v0 offset:45056
    v_mul_f32 v9, v77, v9
    v_mul_f32 v10, v78, v10
    v_mul_f32 v11, v79, v11
    s_waitcnt lgkmcnt(4)
    v_mfma_f32_32x32x16_bf16 v[96:111], v[32:35], a[72:75], v[96:111]
    ds_read_b128 v[24:27], v0 offset:33792
    v_cvt_pk_bf16_f32 v74, v8, v9
    v_cvt_pk_bf16_f32 v75, v10, v11
    buffer_store_dwordx4 v[72:75], v2, s[40:43], s52 offen offset:512 sc1
    s_add_u32 s52, s52, 4096
    v_mfma_f32_32x32x16_bf16 v[48:63], v[36:39], a[72:75], v[48:63]
    ds_read_b128 v[28:31], v0 offset:46080
    v_mul_f32 v8, v6, v80
    v_mul_f32 v9, v6, v81
    v_mul_f32 v10, v6, v82
    v_mul_f32 v11, v6, v83
    s_waitcnt lgkmcnt(4)
    v_mfma_f32_32x32x16_bf16 v[96:111], v[40:43], a[76:79], v[96:111]
    ds_read_b128 v[32:35], v0 offset:34816
    v_exp_f32 v8, v8
    v_exp_f32 v9, v9
    v_mfma_f32_32x32x16_bf16 v[48:63], v[44:47], a[76:79], v[48:63]
    ds_read_b128 v[36:39], v0 offset:47104
    v_exp_f32 v10, v10
    s_waitcnt lgkmcnt(4)
    v_mfma_f32_32x32x16_bf16 v[96:111], v[16:19], a[80:83], v[96:111]
    ds_read_b128 v[40:43], v0 offset:35840
    v_exp_f32 v11, v11
    v_fma_f32 v8, v8, v7, v7
    v_fma_f32 v9, v9, v7, v7
    v_mfma_f32_32x32x16_bf16 v[48:63], v[20:23], a[80:83], v[48:63]
    ds_read_b128 v[44:47], v0 offset:48128
    v_fma_f32 v10, v10, v7, v7
    v_fma_f32 v11, v11, v7, v7
    v_rcp_f32 v8, v8
    s_waitcnt lgkmcnt(4)
    v_mfma_f32_32x32x16_bf16 v[96:111], v[24:27], a[84:87], v[96:111]
    s_barrier
    v_add_u32 v0, 49152, v1
    ds_read_b128 v[16:19], v0 offset:0
    v_rcp_f32 v9, v9
    v_rcp_f32 v10, v10
    v_mfma_f32_32x32x16_bf16 v[48:63], v[28:31], a[84:87], v[48:63]
    ds_read_b128 v[20:23], v0 offset:12288
    v_rcp_f32 v11, v11
    v_mul_f32 v8, v80, v8
    s_waitcnt lgkmcnt(4)
    v_mfma_f32_32x32x16_bf16 v[96:111], v[32:35], a[88:91], v[96:111]
    ds_read_b128 v[24:27], v0 offset:1024
    v_mul_f32 v9, v81, v9
    v_mul_f32 v10, v82, v10
    v_mul_f32 v11, v83, v11
    v_mfma_f32_32x32x16_bf16 v[48:63], v[36:39], a[88:91], v[48:63]
    ds_read_b128 v[28:31], v0 offset:13312
    v_cvt_pk_bf16_f32 v80, v8, v9
    v_cvt_pk_bf16_f32 v81, v10, v11
    v_mul_f32 v8, v6, v84
    v_mul_f32 v9, v6, v85
    s_waitcnt lgkmcnt(4)
    v_mfma_f32_32x32x16_bf16 v[96:111], v[40:43], a[92:95], v[96:111]
    ds_read_b128 v[32:35], v0 offset:2048
    v_mul_f32 v10, v6, v86
    v_mul_f32 v11, v6, v87
    v_exp_f32 v8, v8
    v_mfma_f32_32x32x16_bf16 v[48:63], v[44:47], a[92:95], v[48:63]
    ds_read_b128 v[36:39], v0 offset:14336
    v_exp_f32 v9, v9
    s_waitcnt lgkmcnt(4)
    v_mfma_f32_32x32x16_bf16 v[96:111], v[16:19], a[96:99], v[96:111]
    ds_read_b128 v[40:43], v0 offset:3072
    v_exp_f32 v10, v10
    v_exp_f32 v11, v11
    v_mfma_f32_32x32x16_bf16 v[48:63], v[20:23], a[96:99], v[48:63]
    ds_read_b128 v[44:47], v0 offset:15360
    v_fma_f32 v8, v8, v7, v7
    v_fma_f32 v9, v9, v7, v7
    v_fma_f32 v10, v10, v7, v7
    v_fma_f32 v11, v11, v7, v7
    s_waitcnt lgkmcnt(4)
    v_mfma_f32_32x32x16_bf16 v[96:111], v[24:27], a[100:103], v[96:111]
    ds_read_b128 v[16:19], v0 offset:4096
    v_rcp_f32 v8, v8
    v_rcp_f32 v9, v9
    v_mfma_f32_32x32x16_bf16 v[48:63], v[28:31], a[100:103], v[48:63]
    ds_read_b128 v[20:23], v0 offset:16384
    v_rcp_f32 v10, v10
    s_waitcnt lgkmcnt(4)
    v_mfma_f32_32x32x16_bf16 v[96:111], v[32:35], a[104:107], v[96:111]
    ds_read_b64 v[12:13], v3 offset:1536
    ds_read_b64 v[14:15], v3 offset:2048
    ds_read_b128 v[24:27], v0 offset:5120
    v_rcp_f32 v11, v11
    v_mul_f32 v8, v84, v8
    v_mul_f32 v9, v85, v9
    v_mfma_f32_32x32x16_bf16 v[48:63], v[36:39], a[104:107], v[48:63]
    ds_read_b128 v[28:31], v0 offset:17408
    v_mul_f32 v10, v86, v10
    v_mul_f32 v11, v87, v11
    v_cvt_pk_bf16_f32 v82, v8, v9
    v_cvt_pk_bf16_f32 v83, v10, v11
    s_waitcnt lgkmcnt(6)
    v_mfma_f32_32x32x16_bf16 v[96:111], v[40:43], a[108:111], v[96:111]
    ds_read_b128 v[32:35], v0 offset:6144
    buffer_store_dwordx4 v[80:83], v2, s[40:43], s52 offen offset:0 sc1
    v_mul_f32 v8, v6, v88
    v_mul_f32 v9, v6, v89
    v_mfma_f32_32x32x16_bf16 v[48:63], v[44:47], a[108:111], v[48:63]
    ds_read_b128 v[36:39], v0 offset:18432
    v_mul_f32 v10, v6, v90
    v_mul_f32 v11, v6, v91
    v_exp_f32 v8, v8
    s_waitcnt lgkmcnt(6)
    v_mfma_f32_32x32x16_bf16 v[96:111], v[16:19], a[112:115], v[96:111]
    ds_read_b128 v[40:43], v0 offset:7168
    v_exp_f32 v9, v9
    v_exp_f32 v10, v10
    v_mfma_f32_32x32x16_bf16 v[48:63], v[20:23], a[112:115], v[48:63]
    ds_read_b128 v[44:47], v0 offset:19456
    v_exp_f32 v11, v11
    v_fma_f32 v8, v8, v7, v7
    s_waitcnt lgkmcnt(4)
    v_mfma_f32_32x32x16_bf16 v[96:111], v[24:27], a[116:119], v[96:111]
    ds_read_b128 v[16:19], v0 offset:8192
    v_fma_f32 v9, v9, v7, v7
    v_fma_f32 v10, v10, v7, v7
    v_fma_f32 v11, v11, v7, v7
    v_mfma_f32_32x32x16_bf16 v[48:63], v[28:31], a[116:119], v[48:63]
    ds_read_b128 v[20:23], v0 offset:20480
    v_rcp_f32 v8, v8
    v_rcp_f32 v9, v9
    s_waitcnt lgkmcnt(4)
    v_mfma_f32_32x32x16_bf16 v[96:111], v[32:35], a[120:123], v[96:111]
    ds_read_b128 v[24:27], v0 offset:9216
    v_rcp_f32 v10, v10
    v_rcp_f32 v11, v11
    v_mfma_f32_32x32x16_bf16 v[48:63], v[36:39], a[120:123], v[48:63]
    ds_read_b128 v[28:31], v0 offset:21504
    v_mul_f32 v8, v88, v8
    v_mul_f32 v9, v89, v9
    v_mul_f32 v10, v90, v10
    v_mfma_f32_32x32x8_bf16 v[96:111], v[12:13], v[4:5], v[96:111]
    v_mfma_f32_32x32x8_bf16 v[48:63], v[14:15], v[4:5], v[48:63]
    s_waitcnt lgkmcnt(4)
    v_mfma_f32_32x32x16_bf16 v[96:111], v[40:43], a[124:127], v[96:111]
    ds_read_b128 v[32:35], v0 offset:10240
    v_mul_f32 v11, v91, v11
    v_cvt_pk_bf16_f32 v88, v8, v9
    v_cvt_pk_bf16_f32 v89, v10, v11
    v_mfma_f32_32x32x16_bf16 v[48:63], v[44:47], a[124:127], v[48:63]
    ds_read_b128 v[36:39], v0 offset:22528
    v_mul_f32 v8, v6, v92
    v_mul_f32 v9, v6, v93
    v_mul_f32 v10, v6, v94
    v_mul_f32 v11, v6, v95
    s_waitcnt lgkmcnt(4)
    v_mfma_f32_32x32x16_bf16 v[96:111], v[16:19], a[128:131], v[96:111]
    ds_read_b128 v[40:43], v0 offset:11264
    v_exp_f32 v8, v8
    v_exp_f32 v9, v9
    v_mfma_f32_32x32x16_bf16 v[48:63], v[20:23], a[128:131], v[48:63]
    ds_read_b128 v[44:47], v0 offset:23552
    v_exp_f32 v10, v10
    s_waitcnt lgkmcnt(4)
    v_mfma_f32_32x32x16_bf16 v[96:111], v[24:27], a[132:135], v[96:111]
    s_waitcnt vmcnt(1)
    s_barrier
    ds_read_b128 v[16:19], v0 offset:24576
    v_exp_f32 v11, v11
    v_fma_f32 v8, v8, v7, v7
    v_fma_f32 v9, v9, v7, v7
    v_mfma_f32_32x32x16_bf16 v[48:63], v[28:31], a[132:135], v[48:63]
    ds_read_b128 v[20:23], v0 offset:36864
    v_fma_f32 v10, v10, v7, v7
    v_fma_f32 v11, v11, v7, v7
    v_rcp_f32 v8, v8
    s_waitcnt lgkmcnt(4)
    v_mfma_f32_32x32x16_bf16 v[96:111], v[32:35], a[136:139], v[96:111]
    ds_read_b128 v[24:27], v0 offset:25600
    v_rcp_f32 v9, v9
    v_rcp_f32 v10, v10
    v_mfma_f32_32x32x16_bf16 v[48:63], v[36:39], a[136:139], v[48:63]
    ds_read_b128 v[28:31], v0 offset:37888
    v_rcp_f32 v11, v11
    v_mul_f32 v8, v92, v8
    s_waitcnt lgkmcnt(4)
    v_mfma_f32_32x32x16_bf16 v[96:111], v[40:43], a[140:143], v[96:111]
    ds_read_b128 v[32:35], v0 offset:26624
    v_mul_f32 v9, v93, v9
    v_mul_f32 v10, v94, v10
    v_mul_f32 v11, v95, v11
    v_mfma_f32_32x32x16_bf16 v[48:63], v[44:47], a[140:143], v[48:63]
    ds_read_b128 v[36:39], v0 offset:38912
    v_cvt_pk_bf16_f32 v90, v8, v9
    v_cvt_pk_bf16_f32 v91, v10, v11
    buffer_store_dwordx4 v[88:91], v2, s[40:43], s52 offen offset:512 sc1
    s_add_u32 s52, s52, 4096
    s_waitcnt lgkmcnt(4)
    v_mfma_f32_32x32x16_bf16 v[64:79], v[16:19], a[0:3], 0
    ds_read_b128 v[40:43], v0 offset:27648
    v_mfma_f32_32x32x16_bf16 v[80:95], v[20:23], a[0:3], 0
    ds_read_b128 v[44:47], v0 offset:39936
    s_waitcnt lgkmcnt(4)
    v_mfma_f32_32x32x16_bf16 v[64:79], v[24:27], a[4:7], v[64:79]
    ds_read_b128 v[16:19], v0 offset:28672
    v_mul_f32 v8, v6, v96
    v_mul_f32 v9, v6, v97
    v_mul_f32 v10, v6, v98
    v_mul_f32 v11, v6, v99
    v_mfma_f32_32x32x16_bf16 v[80:95], v[28:31], a[4:7], v[80:95]
    ds_read_b128 v[20:23], v0 offset:40960
    v_exp_f32 v8, v8
    v_exp_f32 v9, v9
    s_waitcnt lgkmcnt(4)
    v_mfma_f32_32x32x16_bf16 v[64:79], v[32:35], a[8:11], v[64:79]
    ds_read_b128 v[24:27], v0 offset:29696
    v_exp_f32 v10, v10
    v_mfma_f32_32x32x16_bf16 v[80:95], v[36:39], a[8:11], v[80:95]
    ds_read_b128 v[28:31], v0 offset:41984
    v_exp_f32 v11, v11
    v_fma_f32 v8, v8, v7, v7
    v_fma_f32 v9, v9, v7, v7
    s_waitcnt lgkmcnt(4)
    v_mfma_f32_32x32x16_bf16 v[64:79], v[40:43], a[12:15], v[64:79]
    ds_read_b128 v[32:35], v0 offset:30720
    v_fma_f32 v10, v10, v7, v7
    v_fma_f32 v11, v11, v7, v7
    v_rcp_f32 v8, v8
    v_mfma_f32_32x32x16_bf16 v[80:95], v[44:47], a[12:15], v[80:95]
    ds_read_b128 v[36:39], v0 offset:43008
    v_rcp_f32 v9, v9
    v_rcp_f32 v10, v10
    s_waitcnt lgkmcnt(4)
    v_mfma_f32_32x32x16_bf16 v[64:79], v[16:19], a[16:19], v[64:79]
    ds_read_b128 v[40:43], v0 offset:31744
    v_rcp_f32 v11, v11
    v_mul_f32 v8, v96, v8
    v_mfma_f32_32x32x16_bf16 v[80:95], v[20:23], a[16:19], v[80:95]
    ds_read_b128 v[44:47], v0 offset:44032
    v_mul_f32 v9, v97, v9
    v_mul_f32 v10, v98, v10
    v_mul_f32 v11, v99, v11
    s_waitcnt lgkmcnt(4)
    v_mfma_f32_32x32x16_bf16 v[64:79], v[24:27], a[20:23], v[64:79]
    ds_read_b128 v[16:19], v0 offset:32768
    v_cvt_pk_bf16_f32 v96, v8, v9
    v_cvt_pk_bf16_f32 v97, v10, v11
    v_mul_f32 v8, v6, v100
    v_mul_f32 v9, v6, v101
    v_mfma_f32_32x32x16_bf16 v[80:95], v[28:31], a[20:23], v[80:95]
    ds_read_b128 v[20:23], v0 offset:45056
    v_mul_f32 v10, v6, v102
    v_mul_f32 v11, v6, v103
    v_exp_f32 v8, v8
    s_waitcnt lgkmcnt(4)
    v_mfma_f32_32x32x16_bf16 v[64:79], v[32:35], a[24:27], v[64:79]
    ds_read_b128 v[24:27], v0 offset:33792
    v_exp_f32 v9, v9
    v_mfma_f32_32x32x16_bf16 v[80:95], v[36:39], a[24:27], v[80:95]
    ds_read_b128 v[28:31], v0 offset:46080
    v_exp_f32 v10, v10
    v_exp_f32 v11, v11
    s_waitcnt lgkmcnt(4)
    v_mfma_f32_32x32x16_bf16 v[64:79], v[40:43], a[28:31], v[64:79]
    ds_read_b128 v[32:35], v0 offset:34816
    v_fma_f32 v8, v8, v7, v7
    v_fma_f32 v9, v9, v7, v7
    v_fma_f32 v10, v10, v7, v7
    v_fma_f32 v11, v11, v7, v7
    v_mfma_f32_32x32x16_bf16 v[80:95], v[44:47], a[28:31], v[80:95]
    ds_read_b128 v[36:39], v0 offset:47104
    v_rcp_f32 v8, v8
    v_rcp_f32 v9, v9
    s_waitcnt lgkmcnt(4)
    v_mfma_f32_32x32x16_bf16 v[64:79], v[16:19], a[32:35], v[64:79]
    ds_read_b128 v[40:43], v0 offset:35840
    v_rcp_f32 v10, v10
    v_mfma_f32_32x32x16_bf16 v[80:95], v[20:23], a[32:35], v[80:95]
    ds_read_b128 v[44:47], v0 offset:48128
    v_rcp_f32 v11, v11
    v_mul_f32 v8, v100, v8
    v_mul_f32 v9, v101, v9
    s_waitcnt lgkmcnt(4)
    v_mfma_f32_32x32x16_bf16 v[64:79], v[24:27], a[36:39], v[64:79]
    s_barrier
    v_add_u32 v0, 98304, v1
    ds_read_b128 v[16:19], v0 offset:0
    v_mul_f32 v10, v102, v10
    v_mul_f32 v11, v103, v11
    v_cvt_pk_bf16_f32 v98, v8, v9
    v_cvt_pk_bf16_f32 v99, v10, v11
    v_mfma_f32_32x32x16_bf16 v[80:95], v[28:31], a[36:39], v[80:95]
    ds_read_b128 v[20:23], v0 offset:12288
    buffer_store_dwordx4 v[96:99], v2, s[40:43], s52 offen offset:0 sc1
    v_mul_f32 v8, v6, v104
    v_mul_f32 v9, v6, v105
    s_waitcnt lgkmcnt(4)
    v_mfma_f32_32x32x16_bf16 v[64:79], v[32:35], a[40:43], v[64:79]
    ds_read_b128 v[24:27], v0 offset:1024
    v_mul_f32 v10, v6, v106
    v_mul_f32 v11, v6, v107
    v_exp_f32 v8, v8
    v_mfma_f32_32x32x16_bf16 v[80:95], v[36:39], a[40:43], v[80:95]
    ds_read_b128 v[28:31], v0 offset:13312
    v_exp_f32 v9, v9
    v_exp_f32 v10, v10
    s_waitcnt lgkmcnt(4)
    v_mfma_f32_32x32x16_bf16 v[64:79], v[40:43], a[44:47], v[64:79]
    ds_read_b128 v[32:35], v0 offset:2048
    v_exp_f32 v11, v11
    v_fma_f32 v8, v8, v7, v7
    v_mfma_f32_32x32x16_bf16 v[80:95], v[44:47], a[44:47], v[80:95]
    ds_read_b128 v[36:39], v0 offset:14336
    v_fma_f32 v9, v9, v7, v7
    v_fma_f32 v10, v10, v7, v7
    v_fma_f32 v11, v11, v7, v7
    s_waitcnt lgkmcnt(4)
    v_mfma_f32_32x32x16_bf16 v[64:79], v[16:19], a[48:51], v[64:79]
    ds_read_b128 v[40:43], v0 offset:3072
    v_rcp_f32 v8, v8
    v_rcp_f32 v9, v9
    v_mfma_f32_32x32x16_bf16 v[80:95], v[20:23], a[48:51], v[80:95]
    ds_read_b128 v[44:47], v0 offset:15360
    v_rcp_f32 v10, v10
    v_rcp_f32 v11, v11
    s_waitcnt lgkmcnt(4)
    v_mfma_f32_32x32x16_bf16 v[64:79], v[24:27], a[52:55], v[64:79]
    ds_read_b128 v[16:19], v0 offset:4096
    v_mul_f32 v8, v104, v8
    v_mul_f32 v9, v105, v9
    v_mul_f32 v10, v106, v10
    v_mfma_f32_32x32x16_bf16 v[80:95], v[28:31], a[52:55], v[80:95]
    ds_read_b128 v[20:23], v0 offset:16384
    v_mul_f32 v11, v107, v11
    v_cvt_pk_bf16_f32 v104, v8, v9
    v_cvt_pk_bf16_f32 v105, v10, v11
    s_waitcnt lgkmcnt(4)
    v_mfma_f32_32x32x16_bf16 v[64:79], v[32:35], a[56:59], v[64:79]
    ds_read_b128 v[24:27], v0 offset:5120
    v_mul_f32 v8, v6, v108
    v_mul_f32 v9, v6, v109
    v_mul_f32 v10, v6, v110
    v_mul_f32 v11, v6, v111
    v_mfma_f32_32x32x16_bf16 v[80:95], v[36:39], a[56:59], v[80:95]
    ds_read_b128 v[28:31], v0 offset:17408
    v_exp_f32 v8, v8
    v_exp_f32 v9, v9
    s_waitcnt lgkmcnt(4)
    v_mfma_f32_32x32x16_bf16 v[64:79], v[40:43], a[60:63], v[64:79]
    ds_read_b128 v[32:35], v0 offset:6144
    v_exp_f32 v10, v10
    v_mfma_f32_32x32x16_bf16 v[80:95], v[44:47], a[60:63], v[80:95]
    ds_read_b128 v[36:39], v0 offset:18432
    v_exp_f32 v11, v11
    v_fma_f32 v8, v8, v7, v7
    v_fma_f32 v9, v9, v7, v7
    s_waitcnt lgkmcnt(4)
    v_mfma_f32_32x32x16_bf16 v[64:79], v[16:19], a[64:67], v[64:79]
    ds_read_b128 v[40:43], v0 offset:7168
    v_fma_f32 v10, v10, v7, v7
    v_fma_f32 v11, v11, v7, v7
    v_rcp_f32 v8, v8
    v_mfma_f32_32x32x16_bf16 v[80:95], v[20:23], a[64:67], v[80:95]
    ds_read_b128 v[44:47], v0 offset:19456
    v_rcp_f32 v9, v9
    v_rcp_f32 v10, v10
    s_waitcnt lgkmcnt(4)
    v_mfma_f32_32x32x16_bf16 v[64:79], v[24:27], a[68:71], v[64:79]
    ds_read_b128 v[16:19], v0 offset:8192
    v_rcp_f32 v11, v11
    v_mul_f32 v8, v108, v8
    v_mfma_f32_32x32x16_bf16 v[80:95], v[28:31], a[68:71], v[80:95]
    ds_read_b128 v[20:23], v0 offset:20480
    v_mul_f32 v9, v109, v9
    v_mul_f32 v10, v110, v10
    v_mul_f32 v11, v111, v11
    s_waitcnt lgkmcnt(4)
    v_mfma_f32_32x32x16_bf16 v[64:79], v[32:35], a[72:75], v[64:79]
    ds_read_b128 v[24:27], v0 offset:9216
    v_cvt_pk_bf16_f32 v106, v8, v9
    v_cvt_pk_bf16_f32 v107, v10, v11
    buffer_store_dwordx4 v[104:107], v2, s[40:43], s52 offen offset:512 sc1
    s_add_u32 s52, s52, 4096
    v_mfma_f32_32x32x16_bf16 v[80:95], v[36:39], a[72:75], v[80:95]
    ds_read_b128 v[28:31], v0 offset:21504
    v_mul_f32 v8, v6, v48
    v_mul_f32 v9, v6, v49
    v_mul_f32 v10, v6, v50
    v_mul_f32 v11, v6, v51
    s_waitcnt lgkmcnt(4)
    v_mfma_f32_32x32x16_bf16 v[64:79], v[40:43], a[76:79], v[64:79]
    ds_read_b128 v[32:35], v0 offset:10240
    v_exp_f32 v8, v8
    v_exp_f32 v9, v9
    v_mfma_f32_32x32x16_bf16 v[80:95], v[44:47], a[76:79], v[80:95]
    ds_read_b128 v[36:39], v0 offset:22528
    v_exp_f32 v10, v10
    s_waitcnt lgkmcnt(4)
    v_mfma_f32_32x32x16_bf16 v[64:79], v[16:19], a[80:83], v[64:79]
    ds_read_b128 v[40:43], v0 offset:11264
    v_exp_f32 v11, v11
    v_fma_f32 v8, v8, v7, v7
    v_fma_f32 v9, v9, v7, v7
    v_mfma_f32_32x32x16_bf16 v[80:95], v[20:23], a[80:83], v[80:95]
    ds_read_b128 v[44:47], v0 offset:23552
    v_fma_f32 v10, v10, v7, v7
    v_fma_f32 v11, v11, v7, v7
    v_rcp_f32 v8, v8
    s_waitcnt lgkmcnt(4)
    v_mfma_f32_32x32x16_bf16 v[64:79], v[24:27], a[84:87], v[64:79]
    s_barrier
    ds_read_b128 v[16:19], v0 offset:24576
    v_rcp_f32 v9, v9
    v_rcp_f32 v10, v10
    v_mfma_f32_32x32x16_bf16 v[80:95], v[28:31], a[84:87], v[80:95]
    ds_read_b128 v[20:23], v0 offset:36864
    v_rcp_f32 v11, v11
    v_mul_f32 v8, v48, v8
    s_waitcnt lgkmcnt(4)
    v_mfma_f32_32x32x16_bf16 v[64:79], v[32:35], a[88:91], v[64:79]
    ds_read_b128 v[24:27], v0 offset:25600
    v_mul_f32 v9, v49, v9
    v_mul_f32 v10, v50, v10
    v_mul_f32 v11, v51, v11
    v_mfma_f32_32x32x16_bf16 v[80:95], v[36:39], a[88:91], v[80:95]
    ds_read_b128 v[28:31], v0 offset:37888
    v_cvt_pk_bf16_f32 v48, v8, v9
    v_cvt_pk_bf16_f32 v49, v10, v11
    v_mul_f32 v8, v6, v52
    v_mul_f32 v9, v6, v53
    s_waitcnt lgkmcnt(4)
    v_mfma_f32_32x32x16_bf16 v[64:79], v[40:43], a[92:95], v[64:79]
    ds_read_b128 v[32:35], v0 offset:26624
    v_mul_f32 v10, v6, v54
    v_mul_f32 v11, v6, v55
    v_exp_f32 v8, v8
    v_mfma_f32_32x32x16_bf16 v[80:95], v[44:47], a[92:95], v[80:95]
    ds_read_b128 v[36:39], v0 offset:38912
    v_exp_f32 v9, v9
    s_waitcnt lgkmcnt(4)
    v_mfma_f32_32x32x16_bf16 v[64:79], v[16:19], a[96:99], v[64:79]
    ds_read_b128 v[40:43], v0 offset:27648
    v_exp_f32 v10, v10
    v_exp_f32 v11, v11
    v_mfma_f32_32x32x16_bf16 v[80:95], v[20:23], a[96:99], v[80:95]
    ds_read_b128 v[44:47], v0 offset:39936
    v_fma_f32 v8, v8, v7, v7
    v_fma_f32 v9, v9, v7, v7
    v_fma_f32 v10, v10, v7, v7
    v_fma_f32 v11, v11, v7, v7
    s_waitcnt lgkmcnt(4)
    v_mfma_f32_32x32x16_bf16 v[64:79], v[24:27], a[100:103], v[64:79]
    ds_read_b128 v[16:19], v0 offset:28672
    v_rcp_f32 v8, v8
    v_rcp_f32 v9, v9
    v_mfma_f32_32x32x16_bf16 v[80:95], v[28:31], a[100:103], v[80:95]
    ds_read_b128 v[20:23], v0 offset:40960
    v_rcp_f32 v10, v10
    s_waitcnt lgkmcnt(4)
    v_mfma_f32_32x32x16_bf16 v[64:79], v[32:35], a[104:107], v[64:79]
    ds_read_b64 v[12:13], v3 offset:2560
    ds_read_b64 v[14:15], v3 offset:3072
    ds_read_b128 v[24:27], v0 offset:29696
    v_rcp_f32 v11, v11
    v_mul_f32 v8, v52, v8
    v_mul_f32 v9, v53, v9
    v_mfma_f32_32x32x16_bf16 v[80:95], v[36:39], a[104:107], v[80:95]
    ds_read_b128 v[28:31], v0 offset:41984
    v_mul_f32 v10, v54, v10
    v_mul_f32 v11, v55, v11
    v_cvt_pk_bf16_f32 v50, v8, v9
    v_cvt_pk_bf16_f32 v51, v10, v11
    s_waitcnt lgkmcnt(6)
    v_mfma_f32_32x32x16_bf16 v[64:79], v[40:43], a[108:111], v[64:79]
    ds_read_b128 v[32:35], v0 offset:30720
    buffer_store_dwordx4 v[48:51], v2, s[40:43], s52 offen offset:0 sc1
    v_mul_f32 v8, v6, v56
    v_mul_f32 v9, v6, v57
    v_mfma_f32_32x32x16_bf16 v[80:95], v[44:47], a[108:111], v[80:95]
    ds_read_b128 v[36:39], v0 offset:43008
    v_mul_f32 v10, v6, v58
    v_mul_f32 v11, v6, v59
    v_exp_f32 v8, v8
    s_waitcnt lgkmcnt(6)
    v_mfma_f32_32x32x16_bf16 v[64:79], v[16:19], a[112:115], v[64:79]
    ds_read_b128 v[40:43], v0 offset:31744
    v_exp_f32 v9, v9
    v_exp_f32 v10, v10
    v_mfma_f32_32x32x16_bf16 v[80:95], v[20:23], a[112:115], v[80:95]
    ds_read_b128 v[44:47], v0 offset:44032
    v_exp_f32 v11, v11
    v_fma_f32 v8, v8, v7, v7
    s_waitcnt lgkmcnt(4)
    v_mfma_f32_32x32x16_bf16 v[64:79], v[24:27], a[116:119], v[64:79]
    ds_read_b128 v[16:19], v0 offset:32768
    v_fma_f32 v9, v9, v7, v7
    v_fma_f32 v10, v10, v7, v7
    v_fma_f32 v11, v11, v7, v7
    v_mfma_f32_32x32x16_bf16 v[80:95], v[28:31], a[116:119], v[80:95]
    ds_read_b128 v[20:23], v0 offset:45056
    v_rcp_f32 v8, v8
    v_rcp_f32 v9, v9
    s_waitcnt lgkmcnt(4)
    v_mfma_f32_32x32x16_bf16 v[64:79], v[32:35], a[120:123], v[64:79]
    ds_read_b128 v[24:27], v0 offset:33792
    v_rcp_f32 v10, v10
    v_rcp_f32 v11, v11
    v_mfma_f32_32x32x16_bf16 v[80:95], v[36:39], a[120:123], v[80:95]
    ds_read_b128 v[28:31], v0 offset:46080
    v_mul_f32 v8, v56, v8
    v_mul_f32 v9, v57, v9
    v_mul_f32 v10, v58, v10
    v_mfma_f32_32x32x8_bf16 v[64:79], v[12:13], v[4:5], v[64:79]
    v_mfma_f32_32x32x8_bf16 v[80:95], v[14:15], v[4:5], v[80:95]
    s_waitcnt lgkmcnt(4)
    v_mfma_f32_32x32x16_bf16 v[64:79], v[40:43], a[124:127], v[64:79]
    ds_read_b128 v[32:35], v0 offset:34816
    v_mul_f32 v11, v59, v11
    v_cvt_pk_bf16_f32 v56, v8, v9
    v_cvt_pk_bf16_f32 v57, v10, v11
    v_mfma_f32_32x32x16_bf16 v[80:95], v[44:47], a[124:127], v[80:95]
    ds_read_b128 v[36:39], v0 offset:47104
    v_mul_f32 v8, v6, v60
    v_mul_f32 v9, v6, v61
    v_mul_f32 v10, v6, v62
    v_mul_f32 v11, v6, v63
    s_waitcnt lgkmcnt(4)
    v_mfma_f32_32x32x16_bf16 v[64:79], v[16:19], a[128:131], v[64:79]
    ds_read_b128 v[40:43], v0 offset:35840
    v_exp_f32 v8, v8
    v_exp_f32 v9, v9
    v_mfma_f32_32x32x16_bf16 v[80:95], v[20:23], a[128:131], v[80:95]
    ds_read_b128 v[44:47], v0 offset:48128
    v_exp_f32 v10, v10
    s_waitcnt lgkmcnt(4)
    v_mfma_f32_32x32x16_bf16 v[64:79], v[24:27], a[132:135], v[64:79]
    s_waitcnt vmcnt(1)
    s_barrier
    v_add_u32 v0, 0, v1
    ds_read_b128 v[16:19], v0 offset:0
    v_exp_f32 v11, v11
    v_fma_f32 v8, v8, v7, v7
    v_fma_f32 v9, v9, v7, v7
    v_mfma_f32_32x32x16_bf16 v[80:95], v[28:31], a[132:135], v[80:95]
    ds_read_b128 v[20:23], v0 offset:12288
    v_fma_f32 v10, v10, v7, v7
    v_fma_f32 v11, v11, v7, v7
    v_rcp_f32 v8, v8
    s_waitcnt lgkmcnt(4)
    v_mfma_f32_32x32x16_bf16 v[64:79], v[32:35], a[136:139], v[64:79]
    ds_read_b128 v[24:27], v0 offset:1024
    v_rcp_f32 v9, v9
    v_rcp_f32 v10, v10
    v_mfma_f32_32x32x16_bf16 v[80:95], v[36:39], a[136:139], v[80:95]
    ds_read_b128 v[28:31], v0 offset:13312
    v_rcp_f32 v11, v11
    v_mul_f32 v8, v60, v8
    s_waitcnt lgkmcnt(4)
    v_mfma_f32_32x32x16_bf16 v[64:79], v[40:43], a[140:143], v[64:79]
    ds_read_b128 v[32:35], v0 offset:2048
    v_mul_f32 v9, v61, v9
    v_mul_f32 v10, v62, v10
    v_mul_f32 v11, v63, v11
    v_mfma_f32_32x32x16_bf16 v[80:95], v[44:47], a[140:143], v[80:95]
    ds_read_b128 v[36:39], v0 offset:14336
    v_cvt_pk_bf16_f32 v58, v8, v9
    v_cvt_pk_bf16_f32 v59, v10, v11
    buffer_store_dwordx4 v[56:59], v2, s[40:43], s52 offen offset:512 sc1
    s_add_u32 s52, s52, 4096
    s_waitcnt lgkmcnt(4)
    v_mfma_f32_32x32x16_bf16 v[96:111], v[16:19], a[0:3], 0
    ds_read_b128 v[40:43], v0 offset:3072
    v_mfma_f32_32x32x16_bf16 v[48:63], v[20:23], a[0:3], 0
    ds_read_b128 v[44:47], v0 offset:15360
    s_waitcnt lgkmcnt(4)
    v_mfma_f32_32x32x16_bf16 v[96:111], v[24:27], a[4:7], v[96:111]
    ds_read_b128 v[16:19], v0 offset:4096
    v_mul_f32 v8, v6, v64
    v_mul_f32 v9, v6, v65
    v_mul_f32 v10, v6, v66
    v_mul_f32 v11, v6, v67
    v_mfma_f32_32x32x16_bf16 v[48:63], v[28:31], a[4:7], v[48:63]
    ds_read_b128 v[20:23], v0 offset:16384
    v_exp_f32 v8, v8
    v_exp_f32 v9, v9
    s_waitcnt lgkmcnt(4)
    v_mfma_f32_32x32x16_bf16 v[96:111], v[32:35], a[8:11], v[96:111]
    ds_read_b128 v[24:27], v0 offset:5120
    v_exp_f32 v10, v10
    v_mfma_f32_32x32x16_bf16 v[48:63], v[36:39], a[8:11], v[48:63]
    ds_read_b128 v[28:31], v0 offset:17408
    v_exp_f32 v11, v11
    v_fma_f32 v8, v8, v7, v7
    v_fma_f32 v9, v9, v7, v7
    s_waitcnt lgkmcnt(4)
    v_mfma_f32_32x32x16_bf16 v[96:111], v[40:43], a[12:15], v[96:111]
    ds_read_b128 v[32:35], v0 offset:6144
    v_fma_f32 v10, v10, v7, v7
    v_fma_f32 v11, v11, v7, v7
    v_rcp_f32 v8, v8
    v_mfma_f32_32x32x16_bf16 v[48:63], v[44:47], a[12:15], v[48:63]
    ds_read_b128 v[36:39], v0 offset:18432
    v_rcp_f32 v9, v9
    v_rcp_f32 v10, v10
    s_waitcnt lgkmcnt(4)
    v_mfma_f32_32x32x16_bf16 v[96:111], v[16:19], a[16:19], v[96:111]
    ds_read_b128 v[40:43], v0 offset:7168
    v_rcp_f32 v11, v11
    v_mul_f32 v8, v64, v8
    v_mfma_f32_32x32x16_bf16 v[48:63], v[20:23], a[16:19], v[48:63]
    ds_read_b128 v[44:47], v0 offset:19456
    v_mul_f32 v9, v65, v9
    v_mul_f32 v10, v66, v10
    v_mul_f32 v11, v67, v11
    s_waitcnt lgkmcnt(4)
    v_mfma_f32_32x32x16_bf16 v[96:111], v[24:27], a[20:23], v[96:111]
    ds_read_b128 v[16:19], v0 offset:8192
    v_cvt_pk_bf16_f32 v64, v8, v9
    v_cvt_pk_bf16_f32 v65, v10, v11
    v_mul_f32 v8, v6, v68
    v_mul_f32 v9, v6, v69
    v_mfma_f32_32x32x16_bf16 v[48:63], v[28:31], a[20:23], v[48:63]
    ds_read_b128 v[20:23], v0 offset:20480
    v_mul_f32 v10, v6, v70
    v_mul_f32 v11, v6, v71
    v_exp_f32 v8, v8
    s_waitcnt lgkmcnt(4)
    v_mfma_f32_32x32x16_bf16 v[96:111], v[32:35], a[24:27], v[96:111]
    ds_read_b128 v[24:27], v0 offset:9216
    v_exp_f32 v9, v9
    v_mfma_f32_32x32x16_bf16 v[48:63], v[36:39], a[24:27], v[48:63]
    ds_read_b128 v[28:31], v0 offset:21504
    v_exp_f32 v10, v10
    v_exp_f32 v11, v11
    s_waitcnt lgkmcnt(4)
    v_mfma_f32_32x32x16_bf16 v[96:111], v[40:43], a[28:31], v[96:111]
    ds_read_b128 v[32:35], v0 offset:10240
    v_fma_f32 v8, v8, v7, v7
    v_fma_f32 v9, v9, v7, v7
    v_fma_f32 v10, v10, v7, v7
    v_fma_f32 v11, v11, v7, v7
    v_mfma_f32_32x32x16_bf16 v[48:63], v[44:47], a[28:31], v[48:63]
    ds_read_b128 v[36:39], v0 offset:22528
    v_rcp_f32 v8, v8
    v_rcp_f32 v9, v9
    s_waitcnt lgkmcnt(4)
    v_mfma_f32_32x32x16_bf16 v[96:111], v[16:19], a[32:35], v[96:111]
    ds_read_b128 v[40:43], v0 offset:11264
    v_rcp_f32 v10, v10
    v_mfma_f32_32x32x16_bf16 v[48:63], v[20:23], a[32:35], v[48:63]
    ds_read_b128 v[44:47], v0 offset:23552
    v_rcp_f32 v11, v11
    v_mul_f32 v8, v68, v8
    v_mul_f32 v9, v69, v9
    s_waitcnt lgkmcnt(4)
    v_mfma_f32_32x32x16_bf16 v[96:111], v[24:27], a[36:39], v[96:111]
    s_barrier
    ds_read_b128 v[16:19], v0 offset:24576
    v_mul_f32 v10, v70, v10
    v_mul_f32 v11, v71, v11
    v_cvt_pk_bf16_f32 v66, v8, v9
    v_cvt_pk_bf16_f32 v67, v10, v11
    v_mfma_f32_32x32x16_bf16 v[48:63], v[28:31], a[36:39], v[48:63]
    ds_read_b128 v[20:23], v0 offset:36864
    buffer_store_dwordx4 v[64:67], v2, s[40:43], s52 offen offset:0 sc1
    v_mul_f32 v8, v6, v72
    v_mul_f32 v9, v6, v73
    s_waitcnt lgkmcnt(4)
    v_mfma_f32_32x32x16_bf16 v[96:111], v[32:35], a[40:43], v[96:111]
    ds_read_b128 v[24:27], v0 offset:25600
    v_mul_f32 v10, v6, v74
    v_mul_f32 v11, v6, v75
    v_exp_f32 v8, v8
    v_mfma_f32_32x32x16_bf16 v[48:63], v[36:39], a[40:43], v[48:63]
    ds_read_b128 v[28:31], v0 offset:37888
    v_exp_f32 v9, v9
    v_exp_f32 v10, v10
    s_waitcnt lgkmcnt(4)
    v_mfma_f32_32x32x16_bf16 v[96:111], v[40:43], a[44:47], v[96:111]
    ds_read_b128 v[32:35], v0 offset:26624
    v_exp_f32 v11, v11
    v_fma_f32 v8, v8, v7, v7
    v_mfma_f32_32x32x16_bf16 v[48:63], v[44:47], a[44:47], v[48:63]
    ds_read_b128 v[36:39], v0 offset:38912
    v_fma_f32 v9, v9, v7, v7
    v_fma_f32 v10, v10, v7, v7
    v_fma_f32 v11, v11, v7, v7
    s_waitcnt lgkmcnt(4)
    v_mfma_f32_32x32x16_bf16 v[96:111], v[16:19], a[48:51], v[96:111]
    ds_read_b128 v[40:43], v0 offset:27648
    v_rcp_f32 v8, v8
    v_rcp_f32 v9, v9
    v_mfma_f32_32x32x16_bf16 v[48:63], v[20:23], a[48:51], v[48:63]
    ds_read_b128 v[44:47], v0 offset:39936
    s_waitcnt vmcnt(9)
    s_add_u32 s17, s8, 0
    buffer_load_dwordx4 a[0:3], v1, s[40:43], s17 offen sc1
    v_rcp_f32 v10, v10
    v_rcp_f32 v11, v11
    s_waitcnt lgkmcnt(4)
    v_mfma_f32_32x32x16_bf16 v[96:111], v[24:27], a[52:55], v[96:111]
    ds_read_b128 v[16:19], v0 offset:28672
    v_mul_f32 v8, v72, v8
    v_mul_f32 v9, v73, v9
    v_mul_f32 v10, v74, v10
    v_mfma_f32_32x32x16_bf16 v[48:63], v[28:31], a[52:55], v[48:63]
    ds_read_b128 v[20:23], v0 offset:40960
    s_add_u32 s17, s12, 0
    buffer_load_dwordx4 a[4:7], v1, s[40:43], s17 offen sc1
    v_mul_f32 v11, v75, v11
    v_cvt_pk_bf16_f32 v72, v8, v9
    v_cvt_pk_bf16_f32 v73, v10, v11
    s_waitcnt lgkmcnt(4)
    v_mfma_f32_32x32x16_bf16 v[96:111], v[32:35], a[56:59], v[96:111]
    ds_read_b128 v[24:27], v0 offset:29696
    v_mul_f32 v8, v6, v76
    v_mul_f32 v9, v6, v77
    v_mul_f32 v10, v6, v78
    v_mul_f32 v11, v6, v79
    v_mfma_f32_32x32x16_bf16 v[48:63], v[36:39], a[56:59], v[48:63]
    ds_read_b128 v[28:31], v0 offset:41984
    s_waitcnt vmcnt(9)
    s_add_u32 s17, s8, 4096
    buffer_load_dwordx4 a[8:11], v1, s[40:43], s17 offen sc1
    v_exp_f32 v8, v8
    v_exp_f32 v9, v9
    s_waitcnt lgkmcnt(4)
    v_mfma_f32_32x32x16_bf16 v[96:111], v[40:43], a[60:63], v[96:111]
    ds_read_b128 v[32:35], v0 offset:30720
    v_exp_f32 v10, v10
    v_mfma_f32_32x32x16_bf16 v[48:63], v[44:47], a[60:63], v[48:63]
    ds_read_b128 v[36:39], v0 offset:43008
    s_add_u32 s17, s12, 4096
    buffer_load_dwordx4 a[12:15], v1, s[40:43], s17 offen sc1
    v_exp_f32 v11, v11
    v_fma_f32 v8, v8, v7, v7
    v_fma_f32 v9, v9, v7, v7
    s_waitcnt lgkmcnt(4)
    v_mfma_f32_32x32x16_bf16 v[96:111], v[16:19], a[64:67], v[96:111]
    ds_read_b128 v[40:43], v0 offset:31744
    v_fma_f32 v10, v10, v7, v7
    v_fma_f32 v11, v11, v7, v7
    v_rcp_f32 v8, v8
    v_mfma_f32_32x32x16_bf16 v[48:63], v[20:23], a[64:67], v[48:63]
    ds_read_b128 v[44:47], v0 offset:44032
    s_waitcnt vmcnt(9)
    s_add_u32 s17, s8, 8192
    buffer_load_dwordx4 a[16:19], v1, s[40:43], s17 offen sc1
    v_rcp_f32 v9, v9
    v_rcp_f32 v10, v10
    s_waitcnt lgkmcnt(4)
    v_mfma_f32_32x32x16_bf16 v[96:111], v[24:27], a[68:71], v[96:111]
    ds_read_b128 v[16:19], v0 offset:32768
    v_rcp_f32 v11, v11
    v_mul_f32 v8, v76, v8
    v_mfma_f32_32x32x16_bf16 v[48:63], v[28:31], a[68:71], v[48:63]
    ds_read_b128 v[20:23], v0 offset:45056
    s_add_u32 s17, s12, 8192
    buffer_load_dwordx4 a[20:23], v1, s[40:43], s17 offen sc1
    v_mul_f32 v9, v77, v9
    v_mul_f32 v10, v78, v10
    v_mul_f32 v11, v79, v11
    s_waitcnt lgkmcnt(4)
    v_mfma_f32_32x32x16_bf16 v[96:111], v[32:35], a[72:75], v[96:111]
    ds_read_b128 v[24:27], v0 offset:33792
    v_cvt_pk_bf16_f32 v74, v8, v9
    v_cvt_pk_bf16_f32 v75, v10, v11
    buffer_store_dwordx4 v[72:75], v2, s[40:43], s52 offen offset:512 sc1
    s_add_u32 s52, s52, 4096
    v_mfma_f32_32x32x16_bf16 v[48:63], v[36:39], a[72:75], v[48:63]
    ds_read_b128 v[28:31], v0 offset:46080
    s_add_u32 s17, s9, 0
    buffer_load_dwordx4 a[24:27], v1, s[40:43], s17 offen sc1
    v_mul_f32 v8, v6, v80
    v_mul_f32 v9, v6, v81
    v_mul_f32 v10, v6, v82
    v_mul_f32 v11, v6, v83
    s_waitcnt lgkmcnt(4)
    v_mfma_f32_32x32x16_bf16 v[96:111], v[40:43], a[76:79], v[96:111]
    ds_read_b128 v[32:35], v0 offset:34816
    v_exp_f32 v8, v8
    v_exp_f32 v9, v9
    v_mfma_f32_32x32x16_bf16 v[48:63], v[44:47], a[76:79], v[48:63]
    ds_read_b128 v[36:39], v0 offset:47104
    s_add_u32 s17, s13, 0
    buffer_load_dwordx4 a[28:31], v1, s[40:43], s17 offen sc1
    v_exp_f32 v10, v10
    s_waitcnt lgkmcnt(4)
    v_mfma_f32_32x32x16_bf16 v[96:111], v[16:19], a[80:83], v[96:111]
    ds_read_b128 v[40:43], v0 offset:35840
    v_exp_f32 v11, v11
    v_fma_f32 v8, v8, v7, v7
    v_fma_f32 v9, v9, v7, v7
    v_mfma_f32_32x32x16_bf16 v[48:63], v[20:23], a[80:83], v[48:63]
    ds_read_b128 v[44:47], v0 offset:48128
    s_add_u32 s17, s10, 0
    buffer_load_dwordx4 a[32:35], v1, s[40:43], s17 offen sc1
    v_fma_f32 v10, v10, v7, v7
    v_fma_f32 v11, v11, v7, v7
    v_rcp_f32 v8, v8
    s_waitcnt lgkmcnt(4)
    v_mfma_f32_32x32x16_bf16 v[96:111], v[24:27], a[84:87], v[96:111]
    s_barrier
    v_add_u32 v0, 49152, v1
    ds_read_b128 v[16:19], v0 offset:0
    v_rcp_f32 v9, v9
    v_rcp_f32 v10, v10
    v_mfma_f32_32x32x16_bf16 v[48:63], v[28:31], a[84:87], v[48:63]
    ds_read_b128 v[20:23], v0 offset:12288
    s_add_u32 s17, s14, 0
    buffer_load_dwordx4 a[36:39], v1, s[40:43], s17 offen sc1
    v_rcp_f32 v11, v11
    v_mul_f32 v8, v80, v8
    s_waitcnt lgkmcnt(4)
    v_mfma_f32_32x32x16_bf16 v[96:111], v[32:35], a[88:91], v[96:111]
    ds_read_b128 v[24:27], v0 offset:1024
    v_mul_f32 v9, v81, v9
    v_mul_f32 v10, v82, v10
    v_mul_f32 v11, v83, v11
    v_mfma_f32_32x32x16_bf16 v[48:63], v[36:39], a[88:91], v[48:63]
    ds_read_b128 v[28:31], v0 offset:13312
    s_add_u32 s17, s11, 0
    buffer_load_dwordx4 a[40:43], v1, s[40:43], s17 offen sc1
    v_cvt_pk_bf16_f32 v80, v8, v9
    v_cvt_pk_bf16_f32 v81, v10, v11
    v_mul_f32 v8, v6, v84
    v_mul_f32 v9, v6, v85
    s_waitcnt lgkmcnt(4)
    v_mfma_f32_32x32x16_bf16 v[96:111], v[40:43], a[92:95], v[96:111]
    ds_read_b128 v[32:35], v0 offset:2048
    v_mul_f32 v10, v6, v86
    v_mul_f32 v11, v6, v87
    v_exp_f32 v8, v8
    v_mfma_f32_32x32x16_bf16 v[48:63], v[44:47], a[92:95], v[48:63]
    ds_read_b128 v[36:39], v0 offset:14336
    s_add_u32 s17, s15, 0
    buffer_load_dwordx4 a[44:47], v1, s[40:43], s17 offen sc1
    v_exp_f32 v9, v9
    s_waitcnt lgkmcnt(4)
    v_mfma_f32_32x32x16_bf16 v[96:111], v[16:19], a[96:99], v[96:111]
    ds_read_b128 v[40:43], v0 offset:3072
    v_exp_f32 v10, v10
    v_exp_f32 v11, v11
    v_mfma_f32_32x32x16_bf16 v[48:63], v[20:23], a[96:99], v[48:63]
    ds_read_b128 v[44:47], v0 offset:15360
    s_waitcnt vmcnt(16)
    s_add_u32 s17, s8, 12288
    buffer_load_dwordx4 a[48:51], v1, s[40:43], s17 offen sc1
    v_fma_f32 v8, v8, v7, v7
    v_fma_f32 v9, v9, v7, v7
    v_fma_f32 v10, v10, v7, v7
    v_fma_f32 v11, v11, v7, v7
    s_waitcnt lgkmcnt(4)
    v_mfma_f32_32x32x16_bf16 v[96:111], v[24:27], a[100:103], v[96:111]
    ds_read_b128 v[16:19], v0 offset:4096
    v_rcp_f32 v8, v8
    v_rcp_f32 v9, v9
    v_mfma_f32_32x32x16_bf16 v[48:63], v[28:31], a[100:103], v[48:63]
    ds_read_b128 v[20:23], v0 offset:16384
    s_add_u32 s17, s12, 12288
    buffer_load_dwordx4 a[52:55], v1, s[40:43], s17 offen sc1
    v_rcp_f32 v10, v10
    s_waitcnt lgkmcnt(4)
    v_mfma_f32_32x32x16_bf16 v[96:111], v[32:35], a[104:107], v[96:111]
    ds_read_b64 v[12:13], v3 offset:3584
    ds_read_b64 v[14:15], v3 offset:0
    ds_read_b128 v[24:27], v0 offset:5120
    v_rcp_f32 v11, v11
    v_mul_f32 v8, v84, v8
    v_mul_f32 v9, v85, v9
    v_mfma_f32_32x32x16_bf16 v[48:63], v[36:39], a[104:107], v[48:63]
    ds_read_b128 v[28:31], v0 offset:17408
    s_add_u32 s17, s9, 4096
    buffer_load_dwordx4 a[56:59], v1, s[40:43], s17 offen sc1
    v_mul_f32 v10, v86, v10
    v_mul_f32 v11, v87, v11
    v_cvt_pk_bf16_f32 v82, v8, v9
    v_cvt_pk_bf16_f32 v83, v10, v11
    s_waitcnt lgkmcnt(6)
    v_mfma_f32_32x32x16_bf16 v[96:111], v[40:43], a[108:111], v[96:111]
    ds_read_b128 v[32:35], v0 offset:6144
    buffer_store_dwordx4 v[80:83], v2, s[40:43], s52 offen offset:0 sc1
    v_mul_f32 v8, v6, v88
    v_mul_f32 v9, v6, v89
    v_mfma_f32_32x32x16_bf16 v[48:63], v[44:47], a[108:111], v[48:63]
    ds_read_b128 v[36:39], v0 offset:18432
    s_add_u32 s17, s13, 4096
    buffer_load_dwordx4 a[60:63], v1, s[40:43], s17 offen sc1
    v_mul_f32 v10, v6, v90
    v_mul_f32 v11, v6, v91
    v_exp_f32 v8, v8
    s_waitcnt lgkmcnt(6)
    v_mfma_f32_32x32x16_bf16 v[96:111], v[16:19], a[112:115], v[96:111]
    ds_read_b128 v[40:43], v0 offset:7168
    v_exp_f32 v9, v9
    v_exp_f32 v10, v10
    v_mfma_f32_32x32x16_bf16 v[48:63], v[20:23], a[112:115], v[48:63]
    ds_read_b128 v[44:47], v0 offset:19456
    v_exp_f32 v11, v11
    v_fma_f32 v8, v8, v7, v7
    s_waitcnt lgkmcnt(4)
    v_mfma_f32_32x32x16_bf16 v[96:111], v[24:27], a[116:119], v[96:111]
    ds_read_b128 v[16:19], v0 offset:8192
    v_fma_f32 v9, v9, v7, v7
    v_fma_f32 v10, v10, v7, v7
    v_fma_f32 v11, v11, v7, v7
    v_mfma_f32_32x32x16_bf16 v[48:63], v[28:31], a[116:119], v[48:63]
    ds_read_b128 v[20:23], v0 offset:20480
    v_rcp_f32 v8, v8
    v_rcp_f32 v9, v9
    s_waitcnt lgkmcnt(4)
    v_mfma_f32_32x32x16_bf16 v[96:111], v[32:35], a[120:123], v[96:111]
    ds_read_b128 v[24:27], v0 offset:9216
    v_rcp_f32 v10, v10
    v_rcp_f32 v11, v11
    v_mfma_f32_32x32x16_bf16 v[48:63], v[36:39], a[120:123], v[48:63]
    ds_read_b128 v[28:31], v0 offset:21504
    v_mul_f32 v8, v88, v8
    v_mul_f32 v9, v89, v9
    v_mul_f32 v10, v90, v10
    v_mfma_f32_32x32x8_bf16 v[96:111], v[12:13], v[4:5], v[96:111]
    v_mfma_f32_32x32x8_bf16 v[48:63], v[14:15], v[4:5], v[48:63]
    s_waitcnt lgkmcnt(4)
    v_mfma_f32_32x32x16_bf16 v[96:111], v[40:43], a[124:127], v[96:111]
    ds_read_b128 v[32:35], v0 offset:10240
    v_mul_f32 v11, v91, v11
    v_cvt_pk_bf16_f32 v88, v8, v9
    v_cvt_pk_bf16_f32 v89, v10, v11
    v_mfma_f32_32x32x16_bf16 v[48:63], v[44:47], a[124:127], v[48:63]
    ds_read_b128 v[36:39], v0 offset:22528
    v_mul_f32 v8, v6, v92
    v_mul_f32 v9, v6, v93
    v_mul_f32 v10, v6, v94
    v_mul_f32 v11, v6, v95
    s_waitcnt lgkmcnt(4)
    v_mfma_f32_32x32x16_bf16 v[96:111], v[16:19], a[128:131], v[96:111]
    ds_read_b128 v[40:43], v0 offset:11264
    v_exp_f32 v8, v8
    v_exp_f32 v9, v9
    v_mfma_f32_32x32x16_bf16 v[48:63], v[20:23], a[128:131], v[48:63]
    ds_read_b128 v[44:47], v0 offset:23552
    v_exp_f32 v10, v10
    s_waitcnt lgkmcnt(4)
    v_mfma_f32_32x32x16_bf16 v[96:111], v[24:27], a[132:135], v[96:111]
    v_add_u32 v12, 0, v1
    v_add_u32 v13, 36864, v1
    v_add_u32 v14, 73728, v1
    v_add_u32 v15, 110592, v1
    s_waitcnt vmcnt(11)
    s_barrier
    ds_read_b128 a[72:75], v14 offset:0
    v_exp_f32 v11, v11
    v_fma_f32 v8, v8, v7, v7
    v_fma_f32 v9, v9, v7, v7
    v_mfma_f32_32x32x16_bf16 v[48:63], v[28:31], a[132:135], v[48:63]
    ds_read_b128 a[76:79], v14 offset:1024
    v_fma_f32 v10, v10, v7, v7
    v_fma_f32 v11, v11, v7, v7
    v_rcp_f32 v8, v8
    s_waitcnt lgkmcnt(4)
    v_mfma_f32_32x32x16_bf16 v[96:111], v[32:35], a[136:139], v[96:111]
    ds_read_b128 a[80:83], v14 offset:2048
    ds_read_b128 a[84:87], v14 offset:3072
    v_rcp_f32 v9, v9
    v_rcp_f32 v10, v10
    v_mfma_f32_32x32x16_bf16 v[48:63], v[36:39], a[136:139], v[48:63]
    ds_read_b128 a[88:91], v14 offset:4096
    v_rcp_f32 v11, v11
    v_mul_f32 v8, v92, v8
    s_waitcnt lgkmcnt(5)
    v_mfma_f32_32x32x16_bf16 v[96:111], v[40:43], a[140:143], v[96:111]
    ds_read_b128 a[92:95], v14 offset:5120
    v_mul_f32 v9, v93, v9
    v_mul_f32 v10, v94, v10
    v_mul_f32 v11, v95, v11
    v_mfma_f32_32x32x16_bf16 v[48:63], v[44:47], a[140:143], v[48:63]
    ds_read_b128 a[96:99], v14 offset:6144
    v_cvt_pk_bf16_f32 v90, v8, v9
    v_cvt_pk_bf16_f32 v91, v10, v11
    buffer_store_dwordx4 v[88:91], v2, s[40:43], s52 offen offset:512 sc1
    s_add_u32 s52, s52, 4096
    s_waitcnt vmcnt(17) lgkmcnt(4)
    v_mfma_f32_16x16x32_bf16 v[16:19], a[72:75], a[0:3], 0
    ds_read_b128 a[100:103], v14 offset:7168
    v_mfma_f32_16x16x32_bf16 v[64:67], a[72:75], a[4:7], 0
    v_mfma_f32_16x16x32_bf16 v[20:23], a[76:79], a[0:3], 0
    ds_read_b128 a[72:75], v14 offset:8192
    v_mfma_f32_16x16x32_bf16 v[68:71], a[76:79], a[4:7], 0
    v_mul_f32 v8, v6, v96
    v_mul_f32 v9, v6, v97
    v_mul_f32 v10, v6, v98
    v_mfma_f32_16x16x32_bf16 v[24:27], a[80:83], a[0:3], 0
    ds_read_b128 a[76:79], v14 offset:9216
    v_mfma_f32_16x16x32_bf16 v[72:75], a[80:83], a[4:7], 0
    v_mul_f32 v11, v6, v99
    v_exp_f32 v8, v8
    s_waitcnt lgkmcnt(4)
    v_mfma_f32_16x16x32_bf16 v[28:31], a[84:87], a[0:3], 0
    ds_read_b128 a[80:83], v14 offset:10240
    v_mfma_f32_16x16x32_bf16 v[76:79], a[84:87], a[4:7], 0
    s_add_u32 s17, s10, 4096
    buffer_load_dwordx4 a[64:67], v1, s[40:43], s17 offen sc1
    v_exp_f32 v9, v9
    v_exp_f32 v10, v10
    v_mfma_f32_16x16x32_bf16 a[104:107], a[88:91], a[0:3], 0
    ds_read_b128 a[84:87], v14 offset:11264
    v_mfma_f32_16x16x32_bf16 a[108:111], a[88:91], a[4:7], 0
    v_exp_f32 v11, v11
    v_fma_f32 v8, v8, v7, v7
    v_fma_f32 v9, v9, v7, v7
    v_mfma_f32_16x16x32_bf16 v[32:35], a[92:95], a[0:3], 0
    ds_read_b128 a[88:91], v14 offset:12288
    v_mfma_f32_16x16x32_bf16 v[80:83], a[92:95], a[4:7], 0
    v_fma_f32 v10, v10, v7, v7
    v_fma_f32 v11, v11, v7, v7
    v_rcp_f32 v8, v8
    s_waitcnt lgkmcnt(4)
    v_mfma_f32_16x16x32_bf16 v[36:39], a[96:99], a[0:3], 0
    ds_read_b128 a[92:95], v14 offset:13312
    v_mfma_f32_16x16x32_bf16 v[84:87], a[96:99], a[4:7], 0
    s_add_u32 s17, s14, 4096
    buffer_load_dwordx4 a[68:71], v1, s[40:43], s17 offen sc1
    v_rcp_f32 v9, v9
    v_mfma_f32_16x16x32_bf16 v[40:43], a[100:103], a[0:3], 0
    ds_read_b128 a[96:99], v14 offset:14336
    v_mfma_f32_16x16x32_bf16 v[88:91], a[100:103], a[4:7], 0
    v_rcp_f32 v10, v10
    v_rcp_f32 v11, v11
    v_mfma_f32_16x16x32_bf16 v[44:47], a[72:75], a[0:3], 0
    ds_read_b128 a[100:103], v14 offset:15360
    v_mfma_f32_16x16x32_bf16 v[92:95], a[72:75], a[4:7], 0
    v_mul_f32 v8, v96, v8
    v_mul_f32 v9, v97, v9
    v_mul_f32 v10, v98, v10
    s_waitcnt vmcnt(17) lgkmcnt(4)
    v_mfma_f32_16x16x32_bf16 v[16:19], a[76:79], a[8:11], v[16:19]
    ds_read_b128 a[72:75], v14 offset:16384
    v_mfma_f32_16x16x32_bf16 v[64:67], a[76:79], a[12:15], v[64:67]
    v_mul_f32 v11, v99, v11
    v_cvt_pk_bf16_f32 v96, v8, v9
    v_cvt_pk_bf16_f32 v97, v10, v11
    v_mul_f32 v8, v6, v100
    v_mfma_f32_16x16x32_bf16 v[20:23], a[80:83], a[8:11], v[20:23]
    ds_read_b128 a[76:79], v14 offset:17408
    v_mfma_f32_16x16x32_bf16 v[68:71], a[80:83], a[12:15], v[68:71]
    v_mul_f32 v9, v6, v101
    v_mul_f32 v10, v6, v102
    v_mul_f32 v11, v6, v103
    v_mfma_f32_16x16x32_bf16 v[24:27], a[84:87], a[8:11], v[24:27]
    ds_read_b128 a[80:83], v14 offset:18432
    v_mfma_f32_16x16x32_bf16 v[72:75], a[84:87], a[12:15], v[72:75]
    v_exp_f32 v8, v8
    v_exp_f32 v9, v9
    s_waitcnt lgkmcnt(4)
    v_mfma_f32_16x16x32_bf16 v[28:31], a[88:91], a[8:11], v[28:31]
    ds_read_b128 a[84:87], v14 offset:19456
    v_mfma_f32_16x16x32_bf16 v[76:79], a[88:91], a[12:15], v[76:79]
    s_add_u32 s17, s11, 4096
    buffer_load_dwordx4 a[0:3], v1, s[40:43], s17 offen sc1
    v_exp_f32 v10, v10
    v_exp_f32 v11, v11
    v_mfma_f32_16x16x32_bf16 a[104:107], a[92:95], a[8:11], a[104:107]
    ds_read_b128 a[88:91], v14 offset:20480
    v_mfma_f32_16x16x32_bf16 a[108:111], a[92:95], a[12:15], a[108:111]
    v_fma_f32 v8, v8, v7, v7
    v_fma_f32 v9, v9, v7, v7
    v_mfma_f32_16x16x32_bf16 v[32:35], a[96:99], a[8:11], v[32:35]
    ds_read_b128 a[92:95], v14 offset:21504
    v_mfma_f32_16x16x32_bf16 v[80:83], a[96:99], a[12:15], v[80:83]
    v_fma_f32 v10, v10, v7, v7
    v_fma_f32 v11, v11, v7, v7
    v_rcp_f32 v8, v8
    s_waitcnt lgkmcnt(4)
    v_mfma_f32_16x16x32_bf16 v[36:39], a[100:103], a[8:11], v[36:39]
    ds_read_b128 a[96:99], v14 offset:22528
    v_mfma_f32_16x16x32_bf16 v[84:87], a[100:103], a[12:15], v[84:87]
    s_add_u32 s17, s15, 4096
    buffer_load_dwordx4 a[4:7], v1, s[40:43], s17 offen sc1
    v_rcp_f32 v9, v9
    v_rcp_f32 v10, v10
    v_mfma_f32_16x16x32_bf16 v[40:43], a[72:75], a[8:11], v[40:43]
    ds_read_b128 a[100:103], v14 offset:23552
    v_mfma_f32_16x16x32_bf16 v[88:91], a[72:75], a[12:15], v[88:91]
    v_rcp_f32 v11, v11
    v_mul_f32 v8, v100, v8
    v_mfma_f32_16x16x32_bf16 v[44:47], a[76:79], a[8:11], v[44:47]
    ds_read_b128 a[72:75], v14 offset:24576
    v_mfma_f32_16x16x32_bf16 v[92:95], a[76:79], a[12:15], v[92:95]
    v_mul_f32 v9, v101, v9
    v_mul_f32 v10, v102, v10
    v_mul_f32 v11, v103, v11
    s_waitcnt vmcnt(17) lgkmcnt(4)
    v_mfma_f32_16x16x32_bf16 v[16:19], a[80:83], a[16:19], v[16:19]
    ds_read_b128 a[76:79], v14 offset:25600
    v_mfma_f32_16x16x32_bf16 v[64:67], a[80:83], a[20:23], v[64:67]
    v_cvt_pk_bf16_f32 v98, v8, v9
    v_cvt_pk_bf16_f32 v99, v10, v11
    buffer_store_dwordx4 v[96:99], v2, s[40:43], s52 offen offset:0 sc1
    v_mul_f32 v8, v6, v104
    v_mfma_f32_16x16x32_bf16 v[20:23], a[84:87], a[16:19], v[20:23]
    ds_read_b128 a[80:83], v14 offset:26624
    v_mfma_f32_16x16x32_bf16 v[68:71], a[84:87], a[20:23], v[68:71]
    v_mul_f32 v9, v6, v105
    v_mul_f32 v10, v6, v106
    v_mul_f32 v11, v6, v107
    v_mfma_f32_16x16x32_bf16 v[24:27], a[88:91], a[16:19], v[24:27]
    ds_read_b128 a[84:87], v14 offset:27648
    v_mfma_f32_16x16x32_bf16 v[72:75], a[88:91], a[20:23], v[72:75]
    v_exp_f32 v8, v8
    v_exp_f32 v9, v9
    s_waitcnt lgkmcnt(4)
    v_mfma_f32_16x16x32_bf16 v[28:31], a[92:95], a[16:19], v[28:31]
    ds_read_b128 a[88:91], v14 offset:28672
    v_mfma_f32_16x16x32_bf16 v[76:79], a[92:95], a[20:23], v[76:79]
    s_waitcnt vmcnt(25)
    s_add_u32 s17, s8, 16384
    buffer_load_dwordx4 a[8:11], v1, s[40:43], s17 offen sc1
    v_exp_f32 v10, v10
    v_mfma_f32_16x16x32_bf16 a[104:107], a[96:99], a[16:19], a[104:107]
    ds_read_b128 a[92:95], v14 offset:29696
    v_mfma_f32_16x16x32_bf16 a[108:111], a[96:99], a[20:23], a[108:111]
    v_exp_f32 v11, v11
    v_fma_f32 v8, v8, v7, v7
    v_fma_f32 v9, v9, v7, v7
    v_mfma_f32_16x16x32_bf16 v[32:35], a[100:103], a[16:19], v[32:35]
    ds_read_b128 a[96:99], v14 offset:30720
    v_mfma_f32_16x16x32_bf16 v[80:83], a[100:103], a[20:23], v[80:83]
    v_fma_f32 v10, v10, v7, v7
    v_fma_f32 v11, v11, v7, v7
    v_rcp_f32 v8, v8
    s_waitcnt lgkmcnt(4)
    v_mfma_f32_16x16x32_bf16 v[36:39], a[72:75], a[16:19], v[36:39]
    ds_read_b128 a[100:103], v14 offset:31744
    v_mfma_f32_16x16x32_bf16 v[84:87], a[72:75], a[20:23], v[84:87]
    s_add_u32 s17, s12, 16384
    buffer_load_dwordx4 a[12:15], v1, s[40:43], s17 offen sc1
    v_rcp_f32 v9, v9
    v_rcp_f32 v10, v10
    v_mfma_f32_16x16x32_bf16 v[40:43], a[76:79], a[16:19], v[40:43]
    ds_read_b128 a[72:75], v14 offset:32768
    v_mfma_f32_16x16x32_bf16 v[88:91], a[76:79], a[20:23], v[88:91]
    v_rcp_f32 v11, v11
    v_mfma_f32_16x16x32_bf16 v[44:47], a[80:83], a[16:19], v[44:47]
    ds_read_b128 a[76:79], v14 offset:33792
    v_mfma_f32_16x16x32_bf16 v[92:95], a[80:83], a[20:23], v[92:95]
    v_mul_f32 v8, v104, v8
    v_mul_f32 v9, v105, v9
    v_mul_f32 v10, v106, v10
    v_mul_f32 v11, v107, v11
    s_waitcnt vmcnt(17) lgkmcnt(4)
    v_mfma_f32_16x16x32_bf16 v[16:19], a[84:87], a[24:27], v[16:19]
    ds_read_b128 a[80:83], v14 offset:34816
    v_mfma_f32_16x16x32_bf16 v[64:67], a[84:87], a[28:31], v[64:67]
    v_cvt_pk_bf16_f32 v104, v8, v9
    v_cvt_pk_bf16_f32 v105, v10, v11
    v_mul_f32 v8, v6, v108
    v_mfma_f32_16x16x32_bf16 v[20:23], a[88:91], a[24:27], v[20:23]
    ds_read_b128 a[84:87], v14 offset:35840
    v_mfma_f32_16x16x32_bf16 v[68:71], a[88:91], a[28:31], v[68:71]
    v_mul_f32 v9, v6, v109
    v_mul_f32 v10, v6, v110
    v_mul_f32 v11, v6, v111
    v_mfma_f32_16x16x32_bf16 v[24:27], a[92:95], a[24:27], v[24:27]
    s_barrier
    ds_read_b128 a[88:91], v15 offset:0
    v_mfma_f32_16x16x32_bf16 v[72:75], a[92:95], a[28:31], v[72:75]
    v_exp_f32 v8, v8
    v_exp_f32 v9, v9
    s_waitcnt lgkmcnt(4)
    v_mfma_f32_16x16x32_bf16 v[28:31], a[96:99], a[24:27], v[28:31]
    ds_read_b128 a[92:95], v15 offset:1024
    v_mfma_f32_16x16x32_bf16 v[76:79], a[96:99], a[28:31], v[76:79]
    s_add_u32 s17, s9, 8192
    buffer_load_dwordx4 a[16:19], v1, s[40:43], s17 offen sc1
    v_exp_f32 v10, v10
    v_exp_f32 v11, v11
    v_mfma_f32_16x16x32_bf16 a[104:107], a[100:103], a[24:27], a[104:107]
    ds_read_b128 a[96:99], v15 offset:2048
    v_mfma_f32_16x16x32_bf16 a[108:111], a[100:103], a[28:31], a[108:111]
    v_fma_f32 v8, v8, v7, v7
    v_fma_f32 v9, v9, v7, v7
    v_fma_f32 v10, v10, v7, v7
    v_mfma_f32_16x16x32_bf16 v[32:35], a[72:75], a[24:27], v[32:35]
    ds_read_b128 a[100:103], v15 offset:3072
    v_mfma_f32_16x16x32_bf16 v[80:83], a[72:75], a[28:31], v[80:83]
    v_fma_f32 v11, v11, v7, v7
    v_rcp_f32 v8, v8
    s_waitcnt lgkmcnt(4)
    v_mfma_f32_16x16x32_bf16 v[36:39], a[76:79], a[24:27], v[36:39]
    ds_read_b128 a[72:75], v15 offset:4096
    v_mfma_f32_16x16x32_bf16 v[84:87], a[76:79], a[28:31], v[84:87]
    s_add_u32 s17, s13, 8192
    buffer_load_dwordx4 a[20:23], v1, s[40:43], s17 offen sc1
    v_rcp_f32 v9, v9
    v_rcp_f32 v10, v10
    v_mfma_f32_16x16x32_bf16 v[40:43], a[80:83], a[24:27], v[40:43]
    ds_read_b128 a[76:79], v15 offset:5120
    v_mfma_f32_16x16x32_bf16 v[88:91], a[80:83], a[28:31], v[88:91]
    v_rcp_f32 v11, v11
    v_mul_f32 v8, v108, v8
    v_mfma_f32_16x16x32_bf16 v[44:47], a[84:87], a[24:27], v[44:47]
    ds_read_b128 a[80:83], v15 offset:6144
    v_mfma_f32_16x16x32_bf16 v[92:95], a[84:87], a[28:31], v[92:95]
    v_mul_f32 v9, v109, v9
    v_mul_f32 v10, v110, v10
    v_mul_f32 v11, v111, v11
    v_cvt_pk_bf16_f32 v106, v8, v9
    s_waitcnt vmcnt(17) lgkmcnt(4)
    v_mfma_f32_16x16x32_bf16 v[16:19], a[88:91], a[32:35], v[16:19]
    ds_read_b128 a[84:87], v15 offset:7168
    v_mfma_f32_16x16x32_bf16 v[64:67], a[88:91], a[36:39], v[64:67]
    v_cvt_pk_bf16_f32 v107, v10, v11
    buffer_store_dwordx4 v[104:107], v2, s[40:43], s52 offen offset:512 sc1
    s_add_u32 s52, s52, 4096
    v_mfma_f32_16x16x32_bf16 v[20:23], a[92:95], a[32:35], v[20:23]
    ds_read_b128 a[88:91], v15 offset:8192
    v_mfma_f32_16x16x32_bf16 v[68:71], a[92:95], a[36:39], v[68:71]
    v_mul_f32 v8, v6, v48
    v_mul_f32 v9, v6, v49
    v_mul_f32 v10, v6, v50
    v_mfma_f32_16x16x32_bf16 v[24:27], a[96:99], a[32:35], v[24:27]
    ds_read_b128 a[92:95], v15 offset:9216
    v_mfma_f32_16x16x32_bf16 v[72:75], a[96:99], a[36:39], v[72:75]
    v_mul_f32 v11, v6, v51
    v_exp_f32 v8, v8
    s_waitcnt lgkmcnt(4)
    v_mfma_f32_16x16x32_bf16 v[28:31], a[100:103], a[32:35], v[28:31]
    ds_read_b128 a[96:99], v15 offset:10240
    v_mfma_f32_16x16x32_bf16 v[76:79], a[100:103], a[36:39], v[76:79]
    s_add_u32 s17, s10, 8192
    buffer_load_dwordx4 a[24:27], v1, s[40:43], s17 offen sc1
    v_exp_f32 v9, v9
    v_exp_f32 v10, v10
    v_mfma_f32_16x16x32_bf16 a[104:107], a[72:75], a[32:35], a[104:107]
    ds_read_b128 a[100:103], v15 offset:11264
    v_mfma_f32_16x16x32_bf16 a[108:111], a[72:75], a[36:39], a[108:111]
    v_exp_f32 v11, v11
    v_fma_f32 v8, v8, v7, v7
    v_fma_f32 v9, v9, v7, v7
    v_mfma_f32_16x16x32_bf16 v[32:35], a[76:79], a[32:35], v[32:35]
    ds_read_b128 a[72:75], v15 offset:12288
    v_mfma_f32_16x16x32_bf16 v[80:83], a[76:79], a[36:39], v[80:83]
    v_fma_f32 v10, v10, v7, v7
    v_fma_f32 v11, v11, v7, v7
    v_rcp_f32 v8, v8
    s_waitcnt lgkmcnt(4)
    v_mfma_f32_16x16x32_bf16 v[36:39], a[80:83], a[32:35], v[36:39]
    ds_read_b128 a[76:79], v15 offset:13312
    v_mfma_f32_16x16x32_bf16 v[84:87], a[80:83], a[36:39], v[84:87]
    s_add_u32 s17, s14, 8192
    buffer_load_dwordx4 a[28:31], v1, s[40:43], s17 offen sc1
    v_rcp_f32 v9, v9
    v_mfma_f32_16x16x32_bf16 v[40:43], a[84:87], a[32:35], v[40:43]
    ds_read_b128 a[80:83], v15 offset:14336
    v_mfma_f32_16x16x32_bf16 v[88:91], a[84:87], a[36:39], v[88:91]
    v_rcp_f32 v10, v10
    v_rcp_f32 v11, v11
    v_mfma_f32_16x16x32_bf16 v[44:47], a[88:91], a[32:35], v[44:47]
    ds_read_b128 a[84:87], v15 offset:15360
    v_mfma_f32_16x16x32_bf16 v[92:95], a[88:91], a[36:39], v[92:95]
    v_mul_f32 v8, v48, v8
    v_mul_f32 v9, v49, v9
    v_mul_f32 v10, v50, v10
    s_waitcnt vmcnt(18) lgkmcnt(4)
    v_mfma_f32_16x16x32_bf16 v[16:19], a[92:95], a[40:43], v[16:19]
    ds_read_b128 a[88:91], v15 offset:16384
    v_mfma_f32_16x16x32_bf16 v[64:67], a[92:95], a[44:47], v[64:67]
    v_mul_f32 v11, v51, v11
    v_cvt_pk_bf16_f32 v48, v8, v9
    v_cvt_pk_bf16_f32 v49, v10, v11
    v_mul_f32 v8, v6, v52
    v_mfma_f32_16x16x32_bf16 v[20:23], a[96:99], a[40:43], v[20:23]
    ds_read_b128 a[92:95], v15 offset:17408
    v_mfma_f32_16x16x32_bf16 v[68:71], a[96:99], a[44:47], v[68:71]
    v_mul_f32 v9, v6, v53
    v_mul_f32 v10, v6, v54
    v_mul_f32 v11, v6, v55
    v_mfma_f32_16x16x32_bf16 v[24:27], a[100:103], a[40:43], v[24:27]
    ds_read_b128 a[96:99], v15 offset:18432
    v_mfma_f32_16x16x32_bf16 v[72:75], a[100:103], a[44:47], v[72:75]
    v_exp_f32 v8, v8
    v_exp_f32 v9, v9
    s_waitcnt lgkmcnt(4)
    v_mfma_f32_16x16x32_bf16 v[28:31], a[72:75], a[40:43], v[28:31]
    ds_read_b128 a[100:103], v15 offset:19456
    v_mfma_f32_16x16x32_bf16 v[76:79], a[72:75], a[44:47], v[76:79]
    s_add_u32 s17, s11, 8192
    buffer_load_dwordx4 a[32:35], v1, s[40:43], s17 offen sc1
    v_exp_f32 v10, v10
    v_exp_f32 v11, v11
    v_mfma_f32_16x16x32_bf16 a[104:107], a[76:79], a[40:43], a[104:107]
    ds_read_b128 a[72:75], v15 offset:20480
    v_mfma_f32_16x16x32_bf16 a[108:111], a[76:79], a[44:47], a[108:111]
    v_fma_f32 v8, v8, v7, v7
    v_fma_f32 v9, v9, v7, v7
    v_mfma_f32_16x16x32_bf16 v[32:35], a[80:83], a[40:43], v[32:35]
    ds_read_b128 a[76:79], v15 offset:21504
    v_mfma_f32_16x16x32_bf16 v[80:83], a[80:83], a[44:47], v[80:83]
    v_fma_f32 v10, v10, v7, v7
    v_fma_f32 v11, v11, v7, v7
    v_rcp_f32 v8, v8
    s_waitcnt lgkmcnt(4)
    v_mfma_f32_16x16x32_bf16 v[36:39], a[84:87], a[40:43], v[36:39]
    ds_read_b128 a[80:83], v15 offset:22528
    v_mfma_f32_16x16x32_bf16 v[84:87], a[84:87], a[44:47], v[84:87]
    s_add_u32 s17, s15, 8192
    buffer_load_dwordx4 a[36:39], v1, s[40:43], s17 offen sc1
    v_rcp_f32 v9, v9
    v_rcp_f32 v10, v10
    v_mfma_f32_16x16x32_bf16 v[40:43], a[88:91], a[40:43], v[40:43]
    ds_read_b128 a[84:87], v15 offset:23552
    v_mfma_f32_16x16x32_bf16 v[88:91], a[88:91], a[44:47], v[88:91]
    v_rcp_f32 v11, v11
    v_mul_f32 v8, v52, v8
    v_mfma_f32_16x16x32_bf16 v[44:47], a[92:95], a[40:43], v[44:47]
    ds_read_b128 a[88:91], v15 offset:24576
    v_mfma_f32_16x16x32_bf16 v[92:95], a[92:95], a[44:47], v[92:95]
    v_mul_f32 v9, v53, v9
    v_mul_f32 v10, v54, v10
    v_mul_f32 v11, v55, v11
    s_waitcnt vmcnt(18) lgkmcnt(4)
    v_mfma_f32_16x16x32_bf16 v[16:19], a[96:99], a[48:51], v[16:19]
    ds_read_b128 a[92:95], v15 offset:25600
    v_mfma_f32_16x16x32_bf16 v[64:67], a[96:99], a[52:55], v[64:67]
    v_cvt_pk_bf16_f32 v50, v8, v9
    v_cvt_pk_bf16_f32 v51, v10, v11
    buffer_store_dwordx4 v[48:51], v2, s[40:43], s52 offen offset:0 sc1
    v_mul_f32 v8, v6, v56
    v_mfma_f32_16x16x32_bf16 v[20:23], a[100:103], a[48:51], v[20:23]
    ds_read_b128 a[96:99], v15 offset:26624
    v_mfma_f32_16x16x32_bf16 v[68:71], a[100:103], a[52:55], v[68:71]
    v_mul_f32 v9, v6, v57
    v_mul_f32 v10, v6, v58
    v_mul_f32 v11, v6, v59
    v_mfma_f32_16x16x32_bf16 v[24:27], a[72:75], a[48:51], v[24:27]
    ds_read_b128 a[100:103], v15 offset:27648
    v_mfma_f32_16x16x32_bf16 v[72:75], a[72:75], a[52:55], v[72:75]
    v_exp_f32 v8, v8
    v_exp_f32 v9, v9
    s_waitcnt lgkmcnt(4)
    v_mfma_f32_16x16x32_bf16 v[28:31], a[76:79], a[48:51], v[28:31]
    ds_read_b128 a[72:75], v15 offset:28672
    v_mfma_f32_16x16x32_bf16 v[76:79], a[76:79], a[52:55], v[76:79]
    s_waitcnt vmcnt(27)
    s_add_u32 s17, s8, 20480
    buffer_load_dwordx4 a[40:43], v1, s[40:43], s17 offen sc1
    v_exp_f32 v10, v10
    v_mfma_f32_16x16x32_bf16 a[104:107], a[80:83], a[48:51], a[104:107]
    ds_read_b128 a[76:79], v15 offset:29696
    v_mfma_f32_16x16x32_bf16 a[108:111], a[80:83], a[52:55], a[108:111]
    v_exp_f32 v11, v11
    v_fma_f32 v8, v8, v7, v7
    v_fma_f32 v9, v9, v7, v7
    v_mfma_f32_16x16x32_bf16 v[32:35], a[84:87], a[48:51], v[32:35]
    ds_read_b128 a[80:83], v15 offset:30720
    v_mfma_f32_16x16x32_bf16 v[80:83], a[84:87], a[52:55], v[80:83]
    v_fma_f32 v10, v10, v7, v7
    v_fma_f32 v11, v11, v7, v7
    v_rcp_f32 v8, v8
    s_waitcnt lgkmcnt(4)
    v_mfma_f32_16x16x32_bf16 v[36:39], a[88:91], a[48:51], v[36:39]
    ds_read_b128 a[84:87], v15 offset:31744
    v_mfma_f32_16x16x32_bf16 v[84:87], a[88:91], a[52:55], v[84:87]
    s_add_u32 s17, s12, 20480
    buffer_load_dwordx4 a[44:47], v1, s[40:43], s17 offen sc1
    v_rcp_f32 v9, v9
    v_rcp_f32 v10, v10
    v_mfma_f32_16x16x32_bf16 v[40:43], a[92:95], a[48:51], v[40:43]
    ds_read_b128 a[88:91], v15 offset:32768
    v_mfma_f32_16x16x32_bf16 v[88:91], a[92:95], a[52:55], v[88:91]
    v_rcp_f32 v11, v11
    v_mfma_f32_16x16x32_bf16 v[44:47], a[96:99], a[48:51], v[44:47]
    ds_read_b128 a[92:95], v15 offset:33792
    v_mfma_f32_16x16x32_bf16 v[92:95], a[96:99], a[52:55], v[92:95]
    v_mul_f32 v8, v56, v8
    v_mul_f32 v9, v57, v9
    v_mul_f32 v10, v58, v10
    v_mul_f32 v11, v59, v11
    s_waitcnt vmcnt(18) lgkmcnt(4)
    v_mfma_f32_16x16x32_bf16 v[16:19], a[100:103], a[56:59], v[16:19]
    ds_read_b128 a[96:99], v15 offset:34816
    v_mfma_f32_16x16x32_bf16 v[64:67], a[100:103], a[60:63], v[64:67]
    v_cvt_pk_bf16_f32 v56, v8, v9
    v_cvt_pk_bf16_f32 v57, v10, v11
    v_mul_f32 v8, v6, v60
    v_mfma_f32_16x16x32_bf16 v[20:23], a[72:75], a[56:59], v[20:23]
    ds_read_b128 a[100:103], v15 offset:35840
    v_mfma_f32_16x16x32_bf16 v[68:71], a[72:75], a[60:63], v[68:71]
    v_mul_f32 v9, v6, v61
    v_mul_f32 v10, v6, v62
    v_mul_f32 v11, v6, v63
    v_mfma_f32_16x16x32_bf16 v[24:27], a[76:79], a[56:59], v[24:27]
    s_waitcnt vmcnt(7)
    s_barrier
    ds_read_b128 a[72:75], v12 offset:0
    v_mfma_f32_16x16x32_bf16 v[72:75], a[76:79], a[60:63], v[72:75]
    v_exp_f32 v8, v8
    v_exp_f32 v9, v9
    s_waitcnt lgkmcnt(4)
    v_mfma_f32_16x16x32_bf16 v[28:31], a[80:83], a[56:59], v[28:31]
    ds_read_b128 a[76:79], v12 offset:1024
    v_mfma_f32_16x16x32_bf16 v[76:79], a[80:83], a[60:63], v[76:79]
    s_add_u32 s17, s9, 12288
    buffer_load_dwordx4 a[48:51], v1, s[40:43], s17 offen sc1
    v_exp_f32 v10, v10
    v_exp_f32 v11, v11
    v_mfma_f32_16x16x32_bf16 a[104:107], a[84:87], a[56:59], a[104:107]
    ds_read_b128 a[80:83], v12 offset:2048
    v_mfma_f32_16x16x32_bf16 a[108:111], a[84:87], a[60:63], a[108:111]
    v_fma_f32 v8, v8, v7, v7
    v_fma_f32 v9, v9, v7, v7
    v_fma_f32 v10, v10, v7, v7
    v_mfma_f32_16x16x32_bf16 v[32:35], a[88:91], a[56:59], v[32:35]
    ds_read_b128 a[84:87], v12 offset:3072
    v_mfma_f32_16x16x32_bf16 v[80:83], a[88:91], a[60:63], v[80:83]
    v_fma_f32 v11, v11, v7, v7
    v_rcp_f32 v8, v8
    s_waitcnt lgkmcnt(4)
    v_mfma_f32_16x16x32_bf16 v[36:39], a[92:95], a[56:59], v[36:39]
    ds_read_b128 a[88:91], v12 offset:4096
    v_mfma_f32_16x16x32_bf16 v[84:87], a[92:95], a[60:63], v[84:87]
    s_add_u32 s17, s13, 12288
    buffer_load_dwordx4 a[52:55], v1, s[40:43], s17 offen sc1
    v_rcp_f32 v9, v9
    v_rcp_f32 v10, v10
    v_mfma_f32_16x16x32_bf16 v[40:43], a[96:99], a[56:59], v[40:43]
    ds_read_b128 a[92:95], v12 offset:5120
    v_mfma_f32_16x16x32_bf16 v[88:91], a[96:99], a[60:63], v[88:91]
    v_rcp_f32 v11, v11
    v_mul_f32 v8, v60, v8
    v_mfma_f32_16x16x32_bf16 v[44:47], a[100:103], a[56:59], v[44:47]
    ds_read_b128 a[96:99], v12 offset:6144
    v_mfma_f32_16x16x32_bf16 v[92:95], a[100:103], a[60:63], v[92:95]
    v_mul_f32 v9, v61, v9
    v_mul_f32 v10, v62, v10
    v_mul_f32 v11, v63, v11
    v_cvt_pk_bf16_f32 v58, v8, v9
    s_waitcnt vmcnt(17) lgkmcnt(4)
    v_mfma_f32_16x16x32_bf16 v[16:19], a[72:75], a[64:67], v[16:19]
    ds_read_b128 a[100:103], v12 offset:7168
    v_mfma_f32_16x16x32_bf16 v[64:67], a[72:75], a[68:71], v[64:67]
    v_cvt_pk_bf16_f32 v59, v10, v11
    buffer_store_dwordx4 v[56:59], v2, s[40:43], s52 offen offset:512 sc1
    s_add_u32 s52, s52, 4096
    v_mfma_f32_16x16x32_bf16 v[20:23], a[76:79], a[64:67], v[20:23]
    ds_read_b128 a[72:75], v12 offset:8192
    v_mfma_f32_16x16x32_bf16 v[68:71], a[76:79], a[68:71], v[68:71]
    v_mfma_f32_16x16x32_bf16 v[24:27], a[80:83], a[64:67], v[24:27]
    ds_read_b128 a[76:79], v12 offset:9216
    v_mfma_f32_16x16x32_bf16 v[72:75], a[80:83], a[68:71], v[72:75]
    s_waitcnt lgkmcnt(4)
    v_mfma_f32_16x16x32_bf16 v[28:31], a[84:87], a[64:67], v[28:31]
    ds_read_b128 a[80:83], v12 offset:10240
    v_mfma_f32_16x16x32_bf16 v[76:79], a[84:87], a[68:71], v[76:79]
    s_add_u32 s17, s10, 12288
    buffer_load_dwordx4 a[56:59], v1, s[40:43], s17 offen sc1
    v_mfma_f32_16x16x32_bf16 a[104:107], a[88:91], a[64:67], a[104:107]
    ds_read_b128 a[84:87], v12 offset:11264
    v_mfma_f32_16x16x32_bf16 a[108:111], a[88:91], a[68:71], a[108:111]
    v_mfma_f32_16x16x32_bf16 v[32:35], a[92:95], a[64:67], v[32:35]
    ds_read_b128 a[88:91], v12 offset:12288
    v_mfma_f32_16x16x32_bf16 v[80:83], a[92:95], a[68:71], v[80:83]
    s_waitcnt lgkmcnt(4)
    v_mfma_f32_16x16x32_bf16 v[36:39], a[96:99], a[64:67], v[36:39]
    ds_read_b128 a[92:95], v12 offset:13312
    v_mfma_f32_16x16x32_bf16 v[84:87], a[96:99], a[68:71], v[84:87]
    s_add_u32 s17, s14, 12288
    buffer_load_dwordx4 a[60:63], v1, s[40:43], s17 offen sc1
    v_mfma_f32_16x16x32_bf16 v[40:43], a[100:103], a[64:67], v[40:43]
    ds_read_b128 a[96:99], v12 offset:14336
    v_mfma_f32_16x16x32_bf16 v[88:91], a[100:103], a[68:71], v[88:91]
    v_mfma_f32_16x16x32_bf16 v[44:47], a[72:75], a[64:67], v[44:47]
    ds_read_b128 a[100:103], v12 offset:15360
    v_mfma_f32_16x16x32_bf16 v[92:95], a[72:75], a[68:71], v[92:95]
    s_waitcnt vmcnt(18) lgkmcnt(4)
    v_mfma_f32_16x16x32_bf16 v[16:19], a[76:79], a[0:3], v[16:19]
    ds_read_b128 a[72:75], v12 offset:16384
    v_mfma_f32_16x16x32_bf16 v[64:67], a[76:79], a[4:7], v[64:67]
    v_mfma_f32_16x16x32_bf16 v[20:23], a[80:83], a[0:3], v[20:23]
    ds_read_b128 a[76:79], v12 offset:17408
    v_mfma_f32_16x16x32_bf16 v[68:71], a[80:83], a[4:7], v[68:71]
    v_mfma_f32_16x16x32_bf16 v[24:27], a[84:87], a[0:3], v[24:27]
    ds_read_b128 a[80:83], v12 offset:18432
    v_mfma_f32_16x16x32_bf16 v[72:75], a[84:87], a[4:7], v[72:75]
    s_waitcnt lgkmcnt(4)
    v_mfma_f32_16x16x32_bf16 v[28:31], a[88:91], a[0:3], v[28:31]
    ds_read_b128 a[84:87], v12 offset:19456
    v_mfma_f32_16x16x32_bf16 v[76:79], a[88:91], a[4:7], v[76:79]
    s_add_u32 s17, s11, 12288
    buffer_load_dwordx4 a[64:67], v1, s[40:43], s17 offen sc1
    v_mfma_f32_16x16x32_bf16 a[104:107], a[92:95], a[0:3], a[104:107]
    ds_read_b128 a[88:91], v12 offset:20480
    v_mfma_f32_16x16x32_bf16 a[108:111], a[92:95], a[4:7], a[108:111]
    v_mfma_f32_16x16x32_bf16 v[32:35], a[96:99], a[0:3], v[32:35]
    ds_read_b128 a[92:95], v12 offset:21504
    v_mfma_f32_16x16x32_bf16 v[80:83], a[96:99], a[4:7], v[80:83]
    s_waitcnt lgkmcnt(4)
    v_mfma_f32_16x16x32_bf16 v[36:39], a[100:103], a[0:3], v[36:39]
    ds_read_b128 a[96:99], v12 offset:22528
    v_mfma_f32_16x16x32_bf16 v[84:87], a[100:103], a[4:7], v[84:87]
    s_add_u32 s17, s15, 12288
    buffer_load_dwordx4 a[68:71], v1, s[40:43], s17 offen sc1
    v_mfma_f32_16x16x32_bf16 v[40:43], a[72:75], a[0:3], v[40:43]
    ds_read_b128 a[100:103], v12 offset:23552
    v_mfma_f32_16x16x32_bf16 v[88:91], a[72:75], a[4:7], v[88:91]
    v_mfma_f32_16x16x32_bf16 v[44:47], a[76:79], a[0:3], v[44:47]
    ds_read_b128 a[72:75], v12 offset:24576
    v_mfma_f32_16x16x32_bf16 v[92:95], a[76:79], a[4:7], v[92:95]
    s_waitcnt vmcnt(17) lgkmcnt(4)
    v_mfma_f32_16x16x32_bf16 v[16:19], a[80:83], a[8:11], v[16:19]
    ds_read_b128 a[76:79], v12 offset:25600
    v_mfma_f32_16x16x32_bf16 v[64:67], a[80:83], a[12:15], v[64:67]
    v_mfma_f32_16x16x32_bf16 v[20:23], a[84:87], a[8:11], v[20:23]
    ds_read_b128 a[80:83], v12 offset:26624
    v_mfma_f32_16x16x32_bf16 v[68:71], a[84:87], a[12:15], v[68:71]
    v_mfma_f32_16x16x32_bf16 v[24:27], a[88:91], a[8:11], v[24:27]
    ds_read_b128 a[84:87], v12 offset:27648
    v_mfma_f32_16x16x32_bf16 v[72:75], a[88:91], a[12:15], v[72:75]
    s_waitcnt lgkmcnt(4)
    v_mfma_f32_16x16x32_bf16 v[28:31], a[92:95], a[8:11], v[28:31]
    ds_read_b128 a[88:91], v12 offset:28672
    v_mfma_f32_16x16x32_bf16 v[76:79], a[92:95], a[12:15], v[76:79]
    s_waitcnt vmcnt(24)
    s_add_u32 s17, s8, 24576
    buffer_load_dwordx4 a[0:3], v1, s[40:43], s17 offen sc1
    v_mfma_f32_16x16x32_bf16 a[104:107], a[96:99], a[8:11], a[104:107]
    ds_read_b128 a[92:95], v12 offset:29696
    v_mfma_f32_16x16x32_bf16 a[108:111], a[96:99], a[12:15], a[108:111]
    v_mfma_f32_16x16x32_bf16 v[32:35], a[100:103], a[8:11], v[32:35]
    ds_read_b128 a[96:99], v12 offset:30720
    v_mfma_f32_16x16x32_bf16 v[80:83], a[100:103], a[12:15], v[80:83]
    s_waitcnt lgkmcnt(4)
    v_mfma_f32_16x16x32_bf16 v[36:39], a[72:75], a[8:11], v[36:39]
    ds_read_b128 a[100:103], v12 offset:31744
    v_mfma_f32_16x16x32_bf16 v[84:87], a[72:75], a[12:15], v[84:87]
    s_add_u32 s17, s12, 24576
    buffer_load_dwordx4 a[4:7], v1, s[40:43], s17 offen sc1
    v_mfma_f32_16x16x32_bf16 v[40:43], a[76:79], a[8:11], v[40:43]
    ds_read_b128 a[72:75], v12 offset:32768
    v_mfma_f32_16x16x32_bf16 v[88:91], a[76:79], a[12:15], v[88:91]
    v_mfma_f32_16x16x32_bf16 v[44:47], a[80:83], a[8:11], v[44:47]
    ds_read_b128 a[76:79], v12 offset:33792
    v_mfma_f32_16x16x32_bf16 v[92:95], a[80:83], a[12:15], v[92:95]
    s_waitcnt vmcnt(17) lgkmcnt(4)
    v_mfma_f32_16x16x32_bf16 v[16:19], a[84:87], a[16:19], v[16:19]
    ds_read_b128 a[80:83], v12 offset:34816
    v_mfma_f32_16x16x32_bf16 v[64:67], a[84:87], a[20:23], v[64:67]
    v_mfma_f32_16x16x32_bf16 v[20:23], a[88:91], a[16:19], v[20:23]
    ds_read_b128 a[84:87], v12 offset:35840
    v_mfma_f32_16x16x32_bf16 v[68:71], a[88:91], a[20:23], v[68:71]
    v_mfma_f32_16x16x32_bf16 v[24:27], a[92:95], a[16:19], v[24:27]
    s_waitcnt vmcnt(6)
    s_barrier
    ds_read_b128 a[88:91], v13 offset:0
    v_mfma_f32_16x16x32_bf16 v[72:75], a[92:95], a[20:23], v[72:75]
    s_waitcnt lgkmcnt(4)
    v_mfma_f32_16x16x32_bf16 v[28:31], a[96:99], a[16:19], v[28:31]
    ds_read_b128 a[92:95], v13 offset:1024
    v_mfma_f32_16x16x32_bf16 v[76:79], a[96:99], a[20:23], v[76:79]
    s_add_u32 s17, s9, 16384
    buffer_load_dwordx4 a[8:11], v1, s[40:43], s17 offen sc1
    v_mfma_f32_16x16x32_bf16 a[104:107], a[100:103], a[16:19], a[104:107]
    ds_read_b128 a[96:99], v13 offset:2048
    v_mfma_f32_16x16x32_bf16 a[108:111], a[100:103], a[20:23], a[108:111]
    v_mfma_f32_16x16x32_bf16 v[32:35], a[72:75], a[16:19], v[32:35]
    ds_read_b128 a[100:103], v13 offset:3072
    v_mfma_f32_16x16x32_bf16 v[80:83], a[72:75], a[20:23], v[80:83]
    s_waitcnt lgkmcnt(4)
    v_mfma_f32_16x16x32_bf16 v[36:39], a[76:79], a[16:19], v[36:39]
    ds_read_b128 a[72:75], v13 offset:4096
    v_mfma_f32_16x16x32_bf16 v[84:87], a[76:79], a[20:23], v[84:87]
    s_add_u32 s17, s13, 16384
    buffer_load_dwordx4 a[12:15], v1, s[40:43], s17 offen sc1
    v_mfma_f32_16x16x32_bf16 v[40:43], a[80:83], a[16:19], v[40:43]
    ds_read_b128 a[76:79], v13 offset:5120
    v_mfma_f32_16x16x32_bf16 v[88:91], a[80:83], a[20:23], v[88:91]
    v_mfma_f32_16x16x32_bf16 v[44:47], a[84:87], a[16:19], v[44:47]
    ds_read_b128 a[80:83], v13 offset:6144
    v_mfma_f32_16x16x32_bf16 v[92:95], a[84:87], a[20:23], v[92:95]
    s_waitcnt vmcnt(16) lgkmcnt(4)
    v_mfma_f32_16x16x32_bf16 v[16:19], a[88:91], a[24:27], v[16:19]
    ds_read_b128 a[84:87], v13 offset:7168
    v_mfma_f32_16x16x32_bf16 v[64:67], a[88:91], a[28:31], v[64:67]
    v_mfma_f32_16x16x32_bf16 v[20:23], a[92:95], a[24:27], v[20:23]
    ds_read_b128 a[88:91], v13 offset:8192
    v_mfma_f32_16x16x32_bf16 v[68:71], a[92:95], a[28:31], v[68:71]
    v_mfma_f32_16x16x32_bf16 v[24:27], a[96:99], a[24:27], v[24:27]
    ds_read_b128 a[92:95], v13 offset:9216
    v_mfma_f32_16x16x32_bf16 v[72:75], a[96:99], a[28:31], v[72:75]
    s_waitcnt lgkmcnt(4)
    v_mfma_f32_16x16x32_bf16 v[28:31], a[100:103], a[24:27], v[28:31]
    ds_read_b128 a[96:99], v13 offset:10240
    v_mfma_f32_16x16x32_bf16 v[76:79], a[100:103], a[28:31], v[76:79]
    s_add_u32 s17, s10, 16384
    buffer_load_dwordx4 a[16:19], v1, s[40:43], s17 offen sc1
    v_mfma_f32_16x16x32_bf16 a[104:107], a[72:75], a[24:27], a[104:107]
    ds_read_b128 a[100:103], v13 offset:11264
    v_mfma_f32_16x16x32_bf16 a[108:111], a[72:75], a[28:31], a[108:111]
    v_mfma_f32_16x16x32_bf16 v[32:35], a[76:79], a[24:27], v[32:35]
    ds_read_b128 a[72:75], v13 offset:12288
    v_mfma_f32_16x16x32_bf16 v[80:83], a[76:79], a[28:31], v[80:83]
    s_waitcnt lgkmcnt(4)
    v_mfma_f32_16x16x32_bf16 v[36:39], a[80:83], a[24:27], v[36:39]
    ds_read_b128 a[76:79], v13 offset:13312
    v_mfma_f32_16x16x32_bf16 v[84:87], a[80:83], a[28:31], v[84:87]
    s_add_u32 s17, s14, 16384
    buffer_load_dwordx4 a[20:23], v1, s[40:43], s17 offen sc1
    v_mfma_f32_16x16x32_bf16 v[40:43], a[84:87], a[24:27], v[40:43]
    ds_read_b128 a[80:83], v13 offset:14336
    v_mfma_f32_16x16x32_bf16 v[88:91], a[84:87], a[28:31], v[88:91]
    v_mfma_f32_16x16x32_bf16 v[44:47], a[88:91], a[24:27], v[44:47]
    ds_read_b128 a[84:87], v13 offset:15360
    v_mfma_f32_16x16x32_bf16 v[92:95], a[88:91], a[28:31], v[92:95]
    s_waitcnt vmcnt(16) lgkmcnt(4)
    v_mfma_f32_16x16x32_bf16 v[16:19], a[92:95], a[32:35], v[16:19]
    ds_read_b128 a[88:91], v13 offset:16384
    v_mfma_f32_16x16x32_bf16 v[64:67], a[92:95], a[36:39], v[64:67]
    v_mfma_f32_16x16x32_bf16 v[20:23], a[96:99], a[32:35], v[20:23]
    ds_read_b128 a[92:95], v13 offset:17408
    v_mfma_f32_16x16x32_bf16 v[68:71], a[96:99], a[36:39], v[68:71]
    v_mfma_f32_16x16x32_bf16 v[24:27], a[100:103], a[32:35], v[24:27]
    ds_read_b128 a[96:99], v13 offset:18432
    v_mfma_f32_16x16x32_bf16 v[72:75], a[100:103], a[36:39], v[72:75]
    s_waitcnt lgkmcnt(4)
    v_mfma_f32_16x16x32_bf16 v[28:31], a[72:75], a[32:35], v[28:31]
    ds_read_b128 a[100:103], v13 offset:19456
    v_mfma_f32_16x16x32_bf16 v[76:79], a[72:75], a[36:39], v[76:79]
    s_add_u32 s17, s11, 16384
    buffer_load_dwordx4 a[24:27], v1, s[40:43], s17 offen sc1
    v_mfma_f32_16x16x32_bf16 a[104:107], a[76:79], a[32:35], a[104:107]
    ds_read_b128 a[72:75], v13 offset:20480
    v_mfma_f32_16x16x32_bf16 a[108:111], a[76:79], a[36:39], a[108:111]
    v_mfma_f32_16x16x32_bf16 v[32:35], a[80:83], a[32:35], v[32:35]
    ds_read_b128 a[76:79], v13 offset:21504
    v_mfma_f32_16x16x32_bf16 v[80:83], a[80:83], a[36:39], v[80:83]
    s_waitcnt lgkmcnt(4)
    v_mfma_f32_16x16x32_bf16 v[36:39], a[84:87], a[32:35], v[36:39]
    ds_read_b128 a[80:83], v13 offset:22528
    v_mfma_f32_16x16x32_bf16 v[84:87], a[84:87], a[36:39], v[84:87]
    s_add_u32 s17, s15, 16384
    buffer_load_dwordx4 a[28:31], v1, s[40:43], s17 offen sc1
    v_mfma_f32_16x16x32_bf16 v[40:43], a[88:91], a[32:35], v[40:43]
    ds_read_b128 a[84:87], v13 offset:23552
    v_mfma_f32_16x16x32_bf16 v[88:91], a[88:91], a[36:39], v[88:91]
    v_mfma_f32_16x16x32_bf16 v[44:47], a[92:95], a[32:35], v[44:47]
    ds_read_b128 a[88:91], v13 offset:24576
    v_mfma_f32_16x16x32_bf16 v[92:95], a[92:95], a[36:39], v[92:95]
    s_waitcnt vmcnt(15) lgkmcnt(4)
    v_mfma_f32_16x16x32_bf16 v[16:19], a[96:99], a[40:43], v[16:19]
    ds_read_b128 a[92:95], v13 offset:25600
    v_mfma_f32_16x16x32_bf16 v[64:67], a[96:99], a[44:47], v[64:67]
    v_mfma_f32_16x16x32_bf16 v[20:23], a[100:103], a[40:43], v[20:23]
    ds_read_b128 a[96:99], v13 offset:26624
    v_mfma_f32_16x16x32_bf16 v[68:71], a[100:103], a[44:47], v[68:71]
    v_mfma_f32_16x16x32_bf16 v[24:27], a[72:75], a[40:43], v[24:27]
    ds_read_b128 a[100:103], v13 offset:27648
    v_mfma_f32_16x16x32_bf16 v[72:75], a[72:75], a[44:47], v[72:75]
    s_waitcnt lgkmcnt(4)
    v_mfma_f32_16x16x32_bf16 v[28:31], a[76:79], a[40:43], v[28:31]
    ds_read_b128 a[72:75], v13 offset:28672
    v_mfma_f32_16x16x32_bf16 v[76:79], a[76:79], a[44:47], v[76:79]
    s_waitcnt vmcnt(22)
    s_add_u32 s17, s8, 28672
    buffer_load_dwordx4 a[32:35], v1, s[40:43], s17 offen sc1
    v_mfma_f32_16x16x32_bf16 a[104:107], a[80:83], a[40:43], a[104:107]
    ds_read_b128 a[76:79], v13 offset:29696
    v_mfma_f32_16x16x32_bf16 a[108:111], a[80:83], a[44:47], a[108:111]
    v_mfma_f32_16x16x32_bf16 v[32:35], a[84:87], a[40:43], v[32:35]
    ds_read_b128 a[80:83], v13 offset:30720
    v_mfma_f32_16x16x32_bf16 v[80:83], a[84:87], a[44:47], v[80:83]
    s_waitcnt lgkmcnt(4)
    v_mfma_f32_16x16x32_bf16 v[36:39], a[88:91], a[40:43], v[36:39]
    ds_read_b128 a[84:87], v13 offset:31744
    v_mfma_f32_16x16x32_bf16 v[84:87], a[88:91], a[44:47], v[84:87]
    s_add_u32 s17, s12, 28672
    buffer_load_dwordx4 a[36:39], v1, s[40:43], s17 offen sc1
    v_mfma_f32_16x16x32_bf16 v[40:43], a[92:95], a[40:43], v[40:43]
    ds_read_b128 a[88:91], v13 offset:32768
    v_mfma_f32_16x16x32_bf16 v[88:91], a[92:95], a[44:47], v[88:91]
    v_mfma_f32_16x16x32_bf16 v[44:47], a[96:99], a[40:43], v[44:47]
    ds_read_b128 a[92:95], v13 offset:33792
    v_mfma_f32_16x16x32_bf16 v[92:95], a[96:99], a[44:47], v[92:95]
    s_waitcnt vmcnt(15) lgkmcnt(4)
    v_mfma_f32_16x16x32_bf16 v[16:19], a[100:103], a[48:51], v[16:19]
    ds_read_b128 a[96:99], v13 offset:34816
    v_mfma_f32_16x16x32_bf16 v[64:67], a[100:103], a[52:55], v[64:67]
    v_mfma_f32_16x16x32_bf16 v[20:23], a[72:75], a[48:51], v[20:23]
    ds_read_b128 a[100:103], v13 offset:35840
    v_mfma_f32_16x16x32_bf16 v[68:71], a[72:75], a[52:55], v[68:71]
    v_mfma_f32_16x16x32_bf16 v[24:27], a[76:79], a[48:51], v[24:27]
    s_barrier
    ds_read_b128 a[72:75], v14 offset:0
    v_mfma_f32_16x16x32_bf16 v[72:75], a[76:79], a[52:55], v[72:75]
    s_waitcnt lgkmcnt(4)
    v_mfma_f32_16x16x32_bf16 v[28:31], a[80:83], a[48:51], v[28:31]
    ds_read_b128 a[76:79], v14 offset:1024
    v_mfma_f32_16x16x32_bf16 v[76:79], a[80:83], a[52:55], v[76:79]
    s_add_u32 s17, s9, 20480
    buffer_load_dwordx4 a[40:43], v1, s[40:43], s17 offen sc1
    v_mfma_f32_16x16x32_bf16 a[104:107], a[84:87], a[48:51], a[104:107]
    ds_read_b128 a[80:83], v14 offset:2048
    v_mfma_f32_16x16x32_bf16 a[108:111], a[84:87], a[52:55], a[108:111]
    v_mfma_f32_16x16x32_bf16 v[32:35], a[88:91], a[48:51], v[32:35]
    ds_read_b128 a[84:87], v14 offset:3072
    v_mfma_f32_16x16x32_bf16 v[80:83], a[88:91], a[52:55], v[80:83]
    s_waitcnt lgkmcnt(4)
    v_mfma_f32_16x16x32_bf16 v[36:39], a[92:95], a[48:51], v[36:39]
    ds_read_b128 a[88:91], v14 offset:4096
    v_mfma_f32_16x16x32_bf16 v[84:87], a[92:95], a[52:55], v[84:87]
    s_add_u32 s17, s13, 20480
    buffer_load_dwordx4 a[44:47], v1, s[40:43], s17 offen sc1
    v_mfma_f32_16x16x32_bf16 v[40:43], a[96:99], a[48:51], v[40:43]
    ds_read_b128 a[92:95], v14 offset:5120
    v_mfma_f32_16x16x32_bf16 v[88:91], a[96:99], a[52:55], v[88:91]
    v_mfma_f32_16x16x32_bf16 v[44:47], a[100:103], a[48:51], v[44:47]
    ds_read_b128 a[96:99], v14 offset:6144
    v_mfma_f32_16x16x32_bf16 v[92:95], a[100:103], a[52:55], v[92:95]
    s_waitcnt vmcnt(14) lgkmcnt(4)
    v_mfma_f32_16x16x32_bf16 v[16:19], a[72:75], a[56:59], v[16:19]
    ds_read_b128 a[100:103], v14 offset:7168
    v_mfma_f32_16x16x32_bf16 v[64:67], a[72:75], a[60:63], v[64:67]
    v_mfma_f32_16x16x32_bf16 v[20:23], a[76:79], a[56:59], v[20:23]
    ds_read_b128 a[72:75], v14 offset:8192
    v_mfma_f32_16x16x32_bf16 v[68:71], a[76:79], a[60:63], v[68:71]
    v_mfma_f32_16x16x32_bf16 v[24:27], a[80:83], a[56:59], v[24:27]
    ds_read_b128 a[76:79], v14 offset:9216
    v_mfma_f32_16x16x32_bf16 v[72:75], a[80:83], a[60:63], v[72:75]
    s_waitcnt lgkmcnt(4)
    v_mfma_f32_16x16x32_bf16 v[28:31], a[84:87], a[56:59], v[28:31]
    ds_read_b128 a[80:83], v14 offset:10240
    v_mfma_f32_16x16x32_bf16 v[76:79], a[84:87], a[60:63], v[76:79]
    s_add_u32 s17, s10, 20480
    buffer_load_dwordx4 a[48:51], v1, s[40:43], s17 offen sc1
    v_mfma_f32_16x16x32_bf16 a[104:107], a[88:91], a[56:59], a[104:107]
    ds_read_b128 a[84:87], v14 offset:11264
    v_mfma_f32_16x16x32_bf16 a[108:111], a[88:91], a[60:63], a[108:111]
    v_mfma_f32_16x16x32_bf16 v[32:35], a[92:95], a[56:59], v[32:35]
    ds_read_b128 a[88:91], v14 offset:12288
    v_mfma_f32_16x16x32_bf16 v[80:83], a[92:95], a[60:63], v[80:83]
    s_waitcnt lgkmcnt(4)
    v_mfma_f32_16x16x32_bf16 v[36:39], a[96:99], a[56:59], v[36:39]
    ds_read_b128 a[92:95], v14 offset:13312
    v_mfma_f32_16x16x32_bf16 v[84:87], a[96:99], a[60:63], v[84:87]
    s_add_u32 s17, s14, 20480
    buffer_load_dwordx4 a[52:55], v1, s[40:43], s17 offen sc1
    v_mfma_f32_16x16x32_bf16 v[40:43], a[100:103], a[56:59], v[40:43]
    ds_read_b128 a[96:99], v14 offset:14336
    v_mfma_f32_16x16x32_bf16 v[88:91], a[100:103], a[60:63], v[88:91]
    v_mfma_f32_16x16x32_bf16 v[44:47], a[72:75], a[56:59], v[44:47]
    ds_read_b128 a[100:103], v14 offset:15360
    v_mfma_f32_16x16x32_bf16 v[92:95], a[72:75], a[60:63], v[92:95]
    s_waitcnt vmcnt(14) lgkmcnt(4)
    v_mfma_f32_16x16x32_bf16 v[16:19], a[76:79], a[64:67], v[16:19]
    ds_read_b128 a[72:75], v14 offset:16384
    v_mfma_f32_16x16x32_bf16 v[64:67], a[76:79], a[68:71], v[64:67]
    v_mfma_f32_16x16x32_bf16 v[20:23], a[80:83], a[64:67], v[20:23]
    ds_read_b128 a[76:79], v14 offset:17408
    v_mfma_f32_16x16x32_bf16 v[68:71], a[80:83], a[68:71], v[68:71]
    v_mfma_f32_16x16x32_bf16 v[24:27], a[84:87], a[64:67], v[24:27]
    ds_read_b128 a[80:83], v14 offset:18432
    v_mfma_f32_16x16x32_bf16 v[72:75], a[84:87], a[68:71], v[72:75]
    s_waitcnt lgkmcnt(4)
    v_mfma_f32_16x16x32_bf16 v[28:31], a[88:91], a[64:67], v[28:31]
    ds_read_b128 a[84:87], v14 offset:19456
    v_mfma_f32_16x16x32_bf16 v[76:79], a[88:91], a[68:71], v[76:79]
    s_add_u32 s17, s11, 20480
    buffer_load_dwordx4 a[56:59], v1, s[40:43], s17 offen sc1
    v_mfma_f32_16x16x32_bf16 a[104:107], a[92:95], a[64:67], a[104:107]
    ds_read_b128 a[88:91], v14 offset:20480
    v_mfma_f32_16x16x32_bf16 a[108:111], a[92:95], a[68:71], a[108:111]
    v_mfma_f32_16x16x32_bf16 v[32:35], a[96:99], a[64:67], v[32:35]
    ds_read_b128 a[92:95], v14 offset:21504
    v_mfma_f32_16x16x32_bf16 v[80:83], a[96:99], a[68:71], v[80:83]
    s_waitcnt lgkmcnt(4)
    v_mfma_f32_16x16x32_bf16 v[36:39], a[100:103], a[64:67], v[36:39]
    ds_read_b128 a[96:99], v14 offset:22528
    v_mfma_f32_16x16x32_bf16 v[84:87], a[100:103], a[68:71], v[84:87]
    s_add_u32 s17, s15, 20480
    buffer_load_dwordx4 a[60:63], v1, s[40:43], s17 offen sc1
    v_mfma_f32_16x16x32_bf16 v[40:43], a[72:75], a[64:67], v[40:43]
    ds_read_b128 a[100:103], v14 offset:23552
    v_mfma_f32_16x16x32_bf16 v[88:91], a[72:75], a[68:71], v[88:91]
    v_mfma_f32_16x16x32_bf16 v[44:47], a[76:79], a[64:67], v[44:47]
    ds_read_b128 a[72:75], v14 offset:24576
    v_mfma_f32_16x16x32_bf16 v[92:95], a[76:79], a[68:71], v[92:95]
    s_waitcnt vmcnt(14) lgkmcnt(4)
    v_mfma_f32_16x16x32_bf16 v[16:19], a[80:83], a[0:3], v[16:19]
    ds_read_b128 a[76:79], v14 offset:25600
    v_mfma_f32_16x16x32_bf16 v[64:67], a[80:83], a[4:7], v[64:67]
    v_mfma_f32_16x16x32_bf16 v[20:23], a[84:87], a[0:3], v[20:23]
    ds_read_b128 a[80:83], v14 offset:26624
    v_mfma_f32_16x16x32_bf16 v[68:71], a[84:87], a[4:7], v[68:71]
    v_mfma_f32_16x16x32_bf16 v[24:27], a[88:91], a[0:3], v[24:27]
    ds_read_b128 a[84:87], v14 offset:27648
    v_mfma_f32_16x16x32_bf16 v[72:75], a[88:91], a[4:7], v[72:75]
    s_waitcnt lgkmcnt(4)
    v_mfma_f32_16x16x32_bf16 v[28:31], a[92:95], a[0:3], v[28:31]
    ds_read_b128 a[88:91], v14 offset:28672
    v_mfma_f32_16x16x32_bf16 v[76:79], a[92:95], a[4:7], v[76:79]
    s_waitcnt vmcnt(20)
    s_add_u32 s17, s8, 32768
    buffer_load_dwordx4 a[64:67], v1, s[40:43], s17 offen sc1
    v_mfma_f32_16x16x32_bf16 a[104:107], a[96:99], a[0:3], a[104:107]
    ds_read_b128 a[92:95], v14 offset:29696
    v_mfma_f32_16x16x32_bf16 a[108:111], a[96:99], a[4:7], a[108:111]
    v_mfma_f32_16x16x32_bf16 v[32:35], a[100:103], a[0:3], v[32:35]
    ds_read_b128 a[96:99], v14 offset:30720
    v_mfma_f32_16x16x32_bf16 v[80:83], a[100:103], a[4:7], v[80:83]
    s_waitcnt lgkmcnt(4)
    v_mfma_f32_16x16x32_bf16 v[36:39], a[72:75], a[0:3], v[36:39]
    ds_read_b128 a[100:103], v14 offset:31744
    v_mfma_f32_16x16x32_bf16 v[84:87], a[72:75], a[4:7], v[84:87]
    s_add_u32 s17, s12, 32768
    buffer_load_dwordx4 a[68:71], v1, s[40:43], s17 offen sc1
    v_mfma_f32_16x16x32_bf16 v[40:43], a[76:79], a[0:3], v[40:43]
    ds_read_b128 a[72:75], v14 offset:32768
    v_mfma_f32_16x16x32_bf16 v[88:91], a[76:79], a[4:7], v[88:91]
    v_mfma_f32_16x16x32_bf16 v[44:47], a[80:83], a[0:3], v[44:47]
    ds_read_b128 a[76:79], v14 offset:33792
    v_mfma_f32_16x16x32_bf16 v[92:95], a[80:83], a[4:7], v[92:95]
    s_waitcnt vmcnt(14) lgkmcnt(4)
    v_mfma_f32_16x16x32_bf16 v[16:19], a[84:87], a[8:11], v[16:19]
    ds_read_b128 a[80:83], v14 offset:34816
    v_mfma_f32_16x16x32_bf16 v[64:67], a[84:87], a[12:15], v[64:67]
    v_mfma_f32_16x16x32_bf16 v[20:23], a[88:91], a[8:11], v[20:23]
    ds_read_b128 a[84:87], v14 offset:35840
    v_mfma_f32_16x16x32_bf16 v[68:71], a[88:91], a[12:15], v[68:71]
    v_mfma_f32_16x16x32_bf16 v[24:27], a[92:95], a[8:11], v[24:27]
    s_barrier
    ds_read_b128 a[88:91], v15 offset:0
    v_mfma_f32_16x16x32_bf16 v[72:75], a[92:95], a[12:15], v[72:75]
    s_waitcnt lgkmcnt(4)
    v_mfma_f32_16x16x32_bf16 v[28:31], a[96:99], a[8:11], v[28:31]
    ds_read_b128 a[92:95], v15 offset:1024
    v_mfma_f32_16x16x32_bf16 v[76:79], a[96:99], a[12:15], v[76:79]
    s_add_u32 s17, s9, 24576
    buffer_load_dwordx4 a[0:3], v1, s[40:43], s17 offen sc1
    v_mfma_f32_16x16x32_bf16 a[104:107], a[100:103], a[8:11], a[104:107]
    ds_read_b128 a[96:99], v15 offset:2048
    v_mfma_f32_16x16x32_bf16 a[108:111], a[100:103], a[12:15], a[108:111]
    v_mfma_f32_16x16x32_bf16 v[32:35], a[72:75], a[8:11], v[32:35]
    ds_read_b128 a[100:103], v15 offset:3072
    v_mfma_f32_16x16x32_bf16 v[80:83], a[72:75], a[12:15], v[80:83]
    s_waitcnt lgkmcnt(4)
    v_mfma_f32_16x16x32_bf16 v[36:39], a[76:79], a[8:11], v[36:39]
    ds_read_b128 a[72:75], v15 offset:4096
    v_mfma_f32_16x16x32_bf16 v[84:87], a[76:79], a[12:15], v[84:87]
    s_add_u32 s17, s13, 24576
    buffer_load_dwordx4 a[4:7], v1, s[40:43], s17 offen sc1
    v_mfma_f32_16x16x32_bf16 v[40:43], a[80:83], a[8:11], v[40:43]
    ds_read_b128 a[76:79], v15 offset:5120
    v_mfma_f32_16x16x32_bf16 v[88:91], a[80:83], a[12:15], v[88:91]
    v_mfma_f32_16x16x32_bf16 v[44:47], a[84:87], a[8:11], v[44:47]
    ds_read_b128 a[80:83], v15 offset:6144
    v_mfma_f32_16x16x32_bf16 v[92:95], a[84:87], a[12:15], v[92:95]
    s_waitcnt vmcnt(14) lgkmcnt(4)
    v_mfma_f32_16x16x32_bf16 v[16:19], a[88:91], a[16:19], v[16:19]
    ds_read_b128 a[84:87], v15 offset:7168
    v_mfma_f32_16x16x32_bf16 v[64:67], a[88:91], a[20:23], v[64:67]
    v_bfe_u32 v8, v1, 8, 2
    v_mfma_f32_16x16x32_bf16 v[20:23], a[92:95], a[16:19], v[20:23]
    ds_read_b128 a[88:91], v15 offset:8192
    v_mfma_f32_16x16x32_bf16 v[68:71], a[92:95], a[20:23], v[68:71]
    v_and_b32 v9, 0xf0, v1
    v_mfma_f32_16x16x32_bf16 v[24:27], a[96:99], a[16:19], v[24:27]
    ds_read_b128 a[92:95], v15 offset:9216
    v_mfma_f32_16x16x32_bf16 v[72:75], a[96:99], a[20:23], v[72:75]
    v_lshl_add_u32 v108, v8, 9, v9
    s_waitcnt lgkmcnt(4)
    v_mfma_f32_16x16x32_bf16 v[28:31], a[100:103], a[16:19], v[28:31]
    ds_read_b128 a[96:99], v15 offset:10240
    v_mfma_f32_16x16x32_bf16 v[76:79], a[100:103], a[20:23], v[76:79]
    s_add_u32 s17, s10, 24576
    buffer_load_dwordx4 a[8:11], v1, s[40:43], s17 offen sc1
    v_mfma_f32_16x16x32_bf16 a[104:107], a[72:75], a[16:19], a[104:107]
    ds_read_b128 a[100:103], v15 offset:11264
    v_mfma_f32_16x16x32_bf16 a[108:111], a[72:75], a[20:23], a[108:111]
    v_lshlrev_b32 v109, 4, v8
    v_mfma_f32_16x16x32_bf16 v[32:35], a[76:79], a[16:19], v[32:35]
    ds_read_b128 a[72:75], v15 offset:12288
    v_mfma_f32_16x16x32_bf16 v[80:83], a[76:79], a[20:23], v[80:83]
    v_and_b32 v10, 2, v8
    s_waitcnt lgkmcnt(4)
    v_mfma_f32_16x16x32_bf16 v[36:39], a[80:83], a[16:19], v[36:39]
    ds_read_b128 a[76:79], v15 offset:13312
    v_mfma_f32_16x16x32_bf16 v[84:87], a[80:83], a[20:23], v[84:87]
    s_add_u32 s17, s14, 24576
    buffer_load_dwordx4 a[12:15], v1, s[40:43], s17 offen sc1
    v_mfma_f32_16x16x32_bf16 v[40:43], a[84:87], a[16:19], v[40:43]
    ds_read_b128 a[80:83], v15 offset:14336
    v_mfma_f32_16x16x32_bf16 v[88:91], a[84:87], a[20:23], v[88:91]
    v_lshl_add_u32 v10, v10, 8, v9
    v_mfma_f32_16x16x32_bf16 v[44:47], a[88:91], a[16:19], v[44:47]
    ds_read_b128 a[84:87], v15 offset:15360
    v_mfma_f32_16x16x32_bf16 v[92:95], a[88:91], a[20:23], v[92:95]
    v_and_b32 v11, 1, v8
    s_waitcnt vmcnt(14) lgkmcnt(4)
    v_mfma_f32_16x16x32_bf16 v[16:19], a[92:95], a[24:27], v[16:19]
    ds_read_b128 a[88:91], v15 offset:16384
    v_mfma_f32_16x16x32_bf16 v[64:67], a[92:95], a[28:31], v[64:67]
    v_lshl_add_u32 v10, v11, 3, v10
    v_mfma_f32_16x16x32_bf16 v[20:23], a[96:99], a[24:27], v[20:23]
    ds_read_b128 a[92:95], v15 offset:17408
    v_mfma_f32_16x16x32_bf16 v[68:71], a[96:99], a[28:31], v[68:71]
    v_lshlrev_b32 v11, 3, v8
    v_mfma_f32_16x16x32_bf16 v[24:27], a[100:103], a[24:27], v[24:27]
    ds_read_b128 a[96:99], v15 offset:18432
    v_mfma_f32_16x16x32_bf16 v[72:75], a[100:103], a[28:31], v[72:75]
    v_mul_u32_u24 v9, 72, v9
    s_waitcnt lgkmcnt(4)
    v_mfma_f32_16x16x32_bf16 v[28:31], a[72:75], a[24:27], v[28:31]
    ds_read_b128 a[100:103], v15 offset:19456
    v_mfma_f32_16x16x32_bf16 v[76:79], a[72:75], a[28:31], v[76:79]
    s_add_u32 s17, s11, 24576
    buffer_load_dwordx4 a[16:19], v1, s[40:43], s17 offen sc1
    v_mfma_f32_16x16x32_bf16 a[104:107], a[76:79], a[24:27], a[104:107]
    ds_read_b128 a[72:75], v15 offset:20480
    v_mfma_f32_16x16x32_bf16 a[108:111], a[76:79], a[28:31], a[108:111]
    v_add_u32 v110, v9, v109
    v_mfma_f32_16x16x32_bf16 v[32:35], a[80:83], a[24:27], v[32:35]
    ds_read_b128 a[76:79], v15 offset:21504
    v_mfma_f32_16x16x32_bf16 v[80:83], a[80:83], a[28:31], v[80:83]
    v_add_u32 v111, v9, v11
    s_waitcnt lgkmcnt(4)
    v_mfma_f32_16x16x32_bf16 v[36:39], a[84:87], a[24:27], v[36:39]
    ds_read_b128 a[80:83], v15 offset:22528
    v_mfma_f32_16x16x32_bf16 v[84:87], a[84:87], a[28:31], v[84:87]
    s_add_u32 s17, s15, 24576
    buffer_load_dwordx4 a[20:23], v1, s[40:43], s17 offen sc1
    v_mfma_f32_16x16x32_bf16 v[40:43], a[88:91], a[24:27], v[40:43]
    ds_read_b128 a[84:87], v15 offset:23552
    v_mfma_f32_16x16x32_bf16 v[88:91], a[88:91], a[28:31], v[88:91]
    s_add_u32 s30, s57, 5760
    v_mfma_f32_16x16x32_bf16 v[44:47], a[92:95], a[24:27], v[44:47]
    ds_read_b128 a[88:91], v15 offset:24576
    v_mfma_f32_16x16x32_bf16 v[92:95], a[92:95], a[28:31], v[92:95]
    s_add_u32 s31, s53, 5760
    s_waitcnt vmcnt(14) lgkmcnt(4)
    v_mfma_f32_16x16x32_bf16 v[16:19], a[96:99], a[32:35], v[16:19]
    ds_read_b128 a[92:95], v15 offset:25600
    v_mfma_f32_16x16x32_bf16 v[64:67], a[96:99], a[36:39], v[64:67]
    buffer_load_dwordx4 v[48:51], v108, s[68:71], s58 offen
    v_mfma_f32_16x16x32_bf16 v[20:23], a[100:103], a[32:35], v[20:23]
    ds_read_b128 a[96:99], v15 offset:26624
    v_mfma_f32_16x16x32_bf16 v[68:71], a[100:103], a[36:39], v[68:71]
    buffer_load_dwordx4 v[52:55], v108, s[68:71], s58 offen offset:2048
    v_mfma_f32_16x16x32_bf16 v[24:27], a[72:75], a[32:35], v[24:27]
    ds_read_b128 a[100:103], v15 offset:27648
    v_mfma_f32_16x16x32_bf16 v[72:75], a[72:75], a[36:39], v[72:75]
    buffer_load_dwordx2 v[104:105], v10, s[68:71], s59 offen
    s_waitcnt lgkmcnt(4)
    v_mfma_f32_16x16x32_bf16 v[28:31], a[76:79], a[32:35], v[28:31]
    ds_read_b128 a[72:75], v15 offset:28672
    v_mfma_f32_16x16x32_bf16 v[76:79], a[76:79], a[36:39], v[76:79]
    s_add_u32 s17, s9, 28672
    buffer_load_dwordx4 a[24:27], v1, s[40:43], s17 offen sc1
    v_mfma_f32_16x16x32_bf16 a[104:107], a[80:83], a[32:35], a[104:107]
    ds_read_b128 a[76:79], v15 offset:29696
    v_mfma_f32_16x16x32_bf16 a[108:111], a[80:83], a[36:39], a[108:111]
    buffer_load_dwordx4 v[56:59], v109, s[60:63], s30 offen
    v_mfma_f32_16x16x32_bf16 v[32:35], a[84:87], a[32:35], v[32:35]
    ds_read_b128 a[80:83], v15 offset:30720
    v_mfma_f32_16x16x32_bf16 v[80:83], a[84:87], a[36:39], v[80:83]
    buffer_load_dwordx4 v[60:63], v109, s[60:63], s30 offen offset:64
    s_waitcnt lgkmcnt(4)
    v_mfma_f32_16x16x32_bf16 v[36:39], a[88:91], a[32:35], v[36:39]
    ds_read_b128 a[84:87], v15 offset:31744
    v_mfma_f32_16x16x32_bf16 v[84:87], a[88:91], a[36:39], v[84:87]
    s_add_u32 s17, s13, 28672
    buffer_load_dwordx4 a[28:31], v1, s[40:43], s17 offen sc1
    v_mfma_f32_16x16x32_bf16 v[40:43], a[92:95], a[32:35], v[40:43]
    ds_read_b128 a[88:91], v15 offset:32768
    v_mfma_f32_16x16x32_bf16 v[88:91], a[92:95], a[36:39], v[88:91]
    buffer_load_dwordx2 v[106:107], v11, s[60:63], s31 offen
    v_mfma_f32_16x16x32_bf16 v[44:47], a[96:99], a[32:35], v[44:47]
    ds_read_b128 a[92:95], v15 offset:33792
    v_mfma_f32_16x16x32_bf16 v[92:95], a[96:99], a[36:39], v[92:95]
    s_mul_i32 s30, s4, 9216
    s_waitcnt vmcnt(20) lgkmcnt(4)
    v_mfma_f32_16x16x32_bf16 v[16:19], a[100:103], a[40:43], v[16:19]
    ds_read_b128 a[96:99], v15 offset:34816
    v_mfma_f32_16x16x32_bf16 v[64:67], a[100:103], a[44:47], v[64:67]
    s_add_u32 s30, s30, s56
    v_mfma_f32_16x16x32_bf16 v[20:23], a[72:75], a[40:43], v[20:23]
    ds_read_b128 a[100:103], v15 offset:35840
    v_mfma_f32_16x16x32_bf16 v[68:71], a[72:75], a[44:47], v[68:71]
    s_mul_i32 s31, s26, 4608
    v_mfma_f32_16x16x32_bf16 v[24:27], a[76:79], a[40:43], v[24:27]
    s_barrier
    ds_read_b128 a[72:75], v12 offset:0
    v_mfma_f32_16x16x32_bf16 v[72:75], a[76:79], a[44:47], v[72:75]
    s_add_u32 s56, s56, s31
    s_waitcnt lgkmcnt(4)
    v_mfma_f32_16x16x32_bf16 v[28:31], a[80:83], a[40:43], v[28:31]
    ds_read_b128 a[76:79], v12 offset:1024
    v_mfma_f32_16x16x32_bf16 v[76:79], a[80:83], a[44:47], v[76:79]
    s_add_u32 s17, s10, 28672
    buffer_load_dwordx4 a[32:35], v1, s[40:43], s17 offen sc1
    v_mfma_f32_16x16x32_bf16 a[104:107], a[84:87], a[40:43], a[104:107]
    ds_read_b128 a[80:83], v12 offset:2048
    v_mfma_f32_16x16x32_bf16 a[108:111], a[84:87], a[44:47], a[108:111]
    s_add_u32 s48, s30, s31
    v_mfma_f32_16x16x32_bf16 v[32:35], a[88:91], a[40:43], v[32:35]
    ds_read_b128 a[84:87], v12 offset:3072
    v_mfma_f32_16x16x32_bf16 v[80:83], a[88:91], a[44:47], v[80:83]
    s_sub_u32 s49, s30, s31
    s_waitcnt lgkmcnt(4)
    v_mfma_f32_16x16x32_bf16 v[36:39], a[92:95], a[40:43], v[36:39]
    ds_read_b128 a[88:91], v12 offset:4096
    v_mfma_f32_16x16x32_bf16 v[84:87], a[92:95], a[44:47], v[84:87]
    s_add_u32 s17, s14, 28672
    buffer_load_dwordx4 a[36:39], v1, s[40:43], s17 offen sc1
    v_mfma_f32_16x16x32_bf16 v[40:43], a[96:99], a[40:43], v[40:43]
    ds_read_b128 a[92:95], v12 offset:5120
    v_mfma_f32_16x16x32_bf16 v[88:91], a[96:99], a[44:47], v[88:91]
    s_add_u32 s49, s49, 4608
    v_mfma_f32_16x16x32_bf16 v[44:47], a[100:103], a[40:43], v[44:47]
    ds_read_b128 a[96:99], v12 offset:6144
    v_mfma_f32_16x16x32_bf16 v[92:95], a[100:103], a[44:47], v[92:95]
    s_lshl_b32 s27, s27, 11
    s_waitcnt vmcnt(20) lgkmcnt(4)
    v_mfma_f32_16x16x32_bf16 v[16:19], a[72:75], a[48:51], v[16:19]
    ds_read_b128 a[100:103], v12 offset:7168
    v_mfma_f32_16x16x32_bf16 v[64:67], a[72:75], a[52:55], v[64:67]
    s_add_u32 s50, s49, s27
    v_mfma_f32_16x16x32_bf16 v[20:23], a[76:79], a[48:51], v[20:23]
    ds_read_b128 a[72:75], v12 offset:8192
    v_mfma_f32_16x16x32_bf16 v[68:71], a[76:79], a[52:55], v[68:71]
    s_sub_u32 s51, s49, s27
    v_mfma_f32_16x16x32_bf16 v[24:27], a[80:83], a[48:51], v[24:27]
    ds_read_b128 a[76:79], v12 offset:9216
    v_mfma_f32_16x16x32_bf16 v[72:75], a[80:83], a[52:55], v[72:75]
    s_add_u32 s51, s51, 2048
    s_waitcnt lgkmcnt(4)
    v_mfma_f32_16x16x32_bf16 v[28:31], a[84:87], a[48:51], v[28:31]
    ds_read_b128 a[80:83], v12 offset:10240
    v_mfma_f32_16x16x32_bf16 v[76:79], a[84:87], a[52:55], v[76:79]
    s_add_u32 s17, s11, 28672
    buffer_load_dwordx4 a[40:43], v1, s[40:43], s17 offen sc1
    v_mfma_f32_16x16x32_bf16 a[104:107], a[88:91], a[48:51], a[104:107]
    ds_read_b128 a[84:87], v12 offset:11264
    v_mfma_f32_16x16x32_bf16 a[108:111], a[88:91], a[52:55], a[108:111]
    s_sub_u32 s52, s48, s27
    v_mfma_f32_16x16x32_bf16 v[32:35], a[92:95], a[48:51], v[32:35]
    ds_read_b128 a[88:91], v12 offset:12288
    v_mfma_f32_16x16x32_bf16 v[80:83], a[92:95], a[52:55], v[80:83]
    s_add_u32 s52, s52, 2048
    s_waitcnt lgkmcnt(4)
    v_mfma_f32_16x16x32_bf16 v[36:39], a[96:99], a[48:51], v[36:39]
    ds_read_b128 a[92:95], v12 offset:13312
    v_mfma_f32_16x16x32_bf16 v[84:87], a[96:99], a[52:55], v[84:87]
    s_add_u32 s17, s15, 28672
    buffer_load_dwordx4 a[44:47], v1, s[40:43], s17 offen sc1
    v_mfma_f32_16x16x32_bf16 v[40:43], a[100:103], a[48:51], v[40:43]
    ds_read_b128 a[96:99], v12 offset:14336
    v_mfma_f32_16x16x32_bf16 v[88:91], a[100:103], a[52:55], v[88:91]
    s_add_u32 s48, s48, 4096
    v_mfma_f32_16x16x32_bf16 v[44:47], a[72:75], a[48:51], v[44:47]
    ds_read_b128 a[100:103], v12 offset:15360
    v_mfma_f32_16x16x32_bf16 v[92:95], a[72:75], a[52:55], v[92:95]
    s_add_u32 s49, s49, 4096
    s_waitcnt vmcnt(20) lgkmcnt(4)
    v_mfma_f32_16x16x32_bf16 v[16:19], a[76:79], a[56:59], v[16:19]
    ds_read_b128 a[72:75], v12 offset:16384
    v_mfma_f32_16x16x32_bf16 v[64:67], a[76:79], a[60:63], v[64:67]
    s_xor_b32 s30, s4, 1
    v_mfma_f32_16x16x32_bf16 v[20:23], a[80:83], a[56:59], v[20:23]
    ds_read_b128 a[76:79], v12 offset:17408
    v_mfma_f32_16x16x32_bf16 v[68:71], a[80:83], a[60:63], v[68:71]
    s_mul_i32 s30, s30, 9216
    v_mfma_f32_16x16x32_bf16 v[24:27], a[84:87], a[56:59], v[24:27]
    ds_read_b128 a[80:83], v12 offset:18432
    v_mfma_f32_16x16x32_bf16 v[72:75], a[84:87], a[60:63], v[72:75]
    s_add_u32 s32, s56, s30
    s_waitcnt lgkmcnt(4)
    v_mfma_f32_16x16x32_bf16 v[28:31], a[88:91], a[56:59], v[28:31]
    ds_read_b128 a[84:87], v12 offset:19456
    v_mfma_f32_16x16x32_bf16 v[76:79], a[88:91], a[60:63], v[76:79]
    s_add_u32 s17, s9, 32768
    buffer_load_dwordx4 a[48:51], v1, s[40:43], s17 offen sc1
    v_mfma_f32_16x16x32_bf16 a[104:107], a[92:95], a[56:59], a[104:107]
    ds_read_b128 a[88:91], v12 offset:20480
    v_mfma_f32_16x16x32_bf16 a[108:111], a[92:95], a[60:63], a[108:111]
    s_xor_b32 s30, s4, 2
    v_mfma_f32_16x16x32_bf16 v[32:35], a[96:99], a[56:59], v[32:35]
    ds_read_b128 a[92:95], v12 offset:21504
    v_mfma_f32_16x16x32_bf16 v[80:83], a[96:99], a[60:63], v[80:83]
    s_mul_i32 s30, s30, 9216
    s_waitcnt lgkmcnt(4)
    v_mfma_f32_16x16x32_bf16 v[36:39], a[100:103], a[56:59], v[36:39]
    ds_read_b128 a[96:99], v12 offset:22528
    v_mfma_f32_16x16x32_bf16 v[84:87], a[100:103], a[60:63], v[84:87]
    s_add_u32 s17, s13, 32768
    buffer_load_dwordx4 a[52:55], v1, s[40:43], s17 offen sc1
    v_mfma_f32_16x16x32_bf16 v[40:43], a[72:75], a[56:59], v[40:43]
    ds_read_b128 a[100:103], v12 offset:23552
    v_mfma_f32_16x16x32_bf16 v[88:91], a[72:75], a[60:63], v[88:91]
    s_add_u32 s33, s56, s30
    v_mfma_f32_16x16x32_bf16 v[44:47], a[76:79], a[56:59], v[44:47]
    ds_read_b128 a[72:75], v12 offset:24576
    v_mfma_f32_16x16x32_bf16 v[92:95], a[76:79], a[60:63], v[92:95]
    s_xor_b32 s30, s4, 3
    s_waitcnt vmcnt(20) lgkmcnt(4)
    v_mfma_f32_16x16x32_bf16 v[16:19], a[80:83], a[64:67], v[16:19]
    ds_read_b128 a[76:79], v12 offset:25600
    v_mfma_f32_16x16x32_bf16 v[64:67], a[80:83], a[68:71], v[64:67]
    s_mul_i32 s30, s30, 9216
    v_mfma_f32_16x16x32_bf16 v[20:23], a[84:87], a[64:67], v[20:23]
    ds_read_b128 a[80:83], v12 offset:26624
    v_mfma_f32_16x16x32_bf16 v[68:71], a[84:87], a[68:71], v[68:71]
    s_add_u32 s34, s56, s30
    v_mfma_f32_16x16x32_bf16 v[24:27], a[88:91], a[64:67], v[24:27]
    ds_read_b128 a[84:87], v12 offset:27648
    v_mfma_f32_16x16x32_bf16 v[72:75], a[88:91], a[68:71], v[72:75]
    s_add_u32 s36, s32, 4096
    s_waitcnt lgkmcnt(4)
    v_mfma_f32_16x16x32_bf16 v[28:31], a[92:95], a[64:67], v[28:31]
    ds_read_b128 a[88:91], v12 offset:28672
    v_mfma_f32_16x16x32_bf16 v[76:79], a[92:95], a[68:71], v[76:79]
    s_add_u32 s17, s10, 32768
    buffer_load_dwordx4 a[56:59], v1, s[40:43], s17 offen sc1
    v_mfma_f32_16x16x32_bf16 a[104:107], a[96:99], a[64:67], a[104:107]
    ds_read_b128 a[92:95], v12 offset:29696
    v_mfma_f32_16x16x32_bf16 a[108:111], a[96:99], a[68:71], a[108:111]
    s_add_u32 s37, s33, 4096
    v_mfma_f32_16x16x32_bf16 v[32:35], a[100:103], a[64:67], v[32:35]
    ds_read_b128 a[96:99], v12 offset:30720
    v_mfma_f32_16x16x32_bf16 v[80:83], a[100:103], a[68:71], v[80:83]
    s_add_u32 s38, s34, 4096
    s_waitcnt lgkmcnt(4)
    v_mfma_f32_16x16x32_bf16 v[36:39], a[72:75], a[64:67], v[36:39]
    ds_read_b128 a[100:103], v12 offset:31744
    v_mfma_f32_16x16x32_bf16 v[84:87], a[72:75], a[68:71], v[84:87]
    s_add_u32 s17, s14, 32768
    buffer_load_dwordx4 a[60:63], v1, s[40:43], s17 offen sc1
    v_mfma_f32_16x16x32_bf16 v[40:43], a[76:79], a[64:67], v[40:43]
    ds_read_b128 a[72:75], v12 offset:32768
    v_mfma_f32_16x16x32_bf16 v[88:91], a[76:79], a[68:71], v[88:91]
    s_add_u32 s32, s32, s27
    v_mfma_f32_16x16x32_bf16 v[44:47], a[80:83], a[64:67], v[44:47]
    ds_read_b128 a[76:79], v12 offset:33792
    v_mfma_f32_16x16x32_bf16 v[92:95], a[80:83], a[68:71], v[92:95]
    s_add_u32 s33, s33, s27
    s_waitcnt vmcnt(20) lgkmcnt(4)
    v_mfma_f32_16x16x32_bf16 v[16:19], a[84:87], a[0:3], v[16:19]
    ds_read_b128 a[80:83], v12 offset:34816
    v_mfma_f32_16x16x32_bf16 v[64:67], a[84:87], a[4:7], v[64:67]
    s_add_u32 s34, s34, s27
    v_mfma_f32_16x16x32_bf16 v[20:23], a[88:91], a[0:3], v[20:23]
    ds_read_b128 a[84:87], v12 offset:35840
    v_mfma_f32_16x16x32_bf16 v[68:71], a[88:91], a[4:7], v[68:71]
    s_add_u32 s57, s57, s7
    v_mfma_f32_16x16x32_bf16 v[24:27], a[92:95], a[0:3], v[24:27]
    s_barrier
    ds_read_b128 a[88:91], v13 offset:5120
    v_mfma_f32_16x16x32_bf16 v[72:75], a[92:95], a[4:7], v[72:75]
    s_add_u32 s53, s53, s7
    s_waitcnt lgkmcnt(4)
    v_mfma_f32_16x16x32_bf16 v[28:31], a[96:99], a[0:3], v[28:31]
    ds_read_b128 a[92:95], v13 offset:6144
    v_mfma_f32_16x16x32_bf16 v[76:79], a[96:99], a[4:7], v[76:79]
    s_add_u32 s17, s11, 32768
    buffer_load_dwordx4 a[64:67], v1, s[40:43], s17 offen sc1
    v_mfma_f32_16x16x32_bf16 a[104:107], a[100:103], a[0:3], a[104:107]
    ds_read_b128 a[96:99], v13 offset:14336
    v_mfma_f32_16x16x32_bf16 a[108:111], a[100:103], a[4:7], a[108:111]
    s_mov_b32 s31, 0xffff0000
    v_mfma_f32_16x16x32_bf16 v[32:35], a[72:75], a[0:3], v[32:35]
    ds_read_b128 a[100:103], v13 offset:15360
    v_mfma_f32_16x16x32_bf16 v[80:83], a[72:75], a[4:7], v[80:83]
    s_mov_b32 s35, 0x100000
    s_waitcnt lgkmcnt(4)
    v_mfma_f32_16x16x32_bf16 v[36:39], a[76:79], a[0:3], v[36:39]
    ds_read_b128 a[72:75], v13 offset:23552
    v_mfma_f32_16x16x32_bf16 v[84:87], a[76:79], a[4:7], v[84:87]
    s_add_u32 s17, s15, 32768
    buffer_load_dwordx4 a[68:71], v1, s[40:43], s17 offen sc1
    v_mfma_f32_16x16x32_bf16 v[40:43], a[80:83], a[0:3], v[40:43]
    ds_read_b128 a[76:79], v13 offset:24576
    v_mfma_f32_16x16x32_bf16 v[88:91], a[80:83], a[4:7], v[88:91]
    v_lshrrev_b32 v3, 1, v1
    v_mfma_f32_16x16x32_bf16 v[44:47], a[84:87], a[0:3], v[44:47]
    ds_read_b128 a[80:83], v13 offset:32768
    v_mfma_f32_16x16x32_bf16 v[92:95], a[84:87], a[4:7], v[92:95]
    s_waitcnt vmcnt(18) lgkmcnt(4)
    v_mfma_f32_16x16x32_bf16 v[32:35], a[88:91], a[8:11], v[32:35]
    ds_read_b128 a[84:87], v13 offset:33792
    v_mfma_f32_16x16x32_bf16 v[80:83], a[88:91], a[12:15], v[80:83]
    v_mfma_f32_16x16x32_bf16 v[36:39], a[92:95], a[8:11], v[36:39]
    s_barrier
    ds_read_b128 a[88:91], v14 offset:5120
    v_mfma_f32_16x16x32_bf16 v[84:87], a[92:95], a[12:15], v[84:87]
    v_mfma_f32_16x16x32_bf16 v[32:35], a[96:99], a[16:19], v[32:35]
    ds_read_b128 a[92:95], v14 offset:6144
    v_mfma_f32_16x16x32_bf16 v[80:83], a[96:99], a[20:23], v[80:83]
    s_waitcnt vmcnt(11) lgkmcnt(4)
    v_mfma_f32_16x16x32_bf16 v[36:39], a[100:103], a[16:19], v[36:39]
    ds_read_b128 a[96:99], v14 offset:14336
    v_mfma_f32_16x16x32_bf16 v[84:87], a[100:103], a[20:23], v[84:87]
    v_mfma_f32_16x16x32_bf16 v[32:35], a[72:75], a[24:27], v[32:35]
    ds_read_b128 a[100:103], v14 offset:15360
    v_mfma_f32_16x16x32_bf16 v[80:83], a[72:75], a[28:31], v[80:83]
    v_mfma_f32_16x16x32_bf16 v[36:39], a[76:79], a[24:27], v[36:39]
    ds_read_b128 a[72:75], v14 offset:23552
    v_mfma_f32_16x16x32_bf16 v[84:87], a[76:79], a[28:31], v[84:87]
    s_waitcnt vmcnt(6) lgkmcnt(4)
    v_mfma_f32_16x16x32_bf16 v[32:35], a[80:83], a[32:35], v[32:35]
    ds_read_b128 a[76:79], v14 offset:24576
    v_mfma_f32_16x16x32_bf16 v[80:83], a[80:83], a[36:39], v[80:83]
    v_mfma_f32_16x16x32_bf16 v[36:39], a[84:87], a[32:35], v[36:39]
    ds_read_b128 a[80:83], v14 offset:32768
    v_mfma_f32_16x16x32_bf16 v[84:87], a[84:87], a[36:39], v[84:87]
    v_mfma_f32_16x16x32_bf16 v[32:35], a[88:91], a[40:43], v[32:35]
    ds_read_b128 a[84:87], v14 offset:33792
    v_mfma_f32_16x16x32_bf16 v[80:83], a[88:91], a[44:47], v[80:83]
    s_waitcnt vmcnt(4) lgkmcnt(4)
    v_mfma_f32_16x16x32_bf16 v[36:39], a[92:95], a[40:43], v[36:39]
    ds_read_b128 a[88:91], v13 offset:7168
    v_mfma_f32_16x16x32_bf16 v[84:87], a[92:95], a[44:47], v[84:87]
    v_mfma_f32_16x16x32_bf16 v[32:35], a[96:99], a[48:51], v[32:35]
    ds_read_b128 a[92:95], v13 offset:8192
    v_mfma_f32_16x16x32_bf16 v[80:83], a[96:99], a[52:55], v[80:83]
    v_mfma_f32_16x16x32_bf16 v[36:39], a[100:103], a[48:51], v[36:39]
    ds_read_b128 a[96:99], v13 offset:4096
    v_mfma_f32_16x16x32_bf16 v[84:87], a[100:103], a[52:55], v[84:87]
    s_waitcnt vmcnt(0) lgkmcnt(4)
    v_mfma_f32_16x16x32_bf16 v[32:35], a[72:75], a[56:59], v[32:35]
    ds_read_b128 a[100:103], v13 offset:16384
    v_mfma_f32_16x16x32_bf16 v[80:83], a[72:75], a[60:63], v[80:83]
    v_mfma_f32_16x16x32_bf16 v[36:39], a[76:79], a[56:59], v[36:39]
    ds_read_b128 a[72:75], v13 offset:17408
    v_mfma_f32_16x16x32_bf16 v[84:87], a[76:79], a[60:63], v[84:87]
    v_mfma_f32_16x16x32_bf16 v[32:35], a[80:83], a[64:67], v[32:35]
    ds_read_b128 a[76:79], v13 offset:13312
    v_mfma_f32_16x16x32_bf16 v[80:83], a[80:83], a[68:71], v[80:83]
    s_waitcnt lgkmcnt(4)
    v_mfma_f32_16x16x32_bf16 v[36:39], a[84:87], a[64:67], v[36:39]
    ds_read_b128 a[80:83], v13 offset:25600
    v_mfma_f32_16x16x32_bf16 v[84:87], a[84:87], a[68:71], v[84:87]
    v_mfma_f32_16x16x32_bf16 v[40:43], a[88:91], a[8:11], v[40:43]
    ds_read_b128 a[84:87], v13 offset:26624
    v_mfma_f32_16x16x32_bf16 v[88:91], a[88:91], a[12:15], v[88:91]
    v_cvt_pk_bf16_f32 v32, v32, v33
    v_cvt_pk_bf16_f32 v33, v34, v35
    v_mfma_f32_16x16x32_bf16 v[44:47], a[92:95], a[8:11], v[44:47]
    ds_read_b128 a[88:91], v13 offset:22528
    v_cvt_pk_bf16_f32 v34, v36, v37
    v_cvt_pk_bf16_f32 v35, v38, v39
    v_mfma_f32_16x16x32_bf16 v[92:95], a[92:95], a[12:15], v[92:95]
    v_min_u32 v32, -2, v32
    v_min_u32 v33, -2, v33
    s_waitcnt lgkmcnt(4)
    v_mfma_f32_16x16x32_bf16 a[104:107], a[96:99], a[8:11], a[104:107]
    ds_read_b128 a[92:95], v13 offset:34816
    v_min_u32 v34, -2, v34
    v_min_u32 v35, -2, v35
    v_mfma_f32_16x16x32_bf16 a[108:111], a[96:99], a[12:15], a[108:111]
    buffer_store_dwordx4 v[32:35], v1, s[44:47], s52 offen offset:0 sc1
    v_cvt_pk_bf16_f32 v80, v80, v81
    v_mfma_f32_16x16x32_bf16 v[40:43], a[100:103], a[16:19], v[40:43]
    ds_read_b128 a[96:99], v13 offset:35840
    v_cvt_pk_bf16_f32 v81, v82, v83
    v_cvt_pk_bf16_f32 v82, v84, v85
    v_mfma_f32_16x16x32_bf16 v[88:91], a[100:103], a[20:23], v[88:91]
    v_cvt_pk_bf16_f32 v83, v86, v87
    v_min_u32 v80, -2, v80
    v_mfma_f32_16x16x32_bf16 v[44:47], a[72:75], a[16:19], v[44:47]
    ds_read_b128 a[100:103], v13 offset:31744
    v_min_u32 v81, -2, v81
    v_min_u32 v82, -2, v82
    v_mfma_f32_16x16x32_bf16 v[92:95], a[72:75], a[20:23], v[92:95]
    v_min_u32 v83, -2, v83
    buffer_store_dwordx4 v[80:83], v1, s[44:47], s51 offen offset:0 sc1
    s_waitcnt lgkmcnt(4)
    v_mfma_f32_16x16x32_bf16 a[104:107], a[76:79], a[16:19], a[104:107]
    ds_read_b128 a[72:75], v14 offset:7168
    v_mfma_f32_16x16x32_bf16 a[108:111], a[76:79], a[20:23], a[108:111]
    v_mfma_f32_16x16x32_bf16 v[40:43], a[80:83], a[24:27], v[40:43]
    ds_read_b128 a[76:79], v14 offset:8192
    v_mfma_f32_16x16x32_bf16 v[88:91], a[80:83], a[28:31], v[88:91]
    v_mfma_f32_16x16x32_bf16 v[44:47], a[84:87], a[24:27], v[44:47]
    ds_read_b128 a[80:83], v14 offset:4096
    v_mfma_f32_16x16x32_bf16 v[92:95], a[84:87], a[28:31], v[92:95]
    s_waitcnt lgkmcnt(4)
    v_mfma_f32_16x16x32_bf16 a[104:107], a[88:91], a[24:27], a[104:107]
    ds_read_b128 a[84:87], v14 offset:16384
    v_mfma_f32_16x16x32_bf16 a[108:111], a[88:91], a[28:31], a[108:111]
    v_mfma_f32_16x16x32_bf16 v[40:43], a[92:95], a[32:35], v[40:43]
    ds_read_b128 a[88:91], v14 offset:17408
    v_mfma_f32_16x16x32_bf16 v[88:91], a[92:95], a[36:39], v[88:91]
    v_mfma_f32_16x16x32_bf16 v[44:47], a[96:99], a[32:35], v[44:47]
    ds_read_b128 a[92:95], v14 offset:13312
    v_mfma_f32_16x16x32_bf16 v[92:95], a[96:99], a[36:39], v[92:95]
    s_waitcnt lgkmcnt(4)
    v_mfma_f32_16x16x32_bf16 a[104:107], a[100:103], a[32:35], a[104:107]
    ds_read_b128 a[96:99], v14 offset:25600
    v_mfma_f32_16x16x32_bf16 a[108:111], a[100:103], a[36:39], a[108:111]
    v_mfma_f32_16x16x32_bf16 v[40:43], a[72:75], a[40:43], v[40:43]
    ds_read_b128 a[100:103], v14 offset:26624
    v_mfma_f32_16x16x32_bf16 v[88:91], a[72:75], a[44:47], v[88:91]
    v_mfma_f32_16x16x32_bf16 v[44:47], a[76:79], a[40:43], v[44:47]
    ds_read_b128 a[72:75], v14 offset:22528
    v_mfma_f32_16x16x32_bf16 v[92:95], a[76:79], a[44:47], v[92:95]
    s_waitcnt lgkmcnt(4)
    v_mfma_f32_16x16x32_bf16 a[104:107], a[80:83], a[40:43], a[104:107]
    ds_read_b128 a[76:79], v14 offset:34816
    v_mfma_f32_16x16x32_bf16 a[108:111], a[80:83], a[44:47], a[108:111]
    v_mfma_f32_16x16x32_bf16 v[40:43], a[84:87], a[48:51], v[40:43]
    ds_read_b128 a[80:83], v14 offset:35840
    v_mfma_f32_16x16x32_bf16 v[88:91], a[84:87], a[52:55], v[88:91]
    v_mfma_f32_16x16x32_bf16 v[44:47], a[88:91], a[48:51], v[44:47]
    ds_read_b128 a[84:87], v14 offset:31744
    v_mfma_f32_16x16x32_bf16 v[92:95], a[88:91], a[52:55], v[92:95]
    s_waitcnt lgkmcnt(4)
    v_mfma_f32_16x16x32_bf16 a[104:107], a[92:95], a[48:51], a[104:107]
    ds_read_b128 a[88:91], v13 offset:0
    v_mfma_f32_16x16x32_bf16 a[108:111], a[92:95], a[52:55], a[108:111]
    v_mfma_f32_16x16x32_bf16 v[40:43], a[96:99], a[56:59], v[40:43]
    ds_read_b128 a[92:95], v13 offset:1024
    v_mfma_f32_16x16x32_bf16 v[88:91], a[96:99], a[60:63], v[88:91]
    v_mfma_f32_16x16x32_bf16 v[44:47], a[100:103], a[56:59], v[44:47]
    ds_read_b128 a[96:99], v13 offset:2048
    v_mfma_f32_16x16x32_bf16 v[92:95], a[100:103], a[60:63], v[92:95]
    s_waitcnt lgkmcnt(4)
    v_mfma_f32_16x16x32_bf16 a[104:107], a[72:75], a[56:59], a[104:107]
    ds_read_b128 a[100:103], v13 offset:3072
    v_mfma_f32_16x16x32_bf16 a[108:111], a[72:75], a[60:63], a[108:111]
    v_mfma_f32_16x16x32_bf16 v[40:43], a[76:79], a[64:67], v[40:43]
    ds_read_b128 a[72:75], v13 offset:9216
    v_mfma_f32_16x16x32_bf16 v[88:91], a[76:79], a[68:71], v[88:91]
    v_mfma_f32_16x16x32_bf16 v[44:47], a[80:83], a[64:67], v[44:47]
    ds_read_b128 a[76:79], v13 offset:10240
    v_mfma_f32_16x16x32_bf16 v[92:95], a[80:83], a[68:71], v[92:95]
    s_waitcnt lgkmcnt(4)
    v_mfma_f32_16x16x32_bf16 a[104:107], a[84:87], a[64:67], a[104:107]
    ds_read_b128 a[80:83], v13 offset:11264
    v_mfma_f32_16x16x32_bf16 a[108:111], a[84:87], a[68:71], a[108:111]
    v_mfma_f32_16x16x32_bf16 v[64:67], a[88:91], a[12:15], v[64:67]
    ds_read_b128 a[84:87], v13 offset:12288
    v_mfma_f32_16x16x32_bf16 v[68:71], a[92:95], a[12:15], v[68:71]
    ds_read_b128 a[88:91], v13 offset:18432
    v_cvt_pk_bf16_f32 v40, v40, v41
    v_cvt_pk_bf16_f32 v41, v42, v43
    s_waitcnt lgkmcnt(4)
    v_mfma_f32_16x16x32_bf16 v[72:75], a[96:99], a[12:15], v[72:75]
    ds_read_b128 a[92:95], v13 offset:19456
    v_cvt_pk_bf16_f32 v42, v44, v45
    v_cvt_pk_bf16_f32 v43, v46, v47
    v_mfma_f32_16x16x32_bf16 v[76:79], a[100:103], a[12:15], v[76:79]
    ds_read_b128 a[96:99], v13 offset:20480
    v_min_u32 v40, -2, v40
    v_min_u32 v41, -2, v41
    v_mfma_f32_16x16x32_bf16 v[64:67], a[72:75], a[20:23], v[64:67]
    ds_read_b128 a[100:103], v13 offset:21504
    v_min_u32 v42, -2, v42
    v_min_u32 v43, -2, v43
    s_waitcnt lgkmcnt(4)
    v_mfma_f32_16x16x32_bf16 v[68:71], a[76:79], a[20:23], v[68:71]
    ds_read_b128 a[72:75], v13 offset:27648
    buffer_store_dwordx4 v[40:43], v1, s[44:47], s52 offen offset:1024 sc1
    v_cvt_pk_bf16_f32 v88, v88, v89
    v_mfma_f32_16x16x32_bf16 v[72:75], a[80:83], a[20:23], v[72:75]
    ds_read_b128 a[76:79], v13 offset:28672
    v_cvt_pk_bf16_f32 v89, v90, v91
    v_cvt_pk_bf16_f32 v90, v92, v93
    v_mfma_f32_16x16x32_bf16 v[76:79], a[84:87], a[20:23], v[76:79]
    ds_read_b128 a[80:83], v13 offset:29696
    v_cvt_pk_bf16_f32 v91, v94, v95
    v_min_u32 v88, -2, v88
    s_waitcnt lgkmcnt(4)
    v_mfma_f32_16x16x32_bf16 v[64:67], a[88:91], a[28:31], v[64:67]
    ds_read_b128 a[84:87], v13 offset:30720
    v_min_u32 v89, -2, v89
    v_min_u32 v90, -2, v90
    v_mfma_f32_16x16x32_bf16 v[68:71], a[92:95], a[28:31], v[68:71]
    ds_read_b128 a[88:91], v14 offset:0
    v_min_u32 v91, -2, v91
    buffer_store_dwordx4 v[88:91], v1, s[44:47], s51 offen offset:1024 sc1
    v_mfma_f32_16x16x32_bf16 v[72:75], a[96:99], a[28:31], v[72:75]
    ds_read_b128 a[92:95], v14 offset:1024
    v_accvgpr_read_b32 v96, a104
    v_accvgpr_read_b32 v97, a105
    s_waitcnt lgkmcnt(4)
    v_mfma_f32_16x16x32_bf16 v[76:79], a[100:103], a[28:31], v[76:79]
    ds_read_b128 a[96:99], v14 offset:2048
    v_accvgpr_read_b32 v98, a106
    v_accvgpr_read_b32 v99, a107
    v_mfma_f32_16x16x32_bf16 v[64:67], a[72:75], a[36:39], v[64:67]
    ds_read_b128 a[100:103], v14 offset:3072
    v_accvgpr_read_b32 v100, a108
    v_accvgpr_read_b32 v101, a109
    v_mfma_f32_16x16x32_bf16 v[68:71], a[76:79], a[36:39], v[68:71]
    ds_read_b128 a[72:75], v14 offset:9216
    v_accvgpr_read_b32 v102, a110
    v_accvgpr_read_b32 v103, a111
    s_waitcnt lgkmcnt(4)
    v_mfma_f32_16x16x32_bf16 v[72:75], a[80:83], a[36:39], v[72:75]
    ds_read_b128 a[76:79], v14 offset:10240
    v_cvt_pk_bf16_f32 v8, v96, v97
    v_cvt_pk_bf16_f32 v9, v98, v99
    v_mfma_f32_16x16x32_bf16 v[76:79], a[84:87], a[36:39], v[76:79]
    ds_read_b128 a[80:83], v14 offset:11264
    v_min_u32 v8, -2, v8
    v_min_u32 v9, -2, v9
    v_mfma_f32_16x16x32_bf16 v[64:67], a[88:91], a[44:47], v[64:67]
    ds_read_b128 a[84:87], v14 offset:12288
    buffer_store_dwordx2 v[8:9], v3, s[44:47], s48 offen sc1
    v_cvt_pk_bf16_f32 v100, v100, v101
    s_waitcnt lgkmcnt(4)
    v_mfma_f32_16x16x32_bf16 v[68:71], a[92:95], a[44:47], v[68:71]
    ds_read_b128 a[88:91], v14 offset:18432
    v_cvt_pk_bf16_f32 v101, v102, v103
    v_min_u32 v100, -2, v100
    v_mfma_f32_16x16x32_bf16 v[72:75], a[96:99], a[44:47], v[72:75]
    ds_read_b128 a[92:95], v14 offset:19456
    v_min_u32 v101, -2, v101
    buffer_store_dwordx2 v[100:101], v3, s[44:47], s49 offen sc1
    v_mfma_f32_16x16x32_bf16 v[76:79], a[100:103], a[44:47], v[76:79]
    ds_read_b128 a[96:99], v14 offset:20480
    s_waitcnt lgkmcnt(4)
    v_mfma_f32_16x16x32_bf16 v[64:67], a[72:75], a[52:55], v[64:67]
    ds_read_b128 a[100:103], v14 offset:21504
    v_mfma_f32_16x16x32_bf16 v[68:71], a[76:79], a[52:55], v[68:71]
    ds_read_b128 a[72:75], v14 offset:27648
    v_mfma_f32_16x16x32_bf16 v[72:75], a[80:83], a[52:55], v[72:75]
    ds_read_b128 a[76:79], v14 offset:28672
    s_waitcnt lgkmcnt(4)
    v_mfma_f32_16x16x32_bf16 v[76:79], a[84:87], a[52:55], v[76:79]
    ds_read_b128 a[80:83], v14 offset:29696
    v_mfma_f32_16x16x32_bf16 v[64:67], a[88:91], a[60:63], v[64:67]
    ds_read_b128 a[84:87], v14 offset:30720
    v_mfma_f32_16x16x32_bf16 v[68:71], a[92:95], a[60:63], v[68:71]
    ds_read_b128 a[88:91], v13 offset:0
    s_waitcnt lgkmcnt(4)
    v_mfma_f32_16x16x32_bf16 v[72:75], a[96:99], a[60:63], v[72:75]
    ds_read_b128 a[92:95], v13 offset:1024
    v_mfma_f32_16x16x32_bf16 v[76:79], a[100:103], a[60:63], v[76:79]
    ds_read_b128 a[96:99], v13 offset:2048
    v_mfma_f32_16x16x32_bf16 v[64:67], a[72:75], a[68:71], v[64:67]
    ds_read_b128 a[100:103], v13 offset:3072
    s_waitcnt lgkmcnt(4)
    v_mfma_f32_16x16x32_bf16 v[68:71], a[76:79], a[68:71], v[68:71]
    ds_read_b128 a[72:75], v13 offset:9216
    v_mfma_f32_16x16x32_bf16 v[72:75], a[80:83], a[68:71], v[72:75]
    ds_read_b128 a[76:79], v13 offset:10240
    v_mfma_f32_16x16x32_bf16 v[76:79], a[84:87], a[68:71], v[76:79]
    ds_read_b128 a[80:83], v13 offset:11264
    s_waitcnt lgkmcnt(4)
    v_mfma_f32_16x16x32_bf16 v[16:19], a[88:91], a[8:11], v[16:19]
    ds_read_b128 a[84:87], v13 offset:12288
    v_mfma_f32_16x16x32_bf16 v[20:23], a[92:95], a[8:11], v[20:23]
    ds_read_b128 a[88:91], v13 offset:18432
    v_cvt_pk_bf16_f32 v64, v64, v65
    v_cvt_pk_bf16_f32 v65, v66, v67
    v_mfma_f32_16x16x32_bf16 v[24:27], a[96:99], a[8:11], v[24:27]
    ds_read_b128 a[92:95], v13 offset:19456
    v_cvt_pk_bf16_f32 v66, v68, v69
    v_cvt_pk_bf16_f32 v67, v70, v71
    s_waitcnt lgkmcnt(4)
    v_mfma_f32_16x16x32_bf16 v[28:31], a[100:103], a[8:11], v[28:31]
    ds_read_b128 a[96:99], v13 offset:20480
    v_min_u32 v64, -2, v64
    v_min_u32 v65, -2, v65
    v_mfma_f32_16x16x32_bf16 v[16:19], a[72:75], a[16:19], v[16:19]
    ds_read_b128 a[100:103], v13 offset:21504
    v_min_u32 v66, -2, v66
    v_min_u32 v67, -2, v67
    v_mfma_f32_16x16x32_bf16 v[20:23], a[76:79], a[16:19], v[20:23]
    ds_read_b128 a[72:75], v13 offset:27648
    buffer_store_dwordx4 v[64:67], v1, s[44:47], s50 offen offset:0 sc1
    v_cvt_pk_bf16_f32 v72, v72, v73
    s_waitcnt lgkmcnt(4)
    v_mfma_f32_16x16x32_bf16 v[24:27], a[80:83], a[16:19], v[24:27]
    ds_read_b128 a[76:79], v13 offset:28672
    v_cvt_pk_bf16_f32 v73, v74, v75
    v_cvt_pk_bf16_f32 v74, v76, v77
    v_mfma_f32_16x16x32_bf16 v[28:31], a[84:87], a[16:19], v[28:31]
    ds_read_b128 a[80:83], v13 offset:29696
    v_cvt_pk_bf16_f32 v75, v78, v79
    v_min_u32 v72, -2, v72
    v_mfma_f32_16x16x32_bf16 v[16:19], a[88:91], a[24:27], v[16:19]
    ds_read_b128 a[84:87], v13 offset:30720
    v_min_u32 v73, -2, v73
    v_min_u32 v74, -2, v74
    s_waitcnt lgkmcnt(4)
    v_mfma_f32_16x16x32_bf16 v[20:23], a[92:95], a[24:27], v[20:23]
    ds_read_b128 a[88:91], v14 offset:0
    v_min_u32 v75, -2, v75
    buffer_store_dwordx4 v[72:75], v1, s[44:47], s50 offen offset:1024 sc1
    v_mfma_f32_16x16x32_bf16 v[24:27], a[96:99], a[24:27], v[24:27]
    ds_read_b128 a[92:95], v14 offset:1024
    s_waitcnt vmcnt(18)
    v_lshlrev_b32 v32, 16, v56
    v_mfma_f32_16x16x32_bf16 v[28:31], a[100:103], a[24:27], v[28:31]
    ds_read_b128 a[96:99], v14 offset:2048
    v_and_b32 v33, s31, v56
    v_lshlrev_b32 v34, 16, v57
    s_waitcnt lgkmcnt(4)
    v_mfma_f32_16x16x32_bf16 v[16:19], a[72:75], a[32:35], v[16:19]
    ds_read_b128 a[100:103], v14 offset:3072
    v_and_b32 v35, s31, v57
    v_lshlrev_b32 v36, 16, v58
    v_mfma_f32_16x16x32_bf16 v[20:23], a[76:79], a[32:35], v[20:23]
    ds_read_b128 a[72:75], v14 offset:9216
    v_and_b32 v37, s31, v58
    v_lshlrev_b32 v38, 16, v59
    v_mfma_f32_16x16x32_bf16 v[24:27], a[80:83], a[32:35], v[24:27]
    ds_read_b128 a[76:79], v14 offset:10240
    v_and_b32 v39, s31, v59
    v_lshlrev_b32 v40, 16, v60
    s_waitcnt lgkmcnt(4)
    v_mfma_f32_16x16x32_bf16 v[28:31], a[84:87], a[32:35], v[28:31]
    ds_read_b128 a[80:83], v14 offset:11264
    v_and_b32 v41, s31, v60
    v_lshlrev_b32 v42, 16, v61
    v_mfma_f32_16x16x32_bf16 v[16:19], a[88:91], a[40:43], v[16:19]
    ds_read_b128 a[84:87], v14 offset:12288
    v_and_b32 v43, s31, v61
    v_lshlrev_b32 v44, 16, v62
    v_mfma_f32_16x16x32_bf16 v[20:23], a[92:95], a[40:43], v[20:23]
    ds_read_b128 a[88:91], v14 offset:18432
    v_and_b32 v45, s31, v62
    v_lshlrev_b32 v46, 16, v63
    s_waitcnt lgkmcnt(4)
    v_mfma_f32_16x16x32_bf16 v[24:27], a[96:99], a[40:43], v[24:27]
    ds_read_b128 a[92:95], v14 offset:19456
    v_and_b32 v47, s31, v63
    v_lshlrev_b32 v100, 16, v106
    v_mfma_f32_16x16x32_bf16 v[28:31], a[100:103], a[40:43], v[28:31]
    ds_read_b128 a[96:99], v14 offset:20480
    v_and_b32 v101, s31, v106
    v_lshlrev_b32 v102, 16, v107
    v_mfma_f32_16x16x32_bf16 v[16:19], a[72:75], a[48:51], v[16:19]
    ds_read_b128 a[100:103], v14 offset:21504
    v_and_b32 v103, s31, v107
    s_waitcnt lgkmcnt(4)
    v_mfma_f32_16x16x32_bf16 v[20:23], a[76:79], a[48:51], v[20:23]
    ds_read_b128 a[72:75], v14 offset:27648
    v_mfma_f32_16x16x32_bf16 v[24:27], a[80:83], a[48:51], v[24:27]
    ds_read_b128 a[76:79], v14 offset:28672
    v_mfma_f32_16x16x32_bf16 v[28:31], a[84:87], a[48:51], v[28:31]
    ds_read_b128 a[80:83], v14 offset:29696
    s_waitcnt lgkmcnt(4)
    v_mfma_f32_16x16x32_bf16 v[16:19], a[88:91], a[56:59], v[16:19]
    ds_read_b128 a[84:87], v14 offset:30720
    v_mfma_f32_16x16x32_bf16 v[20:23], a[92:95], a[56:59], v[20:23]
    v_mfma_f32_16x16x32_bf16 v[24:27], a[96:99], a[56:59], v[24:27]
    s_waitcnt lgkmcnt(2)
    v_mfma_f32_16x16x32_bf16 v[28:31], a[100:103], a[56:59], v[28:31]
    v_mfma_f32_16x16x32_bf16 v[16:19], a[72:75], a[64:67], v[16:19]
    v_mfma_f32_16x16x32_bf16 v[20:23], a[76:79], a[64:67], v[20:23]
    s_waitcnt lgkmcnt(0)
    v_mfma_f32_16x16x32_bf16 v[24:27], a[80:83], a[64:67], v[24:27]
    v_mfma_f32_16x16x32_bf16 v[28:31], a[84:87], a[64:67], v[28:31]
    v_lshlrev_b32 v10, 16, v105
    v_and_b32 v11, s31, v105
    v_pk_fma_f32 v[98:99], v[98:99], v[102:103], v[10:11]
    v_lshlrev_b32 v10, 16, v104
    v_and_b32 v11, s31, v104
    v_pk_fma_f32 v[96:97], v[96:97], v[100:101], v[10:11]
    v_lshlrev_b32 v10, 16, v55
    v_and_b32 v11, s31, v55
    v_pk_fma_f32 v[30:31], v[30:31], v[46:47], v[10:11]
    v_lshlrev_b32 v10, 16, v54
    v_and_b32 v11, s31, v54
    v_pk_fma_f32 v[28:29], v[28:29], v[44:45], v[10:11]
    v_lshlrev_b32 v10, 16, v53
    v_and_b32 v11, s31, v53
    v_pk_fma_f32 v[26:27], v[26:27], v[42:43], v[10:11]
    v_lshlrev_b32 v10, 16, v52
    v_and_b32 v11, s31, v52
    v_pk_fma_f32 v[24:25], v[24:25], v[40:41], v[10:11]
    v_lshlrev_b32 v10, 16, v51
    v_and_b32 v11, s31, v51
    v_pk_fma_f32 v[22:23], v[22:23], v[38:39], v[10:11]
    v_lshlrev_b32 v10, 16, v50
    v_and_b32 v11, s31, v50
    v_pk_fma_f32 v[20:21], v[20:21], v[36:37], v[10:11]
    v_lshlrev_b32 v10, 16, v49
    v_and_b32 v11, s31, v49
    v_pk_fma_f32 v[18:19], v[18:19], v[34:35], v[10:11]
    v_lshlrev_b32 v10, 16, v48
    v_and_b32 v11, s31, v48
    v_pk_fma_f32 v[16:17], v[16:17], v[32:33], v[10:11]
    s_waitcnt vmcnt(0)
KM_RETRY:
    buffer_load_dwordx4 v[64:67], v1, s[44:47], s32 offen offset:0 sc1
    buffer_load_dwordx4 v[68:71], v1, s[44:47], s32 offen offset:1024 sc1
    buffer_load_dwordx2 v[88:89], v3, s[44:47], s36 offen sc1
    buffer_load_dwordx4 v[72:75], v1, s[44:47], s33 offen offset:0 sc1
    buffer_load_dwordx4 v[76:79], v1, s[44:47], s33 offen offset:1024 sc1
    buffer_load_dwordx2 v[90:91], v3, s[44:47], s37 offen sc1
    buffer_load_dwordx4 v[80:83], v1, s[44:47], s34 offen offset:0 sc1
    buffer_load_dwordx4 v[84:87], v1, s[44:47], s34 offen offset:1024 sc1
    buffer_load_dwordx2 v[92:93], v3, s[44:47], s38 offen sc1
    s_waitcnt vmcnt(6)
    v_max3_u32 v8, v64, v65, v66
    v_max3_u32 v9, v67, v68, v69
    v_max3_u32 v8, v8, v70, v71
    v_max3_u32 v9, v9, v88, v89
    s_waitcnt vmcnt(3)
    v_max3_u32 v8, v8, v72, v73
    v_max3_u32 v9, v9, v74, v75
    v_max3_u32 v8, v8, v76, v77
    v_max3_u32 v9, v9, v78, v79
    v_max3_u32 v8, v8, v90, v91
    s_waitcnt vmcnt(0)
    v_max3_u32 v8, v8, v80, v81
    v_max3_u32 v9, v9, v82, v83
    v_max3_u32 v8, v8, v84, v85
    v_max3_u32 v9, v9, v86, v87
    v_max3_u32 v8, v8, v92, v93
    v_max_u32 v8, v8, v9
    v_cmp_eq_u32 vcc, -1, v8
    s_nop 1
    s_cbranch_vccz KM_FIN
    s_sub_u32 s35, s35, 1
    s_cbranch_scc1 KM_FIN
    s_sleep 3
    s_branch KM_RETRY
KM_FIN:
    v_lshlrev_b32 v48, 16, v64
    v_and_b32 v49, s31, v64
    v_lshlrev_b32 v50, 16, v72
    v_and_b32 v51, s31, v72
    v_lshlrev_b32 v52, 16, v80
    v_and_b32 v53, s31, v80
    v_pk_add_f32 v[48:49], v[48:49], v[50:51]
    v_pk_add_f32 v[48:49], v[48:49], v[52:53]
    v_pk_fma_f32 v[16:17], v[48:49], v[32:33], v[16:17]
    v_cvt_pk_bf16_f32 v64, v16, v17
    v_lshlrev_b32 v54, 16, v65
    v_and_b32 v55, s31, v65
    v_lshlrev_b32 v56, 16, v73
    v_and_b32 v57, s31, v73
    v_lshlrev_b32 v58, 16, v81
    v_and_b32 v59, s31, v81
    v_pk_add_f32 v[54:55], v[54:55], v[56:57]
    v_pk_add_f32 v[54:55], v[54:55], v[58:59]
    v_pk_fma_f32 v[18:19], v[54:55], v[34:35], v[18:19]
    v_cvt_pk_bf16_f32 v65, v18, v19
    v_lshlrev_b32 v48, 16, v66
    v_and_b32 v49, s31, v66
    v_lshlrev_b32 v50, 16, v74
    v_and_b32 v51, s31, v74
    v_lshlrev_b32 v52, 16, v82
    v_and_b32 v53, s31, v82
    v_pk_add_f32 v[48:49], v[48:49], v[50:51]
    v_pk_add_f32 v[48:49], v[48:49], v[52:53]
    v_pk_fma_f32 v[20:21], v[48:49], v[36:37], v[20:21]
    v_cvt_pk_bf16_f32 v66, v20, v21
    v_lshlrev_b32 v54, 16, v67
    v_and_b32 v55, s31, v67
    v_lshlrev_b32 v56, 16, v75
    v_and_b32 v57, s31, v75
    v_lshlrev_b32 v58, 16, v83
    v_and_b32 v59, s31, v83
    v_pk_add_f32 v[54:55], v[54:55], v[56:57]
    v_pk_add_f32 v[54:55], v[54:55], v[58:59]
    v_pk_fma_f32 v[22:23], v[54:55], v[38:39], v[22:23]
    v_cvt_pk_bf16_f32 v67, v22, v23
    buffer_store_dwordx4 v[64:67], v110, s[64:67], s57 offen offset:0
    v_lshlrev_b32 v48, 16, v68
    v_and_b32 v49, s31, v68
    v_lshlrev_b32 v50, 16, v76
    v_and_b32 v51, s31, v76
    v_lshlrev_b32 v52, 16, v84
    v_and_b32 v53, s31, v84
    v_pk_add_f32 v[48:49], v[48:49], v[50:51]
    v_pk_add_f32 v[48:49], v[48:49], v[52:53]
    v_pk_fma_f32 v[24:25], v[48:49], v[40:41], v[24:25]
    v_cvt_pk_bf16_f32 v68, v24, v25
    v_lshlrev_b32 v54, 16, v69
    v_and_b32 v55, s31, v69
    v_lshlrev_b32 v56, 16, v77
    v_and_b32 v57, s31, v77
    v_lshlrev_b32 v58, 16, v85
    v_and_b32 v59, s31, v85
    v_pk_add_f32 v[54:55], v[54:55], v[56:57]
    v_pk_add_f32 v[54:55], v[54:55], v[58:59]
    v_pk_fma_f32 v[26:27], v[54:55], v[42:43], v[26:27]
    v_cvt_pk_bf16_f32 v69, v26, v27
    v_lshlrev_b32 v48, 16, v70
    v_and_b32 v49, s31, v70
    v_lshlrev_b32 v50, 16, v78
    v_and_b32 v51, s31, v78
    v_lshlrev_b32 v52, 16, v86
    v_and_b32 v53, s31, v86
    v_pk_add_f32 v[48:49], v[48:49], v[50:51]
    v_pk_add_f32 v[48:49], v[48:49], v[52:53]
    v_pk_fma_f32 v[28:29], v[48:49], v[44:45], v[28:29]
    v_cvt_pk_bf16_f32 v70, v28, v29
    v_lshlrev_b32 v54, 16, v71
    v_and_b32 v55, s31, v71
    v_lshlrev_b32 v56, 16, v79
    v_and_b32 v57, s31, v79
    v_lshlrev_b32 v58, 16, v87
    v_and_b32 v59, s31, v87
    v_pk_add_f32 v[54:55], v[54:55], v[56:57]
    v_pk_add_f32 v[54:55], v[54:55], v[58:59]
    v_pk_fma_f32 v[30:31], v[54:55], v[46:47], v[30:31]
    v_cvt_pk_bf16_f32 v71, v30, v31
    buffer_store_dwordx4 v[68:71], v110, s[64:67], s57 offen offset:64
    v_lshlrev_b32 v48, 16, v88
    v_and_b32 v49, s31, v88
    v_lshlrev_b32 v50, 16, v90
    v_and_b32 v51, s31, v90
    v_lshlrev_b32 v52, 16, v92
    v_and_b32 v53, s31, v92
    v_pk_add_f32 v[48:49], v[48:49], v[50:51]
    v_pk_add_f32 v[48:49], v[48:49], v[52:53]
    v_pk_fma_f32 v[96:97], v[48:49], v[100:101], v[96:97]
    v_cvt_pk_bf16_f32 v88, v96, v97
    v_lshlrev_b32 v54, 16, v89
    v_and_b32 v55, s31, v89
    v_lshlrev_b32 v56, 16, v91
    v_and_b32 v57, s31, v91
    v_lshlrev_b32 v58, 16, v93
    v_and_b32 v59, s31, v93
    v_pk_add_f32 v[54:55], v[54:55], v[56:57]
    v_pk_add_f32 v[54:55], v[54:55], v[58:59]
    v_pk_fma_f32 v[98:99], v[54:55], v[102:103], v[98:99]
    v_cvt_pk_bf16_f32 v89, v98, v99
    s_cmp_eq_u32 s27, 0
    s_cselect_b32 exec_lo, -1, 0
    s_cselect_b32 exec_hi, 0, -1
    buffer_store_dwordx2 v[88:89], v111, s[64:67], s53 offen
    s_endpgm
KM_LD:
    s_mov_b32 s7, s26
    s_lshl_b32 s3, s4, 2
    s_add_u32 s3, s3, s5
    s_and_b32 s30, s2, 1
    s_mul_i32 s30, s30, 5308416
    s_mul_i32 s52, s3, 331776
    s_add_u32 s56, s52, s30
    s_mul_i32 s58, s7, 3072
    s_mul_i32 s30, s5, 0
    s_add_u32 s30, s30, s7
    s_add_u32 s31, s30, 0
    s_sub_u32 s60, s31, 12
    s_cselect_b32 s31, s31, s60
    s_mul_i32 s31, s31, 3072
    s_add_u32 s60, s31, s56
    s_add_u32 s31, s30, 4
    s_sub_u32 s61, s31, 12
    s_cselect_b32 s31, s31, s61
    s_mul_i32 s31, s31, 3072
    s_add_u32 s61, s31, s56
    s_add_u32 s31, s30, 8
    s_sub_u32 s62, s31, 12
    s_cselect_b32 s31, s31, s62
    s_mul_i32 s31, s31, 3072
    s_add_u32 s62, s31, s56
    v_lshlrev_b32 v8, 4, v1
    s_waitcnt lgkmcnt(0)
    s_add_u32 s36, s28, 54525952
    s_addc_u32 s37, s29, 0
    s_mov_b32 s38, 10616832
    s_mov_b32 s39, 0x20000
    s_add_u32 m0, s58, 0
    s_add_u32 s31, s60, 0
    buffer_load_dwordx4 v8, s[36:39], s31 offen offset:0 lds
    buffer_load_dwordx4 v8, s[36:39], s31 offen offset:1024 lds
    buffer_load_dwordx4 v8, s[36:39], s31 offen offset:2048 lds
    s_add_u32 m0, s58, 12288
    s_add_u32 s31, s60, 36864
    buffer_load_dwordx4 v8, s[36:39], s31 offen offset:0 lds
    buffer_load_dwordx4 v8, s[36:39], s31 offen offset:1024 lds
    buffer_load_dwordx4 v8, s[36:39], s31 offen offset:2048 lds
    s_add_u32 m0, s58, 24576
    s_add_u32 s31, s61, 0
    buffer_load_dwordx4 v8, s[36:39], s31 offen offset:0 lds
    buffer_load_dwordx4 v8, s[36:39], s31 offen offset:1024 lds
    buffer_load_dwordx4 v8, s[36:39], s31 offen offset:2048 lds
    s_add_u32 m0, s58, 36864
    s_add_u32 s31, s61, 36864
    buffer_load_dwordx4 v8, s[36:39], s31 offen offset:0 lds
    buffer_load_dwordx4 v8, s[36:39], s31 offen offset:1024 lds
    buffer_load_dwordx4 v8, s[36:39], s31 offen offset:2048 lds
    s_add_u32 s44, s28, 66060288
    s_addc_u32 s45, s29, 0
    s_mov_b32 s46, 5308416
    s_mov_b32 s47, 0x20000
    s_add_u32 s40, s28, 24641536
    s_addc_u32 s41, s29, 0
    s_mov_b32 s42, 73728
    s_mov_b32 s43, 0x20000
    s_add_u32 s48, s28, 196608
    s_addc_u32 s49, s29, 0
    s_mov_b32 s50, 32768
    s_mov_b32 s51, 0x20000
    s_mul_i32 s30, s3, 4608
    s_lshl_b32 s31, s7, 8
    s_add_u32 s64, s30, s31
    s_add_u32 s64, s64, 4096
    s_add_u32 s65, s31, 147456
    s_lshl_b32 s31, s7, 10
    s_add_u32 s30, s30, s31
    s_add_u32 m0, s31, 147456
    v_lshlrev_b32 v9, 2, v1
    v_lshlrev_b32 v10, 7, v1
    buffer_load_dwordx4 v8, s[40:43], s30 offen lds
    s_mul_i32 s4, s4, 1327104
    s_mov_b32 s27, s5
    s_lshl_b32 s59, s7, 3
    s_lshr_b32 s5, s2, 3
    s_lshl_b32 s5, s5, 2
    s_add_u32 s5, s5, s7
    s_mul_i32 s5, s5, 10368
    s_add_u32 s4, s4, s5
    s_mul_i32 s53, s7, 9216
    s_lshl_b32 s54, s2, 7
    s_andn2_b32 s55, s54, 3072
    v_and_b32 v13, 3, v1
    v_lshlrev_b32 v13, 10, v13
    v_lshlrev_b32 v14, 20, v0
    v_and_b32 v14, 0xff00000, v14
    s_mov_b32 s57, 0x100000
    s_waitcnt vmcnt(7)
    s_barrier
    s_add_u32 m0, s58, 49152
    s_add_u32 s31, s62, 0
    buffer_load_dwordx4 v8, s[36:39], s31 offen offset:0 lds
    buffer_load_dwordx4 v8, s[36:39], s31 offen offset:1024 lds
    buffer_load_dwordx4 v8, s[36:39], s31 offen offset:2048 lds
    s_add_u32 m0, s58, 61440
    s_add_u32 s31, s62, 36864
    buffer_load_dwordx4 v8, s[36:39], s31 offen offset:0 lds
    buffer_load_dwordx4 v8, s[36:39], s31 offen offset:1024 lds
    buffer_load_dwordx4 v8, s[36:39], s31 offen offset:2048 lds
    s_add_u32 m0, s58, 73728
    s_add_u32 s31, s60, 73728
    buffer_load_dwordx4 v8, s[36:39], s31 offen offset:0 lds
    buffer_load_dwordx4 v8, s[36:39], s31 offen offset:1024 lds
    buffer_load_dwordx4 v8, s[36:39], s31 offen offset:2048 lds
    s_waitcnt vmcnt(10)
    s_barrier
    s_add_u32 m0, s58, 98304
    s_add_u32 s31, s61, 73728
    buffer_load_dwordx4 v8, s[36:39], s31 offen offset:0 lds
    buffer_load_dwordx4 v8, s[36:39], s31 offen offset:1024 lds
    buffer_load_dwordx4 v8, s[36:39], s31 offen offset:2048 lds
    s_add_u32 m0, s58, 122880
    s_add_u32 s31, s62, 73728
    buffer_load_dwordx4 v8, s[36:39], s31 offen offset:0 lds
    buffer_load_dwordx4 v8, s[36:39], s31 offen offset:1024 lds
    buffer_load_dwordx4 v8, s[36:39], s31 offen offset:2048 lds
    s_waitcnt vmcnt(9)
    s_barrier
    s_add_u32 m0, s58, 0
    s_add_u32 s31, s60, 110592
    buffer_load_dwordx4 v8, s[36:39], s31 offen offset:0 lds
    buffer_load_dwordx4 v8, s[36:39], s31 offen offset:1024 lds
    buffer_load_dwordx4 v8, s[36:39], s31 offen offset:2048 lds
    s_add_u32 m0, s58, 12288
    s_add_u32 s31, s60, 147456
    buffer_load_dwordx4 v8, s[36:39], s31 offen offset:0 lds
    buffer_load_dwordx4 v8, s[36:39], s31 offen offset:1024 lds
    buffer_load_dwordx4 v8, s[36:39], s31 offen offset:2048 lds
    s_waitcnt vmcnt(12)
    s_barrier
    s_add_u32 m0, s58, 24576
    s_add_u32 s31, s61, 110592
    buffer_load_dwordx4 v8, s[36:39], s31 offen offset:0 lds
    buffer_load_dwordx4 v8, s[36:39], s31 offen offset:1024 lds
    buffer_load_dwordx4 v8, s[36:39], s31 offen offset:2048 lds
    s_add_u32 m0, s58, 36864
    s_add_u32 s31, s61, 147456
    buffer_load_dwordx4 v8, s[36:39], s31 offen offset:0 lds
    buffer_load_dwordx4 v8, s[36:39], s31 offen offset:1024 lds
    buffer_load_dwordx4 v8, s[36:39], s31 offen offset:2048 lds
    s_waitcnt vmcnt(15)
    s_barrier
    s_mov_b32 m0, s65
    s_nop 0
    buffer_load_dword v9, s[40:43], s64 offen lds
    s_add_u32 m0, s58, 49152
    s_add_u32 s31, s62, 110592
    buffer_load_dwordx4 v8, s[36:39], s31 offen offset:0 lds
    buffer_load_dwordx4 v8, s[36:39], s31 offen offset:1024 lds
    buffer_load_dwordx4 v8, s[36:39], s31 offen offset:2048 lds
    s_add_u32 m0, s58, 61440
    s_add_u32 s31, s62, 147456
    buffer_load_dwordx4 v8, s[36:39], s31 offen offset:0 lds
    buffer_load_dwordx4 v8, s[36:39], s31 offen offset:1024 lds
    buffer_load_dwordx4 v8, s[36:39], s31 offen offset:2048 lds
    s_waitcnt vmcnt(19)
    s_barrier
    s_add_u32 m0, s58, 73728
    s_add_u32 s31, s60, 184320
    buffer_load_dwordx4 v8, s[36:39], s31 offen offset:0 lds
    buffer_load_dwordx4 v8, s[36:39], s31 offen offset:1024 lds
    buffer_load_dwordx4 v8, s[36:39], s31 offen offset:2048 lds
    s_add_u32 m0, s58, 86016
    s_add_u32 s31, s60, 221184
    buffer_load_dwordx4 v8, s[36:39], s31 offen offset:0 lds
    buffer_load_dwordx4 v8, s[36:39], s31 offen offset:1024 lds
    buffer_load_dwordx4 v8, s[36:39], s31 offen offset:2048 lds
    s_waitcnt vmcnt(19)
    s_barrier
    s_add_u32 m0, s58, 98304
    s_add_u32 s31, s61, 184320
    buffer_load_dwordx4 v8, s[36:39], s31 offen offset:0 lds
    buffer_load_dwordx4 v8, s[36:39], s31 offen offset:1024 lds
    buffer_load_dwordx4 v8, s[36:39], s31 offen offset:2048 lds
    s_add_u32 m0, s58, 110592
    s_add_u32 s31, s61, 221184
    buffer_load_dwordx4 v8, s[36:39], s31 offen offset:0 lds
    buffer_load_dwordx4 v8, s[36:39], s31 offen offset:1024 lds
    buffer_load_dwordx4 v8, s[36:39], s31 offen offset:2048 lds
    s_waitcnt vmcnt(19)
    s_barrier
    s_add_u32 m0, s58, 122880
    s_add_u32 s31, s62, 184320
    buffer_load_dwordx4 v8, s[36:39], s31 offen offset:0 lds
    buffer_load_dwordx4 v8, s[36:39], s31 offen offset:1024 lds
    buffer_load_dwordx4 v8, s[36:39], s31 offen offset:2048 lds
    s_add_u32 m0, s58, 135168
    s_add_u32 s31, s62, 221184
    buffer_load_dwordx4 v8, s[36:39], s31 offen offset:0 lds
    buffer_load_dwordx4 v8, s[36:39], s31 offen offset:1024 lds
    buffer_load_dwordx4 v8, s[36:39], s31 offen offset:2048 lds
    s_waitcnt vmcnt(18)
    s_barrier
    s_add_u32 m0, s58, 0
    s_add_u32 s31, s60, 258048
    buffer_load_dwordx4 v8, s[36:39], s31 offen offset:0 lds
    buffer_load_dwordx4 v8, s[36:39], s31 offen offset:1024 lds
    buffer_load_dwordx4 v8, s[36:39], s31 offen offset:2048 lds
    s_add_u32 m0, s58, 12288
    s_add_u32 s31, s60, 294912
    buffer_load_dwordx4 v8, s[36:39], s31 offen offset:0 lds
    buffer_load_dwordx4 v8, s[36:39], s31 offen offset:1024 lds
    buffer_load_dwordx4 v8, s[36:39], s31 offen offset:2048 lds
    s_waitcnt vmcnt(18)
    s_barrier
    v_mov_b32 v15, 2
    buffer_store_dword v15, v14, s[48:51], s54 offen sc1
    s_add_u32 m0, s58, 24576
    s_add_u32 s31, s61, 258048
    buffer_load_dwordx4 v8, s[36:39], s31 offen offset:0 lds
    buffer_load_dwordx4 v8, s[36:39], s31 offen offset:1024 lds
    buffer_load_dwordx4 v8, s[36:39], s31 offen offset:2048 lds
    s_add_u32 m0, s58, 36864
    s_add_u32 s31, s61, 294912
    buffer_load_dwordx4 v8, s[36:39], s31 offen offset:0 lds
    buffer_load_dwordx4 v8, s[36:39], s31 offen offset:1024 lds
    buffer_load_dwordx4 v8, s[36:39], s31 offen offset:2048 lds
    s_waitcnt vmcnt(19)
    s_barrier
    s_add_u32 m0, s58, 49152
    s_add_u32 s31, s62, 258048
    buffer_load_dwordx4 v8, s[36:39], s31 offen offset:0 lds
    buffer_load_dwordx4 v8, s[36:39], s31 offen offset:1024 lds
    buffer_load_dwordx4 v8, s[36:39], s31 offen offset:2048 lds
    s_add_u32 m0, s58, 61440
    s_add_u32 s31, s62, 294912
    buffer_load_dwordx4 v8, s[36:39], s31 offen offset:0 lds
    buffer_load_dwordx4 v8, s[36:39], s31 offen offset:1024 lds
    buffer_load_dwordx4 v8, s[36:39], s31 offen offset:2048 lds
    s_waitcnt vmcnt(19)
    s_barrier
    buffer_load_dword v17, v13, s[48:51], s55 offen sc1
    s_waitcnt vmcnt(14)
    s_barrier
    v_mov_b32 v15, 4
    buffer_store_dword v15, v14, s[48:51], s54 offen sc1
    s_lshr_b32 s30, 17302528, s59
    s_add_u32 s31, s30, s27
    s_and_b32 s31, s31, 3
    s_and_b32 s30, s30, 0xfc
    s_add_u32 s30, s30, s31
    s_mul_i32 s30, s30, 9216
    s_add_u32 s30, s30, s52
    s_add_u32 m0, s53, 73728
    s_add_u32 s31, s30, 0
    buffer_load_dwordx4 v8, s[44:47], s31 offen offset:0 lds
    buffer_load_dwordx4 v8, s[44:47], s31 offen offset:1024 lds
    buffer_load_dwordx4 v8, s[44:47], s31 offen offset:2048 lds
    s_add_u32 m0, s53, 76800
    s_add_u32 s31, s30, 3072
    buffer_load_dwordx4 v8, s[44:47], s31 offen offset:0 lds
    buffer_load_dwordx4 v8, s[44:47], s31 offen offset:1024 lds
    buffer_load_dwordx4 v8, s[44:47], s31 offen offset:2048 lds
    s_add_u32 m0, s53, 79872
    s_add_u32 s31, s30, 6144
    buffer_load_dwordx4 v8, s[44:47], s31 offen offset:0 lds
    buffer_load_dwordx4 v8, s[44:47], s31 offen offset:1024 lds
    buffer_load_dwordx4 v8, s[44:47], s31 offen offset:2048 lds
    s_waitcnt vmcnt(10)
KM_P13:
    v_cmp_gt_u32 vcc, 2, v17
    s_nop 1
    s_cbranch_vccz KM_Q13
    s_sub_u32 s57, s57, 1
    s_cmp_lt_i32 s57, 0
    s_cbranch_scc1 KM_Q13
    s_sleep 2
    buffer_load_dword v17, v13, s[48:51], s55 offen sc1
    s_waitcnt vmcnt(0)
    s_branch KM_P13
KM_Q13:
    s_waitcnt vmcnt(17)
    s_barrier
    s_lshr_b32 s30, 84673282, s59
    s_add_u32 s31, s30, s27
    s_and_b32 s31, s31, 3
    s_and_b32 s30, s30, 0xfc
    s_add_u32 s30, s30, s31
    s_mul_i32 s30, s30, 9216
    s_add_u32 s30, s30, s52
    s_add_u32 m0, s53, 110592
    s_add_u32 s31, s30, 0
    buffer_load_dwordx4 v8, s[44:47], s31 offen offset:0 lds
    buffer_load_dwordx4 v8, s[44:47], s31 offen offset:1024 lds
    buffer_load_dwordx4 v8, s[44:47], s31 offen offset:2048 lds
    s_add_u32 m0, s53, 113664
    s_add_u32 s31, s30, 3072
    buffer_load_dwordx4 v8, s[44:47], s31 offen offset:0 lds
    buffer_load_dwordx4 v8, s[44:47], s31 offen offset:1024 lds
    buffer_load_dwordx4 v8, s[44:47], s31 offen offset:2048 lds
    s_add_u32 m0, s53, 116736
    s_add_u32 s31, s30, 6144
    buffer_load_dwordx4 v8, s[44:47], s31 offen offset:0 lds
    buffer_load_dwordx4 v8, s[44:47], s31 offen offset:1024 lds
    buffer_load_dwordx4 v8, s[44:47], s31 offen offset:2048 lds
    s_waitcnt vmcnt(20)
    s_barrier
    buffer_load_dword v16, v13, s[48:51], s55 offen sc1
    s_waitcnt vmcnt(10)
    s_barrier
    v_mov_b32 v15, 6
    buffer_store_dword v15, v14, s[48:51], s54 offen sc1
    s_lshr_b32 s30, 152045318, s59
    s_add_u32 s31, s30, s27
    s_and_b32 s31, s31, 3
    s_and_b32 s30, s30, 0xfc
    s_add_u32 s30, s30, s31
    s_mul_i32 s30, s30, 9216
    s_add_u32 s30, s30, s52
    s_add_u32 m0, s53, 0
    s_add_u32 s31, s30, 0
    buffer_load_dwordx4 v8, s[44:47], s31 offen offset:0 lds
    buffer_load_dwordx4 v8, s[44:47], s31 offen offset:1024 lds
    buffer_load_dwordx4 v8, s[44:47], s31 offen offset:2048 lds
    s_add_u32 m0, s53, 3072
    s_add_u32 s31, s30, 3072
    buffer_load_dwordx4 v8, s[44:47], s31 offen offset:0 lds
    buffer_load_dwordx4 v8, s[44:47], s31 offen offset:1024 lds
    buffer_load_dwordx4 v8, s[44:47], s31 offen offset:2048 lds
    s_add_u32 m0, s53, 6144
    s_add_u32 s31, s30, 6144
    buffer_load_dwordx4 v8, s[44:47], s31 offen offset:0 lds
    buffer_load_dwordx4 v8, s[44:47], s31 offen offset:1024 lds
    buffer_load_dwordx4 v8, s[44:47], s31 offen offset:2048 lds
    s_waitcnt vmcnt(10)
KM_P16:
    v_cmp_gt_u32 vcc, 4, v16
    s_nop 1
    s_cbranch_vccz KM_Q16
    s_sub_u32 s57, s57, 1
    s_cmp_lt_i32 s57, 0
    s_cbranch_scc1 KM_Q16
    s_sleep 2
    buffer_load_dword v16, v13, s[48:51], s55 offen sc1
    s_waitcnt vmcnt(0)
    s_branch KM_P16
KM_Q16:
    s_waitcnt vmcnt(11)
    s_barrier
    buffer_load_dword v16, v13, s[48:51], s55 offen sc1
    s_lshr_b32 s30, 219417354, s59
    s_add_u32 s31, s30, s27
    s_and_b32 s31, s31, 3
    s_and_b32 s30, s30, 0xfc
    s_add_u32 s30, s30, s31
    s_mul_i32 s30, s30, 9216
    s_add_u32 s30, s30, s52
    s_add_u32 m0, s53, 36864
    s_add_u32 s31, s30, 0
    buffer_load_dwordx4 v8, s[44:47], s31 offen offset:0 lds
    buffer_load_dwordx4 v8, s[44:47], s31 offen offset:1024 lds
    buffer_load_dwordx4 v8, s[44:47], s31 offen offset:2048 lds
    s_add_u32 m0, s53, 39936
    s_add_u32 s31, s30, 3072
    buffer_load_dwordx4 v8, s[44:47], s31 offen offset:0 lds
    buffer_load_dwordx4 v8, s[44:47], s31 offen offset:1024 lds
    buffer_load_dwordx4 v8, s[44:47], s31 offen offset:2048 lds
    s_add_u32 m0, s53, 43008
    s_add_u32 s31, s30, 6144
    buffer_load_dwordx4 v8, s[44:47], s31 offen offset:0 lds
    buffer_load_dwordx4 v8, s[44:47], s31 offen offset:1024 lds
    buffer_load_dwordx4 v8, s[44:47], s31 offen offset:2048 lds
    s_waitcnt vmcnt(10)
    s_barrier
    v_mov_b32 v15, 8
    buffer_store_dword v15, v14, s[48:51], s54 offen sc1
    s_lshr_b32 s30, 286789390, s59
    s_add_u32 s31, s30, s27
    s_and_b32 s31, s31, 3
    s_and_b32 s30, s30, 0xfc
    s_add_u32 s30, s30, s31
    s_mul_i32 s30, s30, 9216
    s_add_u32 s30, s30, s52
    s_add_u32 m0, s53, 73728
    s_add_u32 s31, s30, 0
    buffer_load_dwordx4 v8, s[44:47], s31 offen offset:0 lds
    buffer_load_dwordx4 v8, s[44:47], s31 offen offset:1024 lds
    buffer_load_dwordx4 v8, s[44:47], s31 offen offset:2048 lds
    s_add_u32 m0, s53, 76800
    s_add_u32 s31, s30, 3072
    buffer_load_dwordx4 v8, s[44:47], s31 offen offset:0 lds
    buffer_load_dwordx4 v8, s[44:47], s31 offen offset:1024 lds
    buffer_load_dwordx4 v8, s[44:47], s31 offen offset:2048 lds
    s_add_u32 m0, s53, 79872
    s_add_u32 s31, s30, 6144
    buffer_load_dwordx4 v8, s[44:47], s31 offen offset:0 lds
    buffer_load_dwordx4 v8, s[44:47], s31 offen offset:1024 lds
    buffer_load_dwordx4 v8, s[44:47], s31 offen offset:2048 lds
    s_waitcnt vmcnt(19)
KM_P18:
    v_cmp_gt_u32 vcc, 6, v16
    s_nop 1
    s_cbranch_vccz KM_Q18
    s_sub_u32 s57, s57, 1
    s_cmp_lt_i32 s57, 0
    s_cbranch_scc1 KM_Q18
    s_sleep 2
    buffer_load_dword v16, v13, s[48:51], s55 offen sc1
    s_waitcnt vmcnt(0)
    s_branch KM_P18
KM_Q18:
    s_waitcnt vmcnt(10)
    s_barrier
    buffer_load_dword v16, v13, s[48:51], s55 offen sc1
    v_mov_b32 v15, 9
    buffer_store_dword v15, v14, s[48:51], s54 offen sc1
    s_lshr_b32 s30, 354161426, s59
    s_add_u32 s31, s30, s27
    s_and_b32 s31, s31, 3
    s_and_b32 s30, s30, 0xfc
    s_add_u32 s30, s30, s31
    s_mul_i32 s30, s30, 9216
    s_add_u32 s30, s30, s52
    s_add_u32 m0, s53, 110592
    s_add_u32 s31, s30, 0
    buffer_load_dwordx4 v8, s[44:47], s31 offen offset:0 lds
    buffer_load_dwordx4 v8, s[44:47], s31 offen offset:1024 lds
    buffer_load_dwordx4 v8, s[44:47], s31 offen offset:2048 lds
    s_add_u32 m0, s53, 113664
    s_add_u32 s31, s30, 3072
    buffer_load_dwordx4 v8, s[44:47], s31 offen offset:0 lds
    buffer_load_dwordx4 v8, s[44:47], s31 offen offset:1024 lds
    buffer_load_dwordx4 v8, s[44:47], s31 offen offset:2048 lds
    s_add_u32 m0, s53, 116736
    s_add_u32 s31, s30, 6144
    buffer_load_dwordx4 v8, s[44:47], s31 offen offset:0 lds
    buffer_load_dwordx4 v8, s[44:47], s31 offen offset:1024 lds
    buffer_load_dwordx4 v8, s[44:47], s31 offen offset:2048 lds
    s_waitcnt vmcnt(11)
    s_barrier
    buffer_load_dword v17, v13, s[48:51], s55 offen sc1
    s_lshr_b32 s30, 421533462, s59
    s_add_u32 s31, s30, s27
    s_and_b32 s31, s31, 3
    s_and_b32 s30, s30, 0xfc
    s_add_u32 s30, s30, s31
    s_mul_i32 s30, s30, 9216
    s_add_u32 s30, s30, s52
    s_add_u32 m0, s53, 0
    s_add_u32 s31, s30, 0
    buffer_load_dwordx4 v8, s[44:47], s31 offen offset:0 lds
    buffer_load_dwordx4 v8, s[44:47], s31 offen offset:1024 lds
    buffer_load_dwordx4 v8, s[44:47], s31 offen offset:2048 lds
    s_add_u32 m0, s53, 3072
    s_add_u32 s31, s30, 3072
    buffer_load_dwordx4 v8, s[44:47], s31 offen offset:0 lds
    buffer_load_dwordx4 v8, s[44:47], s31 offen offset:1024 lds
    buffer_load_dwordx4 v8, s[44:47], s31 offen offset:2048 lds
    s_add_u32 m0, s53, 6144
    s_add_u32 s31, s30, 6144
    buffer_load_dwordx4 v8, s[44:47], s31 offen offset:0 lds
    buffer_load_dwordx4 v8, s[44:47], s31 offen offset:1024 lds
    buffer_load_dwordx4 v8, s[44:47], s31 offen offset:2048 lds
    s_waitcnt vmcnt(20)
KM_P20:
    v_cmp_gt_u32 vcc, 8, v16
    s_nop 1
    s_cbranch_vccz KM_Q20
    s_sub_u32 s57, s57, 1
    s_cmp_lt_i32 s57, 0
    s_cbranch_scc1 KM_Q20
    s_sleep 2
    buffer_load_dword v16, v13, s[48:51], s55 offen sc1
    s_waitcnt vmcnt(0)
    s_branch KM_P20
KM_Q20:
    s_waitcnt vmcnt(10)
    s_barrier
    s_lshr_b32 s30, 505223962, s59
    s_add_u32 s31, s30, s27
    s_and_b32 s31, s31, 3
    s_and_b32 s30, s30, 0xfc
    s_add_u32 s30, s30, s31
    s_mul_i32 s30, s30, 9216
    s_add_u32 s30, s30, s52
    s_add_u32 m0, s53, 36864
    s_add_u32 s31, s30, 0
    buffer_load_dwordx4 v8, s[44:47], s31 offen offset:0 lds
    buffer_load_dwordx4 v8, s[44:47], s31 offen offset:1024 lds
    buffer_load_dwordx4 v8, s[44:47], s31 offen offset:2048 lds
    s_add_u32 m0, s53, 39936
    s_add_u32 s31, s30, 3072
    buffer_load_dwordx4 v8, s[44:47], s31 offen offset:0 lds
    buffer_load_dwordx4 v8, s[44:47], s31 offen offset:1024 lds
    buffer_load_dwordx4 v8, s[44:47], s31 offen offset:2048 lds
    s_add_u32 m0, s53, 43008
    s_add_u32 s31, s30, 6144
    buffer_load_dwordx4 v8, s[44:47], s31 offen offset:0 lds
    buffer_load_dwordx4 v8, s[44:47], s31 offen offset:1024 lds
    buffer_load_dwordx4 v8, s[44:47], s31 offen offset:2048 lds
    s_waitcnt vmcnt(18)
KM_P21:
    v_cmp_gt_u32 vcc, 9, v17
    s_nop 1
    s_cbranch_vccz KM_Q21
    s_sub_u32 s57, s57, 1
    s_cmp_lt_i32 s57, 0
    s_cbranch_scc1 KM_Q21
    s_sleep 2
    buffer_load_dword v17, v13, s[48:51], s55 offen sc1
    s_waitcnt vmcnt(0)
    s_branch KM_P21
KM_Q21:
    s_waitcnt vmcnt(9)
    s_barrier
    s_lshr_b32 s30, 589439263, s59
    s_add_u32 s31, s30, s27
    s_and_b32 s31, s31, 3
    s_and_b32 s30, s30, 0xfc
    s_add_u32 s30, s30, s31
    s_mul_i32 s30, s30, 9216
    s_add_u32 s30, s30, s52
    s_add_u32 m0, s53, 73728
    s_add_u32 s31, s30, 0
    buffer_load_dwordx4 v8, s[44:47], s31 offen offset:0 lds
    buffer_load_dwordx4 v8, s[44:47], s31 offen offset:1024 lds
    buffer_load_dwordx4 v8, s[44:47], s31 offen offset:2048 lds
    s_add_u32 m0, s53, 76800
    s_add_u32 s31, s30, 3072
    buffer_load_dwordx4 v8, s[44:47], s31 offen offset:0 lds
    buffer_load_dwordx4 v8, s[44:47], s31 offen offset:1024 lds
    buffer_load_dwordx4 v8, s[44:47], s31 offen offset:2048 lds
    s_add_u32 m0, s53, 79872
    s_add_u32 s31, s30, 6144
    buffer_load_dwordx4 v8, s[44:47], s31 offen offset:0 lds
    buffer_load_dwordx4 v8, s[44:47], s31 offen offset:1024 lds
    buffer_load_dwordx4 v8, s[44:47], s31 offen offset:2048 lds
    s_waitcnt vmcnt(9)
    s_barrier
    s_waitcnt vmcnt(0)
    s_barrier
END_km_kernel:
    s_endpgm
CODE_END:
    s_endpgm
.section .rodata,"a"
.p2align 6
.amdhsa_kernel k1_kernel
  .amdhsa_next_free_vgpr 256
  .amdhsa_next_free_sgpr 96
  .amdhsa_accum_offset 256
  .amdhsa_group_segment_fixed_size 0
  .amdhsa_kernarg_size 88
  .amdhsa_user_sgpr_count 2
  .amdhsa_user_sgpr_kernarg_segment_ptr 1
  .amdhsa_system_sgpr_workgroup_id_x 1
.end_amdhsa_kernel
.p2align 6
.amdhsa_kernel k2_kernel
  .amdhsa_next_free_vgpr 168
  .amdhsa_next_free_sgpr 96
  .amdhsa_accum_offset 168
  .amdhsa_group_segment_fixed_size 0
  .amdhsa_kernarg_size 88
  .amdhsa_user_sgpr_count 2
  .amdhsa_user_sgpr_kernarg_segment_ptr 1
  .amdhsa_system_sgpr_workgroup_id_x 1
.end_amdhsa_kernel
.p2align 6
.amdhsa_kernel km_kernel
  .amdhsa_next_free_vgpr 256
  .amdhsa_next_free_sgpr 96
  .amdhsa_accum_offset 112
  .amdhsa_group_segment_fixed_size 0
  .amdhsa_kernarg_size 88
  .amdhsa_user_sgpr_count 2
  .amdhsa_user_sgpr_kernarg_segment_ptr 1
  .amdhsa_system_sgpr_workgroup_id_x 1
.end_amdhsa_kernel
```
